```python
import torch

def _softmax(x, axis=-1):
    return torch.softmax(x, dim=axis)
def _gelu(x):
    return torch.nn.functional.gelu(x, approximate="tanh")
def _silu(x):
    return torch.nn.functional.silu(x)
def _sigmoid(x):
    return torch.sigmoid(x)
def _layernorm(x, axis=-1, eps=1e-5):
    m = x.mean(dim=axis, keepdim=True)
    v = x.var(dim=axis, keepdim=True, unbiased=False)
    return (x - m) / torch.sqrt(v + eps)
def _scatter_add(tgt, idx, src, axis=0):
    return tgt.clone().index_add_(axis, idx, src)
def _segment_sum(src, seg, n):
    out = torch.zeros((n,) + src.shape[1:], dtype=src.dtype)
    return out.index_add_(0, seg, src)
def _pad(x, pw):
    flat = tuple(v for pair in reversed(pw) for v in pair)
    return torch.nn.functional.pad(x, flat)

kernel_name = 'sequential_preLN__softmax_full_mha__mixer_token_mlp__prompt'

def setup_inputs():

    _w = (lambda a: (lambda t: t.to(torch.bfloat16) if t.is_floating_point() else t)(torch.as_tensor(a)))
    def _A_setup():
        B, S, D = 1, 2048, 576
        return {
            "x": _w((lambda *s: torch.randn(*s, dtype=torch.bfloat16) * 0.05)(B, S, D)),
            "wqkv": _w((lambda *s: torch.randn(*s, dtype=torch.bfloat16) * 0.05)(D, 3 * D)),
            "wo": _w((lambda *s: torch.randn(*s, dtype=torch.bfloat16) * 0.05)(D, D)),
        }
    _A_in = _A_setup()

    def _B_setup():
        B, S, D, F = 1, 2048, 576, 4608
        return {
            "x": _w((lambda *s: torch.randn(*s, dtype=torch.bfloat16) * 0.05)(B, S, D)),
            "w1": _w((lambda *s: torch.randn(*s, dtype=torch.bfloat16) * 0.8)(S, F) * (S ** -0.5)),
            "b1": _w((lambda *s: torch.randn(*s, dtype=torch.bfloat16) * 12.8)(F) * 0.02),
            "w2": _w((lambda *s: torch.randn(*s, dtype=torch.bfloat16) * 0.4)(F, S) * (F ** -0.5)),
            "b2": _w((lambda *s: torch.randn(*s, dtype=torch.bfloat16) * 6.4)(S) * 0.02),
        }
    _B_in = _B_setup()

    return {
        "A_x": _A_in["x"],
        "A_wqkv": _A_in["wqkv"],
        "A_wo": _A_in["wo"],
        "B_x": _B_in["x"],
        "B_w1": _B_in["w1"],
        "B_b1": _B_in["b1"],
        "B_w2": _B_in["w2"],
        "B_b2": _B_in["b2"],
    }

def reference(A_x, A_wqkv, A_wo, B_x, B_w1, B_b1, B_w2, B_b2):
    def _A_ref(x, wqkv, wo):
        B, S, D = x.shape
        H = 32; Dh = D // H
        qkv = (lambda x, *d: x.permute(*d))((x @ wqkv).reshape(B, S, 3, H, Dh), 2, 0, 3, 1, 4)
        q, k, v = qkv[0], qkv[1], qkv[2]
        scale = Dh ** -0.5
        scores = torch.einsum("bhqd,bhkd->bhqk", q, k) * scale
        p = _softmax(scores, axis=-1)
        o = torch.einsum("bhqk,bhkd->bhqd", p, v)
        return (lambda x, *d: x.permute(*d))(o, 0, 2, 1, 3).reshape(B, S, D) @ wo

    def _B_ref(x, w1, b1, w2, b2):
        B, S, D = x.shape
        h = _layernorm(x, axis=-1)
        u = torch.einsum("bsd,sf->bdf", h, w1) + b1
        u = _gelu(u)
        y = torch.einsum("bdf,fs->bds", u, w2) + b2
        return (lambda x, *d: x.permute(*d))(y, 0, 2, 1)

    x = A_x
    h = x + _A_ref(_layernorm(x, axis=-1), A_wqkv, A_wo)
    h2 = h + _B_ref(_layernorm(h, axis=-1), B_w1, B_b1, B_w2, B_b2)
    return h2
```

```asm
; @launch kernel=qkv_kernel grid=(192,1,1) block=(512,1,1) lds=140928
; @launch kernel=attn_kernel grid=(256,1,1) block=(512,1,1) lds=151552
; @launch kernel=wo_kernel grid=(192,1,1) block=(512,1,1) lds=163840
; @launch kernel=ln2_kernel grid=(128,1,1) block=(256,1,1) lds=0
; @launch kernel=mlp1_kernel grid=(216,1,1) block=(512,1,1) lds=114688
; @launch kernel=mlp2_kernel grid=(192,1,1) block=(512,1,1) lds=122880
.amdgcn_target "amdgcn-amd-amdhsa--gfx950"
.text
.globl qkv_kernel
.p2align 8
.type qkv_kernel,@function
qkv_kernel:
    s_cmp_ge_u32 s2, 192
    s_cbranch_scc1 L_qkv_kernel_end
    s_load_dwordx16 s[64:79], s[0:1], 0
    s_load_dwordx4 s[80:83], s[0:1], 64
    s_load_dwordx2 s[84:85], s[0:1], 80
    s_waitcnt lgkmcnt(0)
    s_and_b32 s31, s2, 7
    s_lshr_b32 s32, s2, 3
    s_lshr_b32 s33, s31, 1
    s_lshl_b32 s33, s33, 2
    s_and_b32 s34, s32, 3
    s_add_u32 s33, s33, s34
    s_and_b32 s34, s31, 1
    s_mul_i32 s34, s34, 6
    s_lshr_b32 s35, s32, 2
    s_add_u32 s34, s34, s35
    v_lshrrev_b32 v1, 6, v0
    v_and_b32 v2, 63, v0
    v_readfirstlane_b32 s38, v1
    v_and_b32 v3, 15, v2
    v_lshrrev_b32 v4, 4, v2
    s_lshr_b32 s55, s38, 2
    s_and_b32 s38, s38, 3
    s_cmp_eq_u32 s55, 0
    s_cbranch_scc1 L_qkv_kernel_comp
    s_mov_b32 s8, s64
    s_and_b32 s9, s65, 0xffff
    s_mov_b32 s10, 2359296
    s_mov_b32 s11, 0x20000
    s_mov_b32 s12, s66
    s_and_b32 s13, s67, 0xffff
    s_mov_b32 s14, 1990656
    s_mov_b32 s15, 0x20000
    s_lshl_b32 s36, s33, 7
    s_lshl_b32 s37, s38, 5
    s_add_u32 s36, s36, s37
    s_mul_i32 s36, s36, 1152
    v_lshrrev_b32 v5, 3, v2
    v_mul_u32_u24 v5, 1152, v5
    v_and_b32 v6, 7, v2
    v_xor_b32 v7, v6, v4
    v_lshl_add_u32 v28, v7, 4, v5
    v_xor_b32 v7, 4, v7
    v_lshl_add_u32 v29, v7, 4, v5
    s_lshl_b32 s52, s38, 12
    s_add_u32 s52, s52, 18432
    s_add_u32 m0, s52, 0
    s_add_u32 s53, s36, 0
    buffer_load_dwordx4 v28, s[8:11], s53 offen lds
    s_add_u32 m0, s52, 1024
    s_add_u32 s53, s36, 9216
    buffer_load_dwordx4 v29, s[8:11], s53 offen lds
    s_add_u32 m0, s52, 2048
    s_add_u32 s53, s36, 18432
    buffer_load_dwordx4 v28, s[8:11], s53 offen lds
    s_add_u32 m0, s52, 3072
    s_add_u32 s53, s36, 27648
    buffer_load_dwordx4 v29, s[8:11], s53 offen lds
    s_add_u32 s36, s36, 128
    s_mul_i32 s37, s34, 288
    v_add_u32 v5, 0, v2
    v_mul_u32_u24 v6, 3641, v5
    v_lshrrev_b32 v6, 16, v6
    v_mul_u32_u24 v7, 18, v6
    v_sub_u32 v7, v5, v7
    v_and_b32 v5, 3, v6
    v_and_b32 v19, 4, v6
    v_lshl_or_b32 v5, v19, 1, v5
    v_and_b32 v19, 8, v6
    v_lshrrev_b32 v19, 1, v19
    v_or_b32 v5, v5, v19
    s_lshl_b32 s39, s38, 4
    v_add_u32 v5, s39, v5
    v_mul_u32_u24 v5, 3456, v5
    v_lshl_add_u32 v5, v7, 4, v5
    s_sub_u32 s39, s37, 0
    v_add_u32 v8, s39, v5
    v_add_u32 v5, 64, v2
    v_mul_u32_u24 v6, 3641, v5
    v_lshrrev_b32 v6, 16, v6
    v_mul_u32_u24 v7, 18, v6
    v_sub_u32 v7, v5, v7
    v_and_b32 v5, 3, v6
    v_and_b32 v19, 4, v6
    v_lshl_or_b32 v5, v19, 1, v5
    v_and_b32 v19, 8, v6
    v_lshrrev_b32 v19, 1, v19
    v_or_b32 v5, v5, v19
    s_lshl_b32 s39, s38, 4
    v_add_u32 v5, s39, v5
    v_mul_u32_u24 v5, 3456, v5
    v_lshl_add_u32 v5, v7, 4, v5
    s_sub_u32 s39, s37, 1024
    v_add_u32 v9, s39, v5
    v_add_u32 v5, 128, v2
    v_mul_u32_u24 v6, 3641, v5
    v_lshrrev_b32 v6, 16, v6
    v_mul_u32_u24 v7, 18, v6
    v_sub_u32 v7, v5, v7
    v_and_b32 v5, 3, v6
    v_and_b32 v19, 4, v6
    v_lshl_or_b32 v5, v19, 1, v5
    v_and_b32 v19, 8, v6
    v_lshrrev_b32 v19, 1, v19
    v_or_b32 v5, v5, v19
    s_lshl_b32 s39, s38, 4
    v_add_u32 v5, s39, v5
    v_mul_u32_u24 v5, 3456, v5
    v_lshl_add_u32 v5, v7, 4, v5
    s_sub_u32 s39, s37, 2048
    v_add_u32 v10, s39, v5
    v_add_u32 v5, 192, v2
    v_mul_u32_u24 v6, 3641, v5
    v_lshrrev_b32 v6, 16, v6
    v_mul_u32_u24 v7, 18, v6
    v_sub_u32 v7, v5, v7
    v_and_b32 v5, 3, v6
    v_and_b32 v19, 4, v6
    v_lshl_or_b32 v5, v19, 1, v5
    v_and_b32 v19, 8, v6
    v_lshrrev_b32 v19, 1, v19
    v_or_b32 v5, v5, v19
    s_lshl_b32 s39, s38, 4
    v_add_u32 v5, s39, v5
    v_mul_u32_u24 v5, 3456, v5
    v_lshl_add_u32 v5, v7, 4, v5
    s_sub_u32 s39, s37, 3072
    v_add_u32 v11, s39, v5
    v_add_u32 v5, 256, v2
    v_mul_u32_u24 v6, 3641, v5
    v_lshrrev_b32 v6, 16, v6
    v_mul_u32_u24 v7, 18, v6
    v_sub_u32 v7, v5, v7
    v_and_b32 v5, 3, v6
    v_and_b32 v19, 4, v6
    v_lshl_or_b32 v5, v19, 1, v5
    v_and_b32 v19, 8, v6
    v_lshrrev_b32 v19, 1, v19
    v_or_b32 v5, v5, v19
    s_lshl_b32 s39, s38, 4
    v_add_u32 v5, s39, v5
    v_mul_u32_u24 v5, 3456, v5
    v_lshl_add_u32 v5, v7, 4, v5
    s_sub_u32 s39, s37, 0
    v_add_u32 v12, s39, v5
    s_mul_i32 s40, s38, 4608
    s_mov_b32 s28, 0
    s_add_u32 m0, s40, 0
    s_nop 0
    buffer_load_dwordx4 v8, s[12:15], s28 offen offset:0 lds
    buffer_load_dwordx4 v9, s[12:15], s28 offen offset:1024 lds
    buffer_load_dwordx4 v10, s[12:15], s28 offen offset:2048 lds
    buffer_load_dwordx4 v11, s[12:15], s28 offen offset:3072 lds
    s_add_u32 m0, s40, 4096
    s_mov_b64 exec, 0xffffffff
    buffer_load_dwordx4 v12, s[12:15], s28 offen lds
    s_mov_b64 exec, -1
    s_add_u32 s28, s28, 221184
    s_add_u32 m0, s52, 34816
    s_add_u32 s53, s36, 0
    buffer_load_dwordx4 v28, s[8:11], s53 offen lds
    s_add_u32 m0, s52, 35840
    s_add_u32 s53, s36, 9216
    buffer_load_dwordx4 v29, s[8:11], s53 offen lds
    s_add_u32 m0, s52, 36864
    s_add_u32 s53, s36, 18432
    buffer_load_dwordx4 v28, s[8:11], s53 offen lds
    s_add_u32 m0, s52, 37888
    s_add_u32 s53, s36, 27648
    buffer_load_dwordx4 v29, s[8:11], s53 offen lds
    s_add_u32 s36, s36, 128
    s_add_u32 m0, s40, 34816
    s_nop 0
    buffer_load_dwordx4 v8, s[12:15], s28 offen offset:0 lds
    buffer_load_dwordx4 v9, s[12:15], s28 offen offset:1024 lds
    buffer_load_dwordx4 v10, s[12:15], s28 offen offset:2048 lds
    buffer_load_dwordx4 v11, s[12:15], s28 offen offset:3072 lds
    s_add_u32 m0, s40, 38912
    s_mov_b64 exec, 0xffffffff
    buffer_load_dwordx4 v12, s[12:15], s28 offen lds
    s_mov_b64 exec, -1
    s_add_u32 s28, s28, 221184
    s_add_u32 m0, s52, 69632
    s_add_u32 s53, s36, 0
    buffer_load_dwordx4 v28, s[8:11], s53 offen lds
    s_add_u32 m0, s52, 70656
    s_add_u32 s53, s36, 9216
    buffer_load_dwordx4 v29, s[8:11], s53 offen lds
    s_add_u32 m0, s52, 71680
    s_add_u32 s53, s36, 18432
    buffer_load_dwordx4 v28, s[8:11], s53 offen lds
    s_add_u32 m0, s52, 72704
    s_add_u32 s53, s36, 27648
    buffer_load_dwordx4 v29, s[8:11], s53 offen lds
    s_add_u32 s36, s36, 128
    s_add_u32 m0, s40, 69632
    s_nop 0
    buffer_load_dwordx4 v8, s[12:15], s28 offen offset:0 lds
    buffer_load_dwordx4 v9, s[12:15], s28 offen offset:1024 lds
    buffer_load_dwordx4 v10, s[12:15], s28 offen offset:2048 lds
    buffer_load_dwordx4 v11, s[12:15], s28 offen offset:3072 lds
    s_add_u32 m0, s40, 73728
    s_mov_b64 exec, 0xffffffff
    buffer_load_dwordx4 v12, s[12:15], s28 offen lds
    s_mov_b64 exec, -1
    s_add_u32 s28, s28, 221184
    s_and_b32 s53, s33, 3
    s_lshl_b32 s53, s53, 2
    s_add_u32 s53, s53, s38
    s_mul_i32 s53, s53, 24
    s_add_u32 s53, s53, 192
    v_lshrrev_b32 v5, 2, v2
    v_min_u32 v5, 11, v5
    v_add_u32 v5, s53, v5
    v_mul_u32_u24 v5, 3456, v5
    v_and_b32 v6, 3, v2
    v_lshl_add_u32 v5, v6, 7, v5
    s_and_b32 s53, s37, 0xffffff80
    buffer_load_dword v24, v5, s[12:15], s53 offen
    s_add_u32 s53, s53, 41472
    buffer_load_dword v24, v5, s[12:15], s53 offen
    s_lshr_b32 s53, s32, 2
    s_lshl_b32 s53, s53, 2
    s_add_u32 s53, s53, s38
    s_lshl_b32 s53, s53, 5
    v_and_b32 v5, 31, v2
    v_add_u32 v5, s53, v5
    v_mul_u32_u24 v6, 10923, v5
    v_lshrrev_b32 v6, 16, v6
    v_mul_u32_u24 v7, 6, v6
    v_sub_u32 v7, v5, v7
    v_mul_u32_u24 v6, 1152, v6
    v_lshl_add_u32 v6, v7, 7, v6
    s_mul_i32 s53, s33, 147456
    buffer_load_dword v24, v6, s[8:11], s53 offen offset:384
    s_waitcnt vmcnt(21)
    s_barrier
    s_waitcnt vmcnt(12)
    s_barrier
    s_add_u32 m0, s52, 104448
    s_add_u32 s53, s36, 0
    buffer_load_dwordx4 v28, s[8:11], s53 offen lds
    s_add_u32 m0, s52, 105472
    s_add_u32 s53, s36, 9216
    buffer_load_dwordx4 v29, s[8:11], s53 offen lds
    s_add_u32 m0, s52, 106496
    s_add_u32 s53, s36, 18432
    buffer_load_dwordx4 v28, s[8:11], s53 offen lds
    s_add_u32 m0, s52, 107520
    s_add_u32 s53, s36, 27648
    buffer_load_dwordx4 v29, s[8:11], s53 offen lds
    s_add_u32 s36, s36, 128
    s_add_u32 m0, s40, 104448
    s_nop 0
    buffer_load_dwordx4 v8, s[12:15], s28 offen offset:0 lds
    buffer_load_dwordx4 v9, s[12:15], s28 offen offset:1024 lds
    buffer_load_dwordx4 v10, s[12:15], s28 offen offset:2048 lds
    buffer_load_dwordx4 v11, s[12:15], s28 offen offset:3072 lds
    s_add_u32 m0, s40, 108544
    s_mov_b64 exec, 0xffffffff
    buffer_load_dwordx4 v12, s[12:15], s28 offen lds
    s_mov_b64 exec, -1
    s_add_u32 s28, s28, 221184
    s_waitcnt vmcnt(12)
    s_barrier
    s_add_u32 m0, s52, 0
    s_add_u32 s53, s36, 0
    buffer_load_dwordx4 v28, s[8:11], s53 offen lds
    s_add_u32 m0, s52, 1024
    s_add_u32 s53, s36, 9216
    buffer_load_dwordx4 v29, s[8:11], s53 offen lds
    s_add_u32 m0, s52, 2048
    s_add_u32 s53, s36, 18432
    buffer_load_dwordx4 v28, s[8:11], s53 offen lds
    s_add_u32 m0, s52, 3072
    s_add_u32 s53, s36, 27648
    buffer_load_dwordx4 v29, s[8:11], s53 offen lds
    s_add_u32 s36, s36, 128
    s_add_u32 m0, s40, 0
    s_nop 0
    buffer_load_dwordx4 v8, s[12:15], s28 offen offset:0 lds
    buffer_load_dwordx4 v9, s[12:15], s28 offen offset:1024 lds
    buffer_load_dwordx4 v10, s[12:15], s28 offen offset:2048 lds
    buffer_load_dwordx4 v11, s[12:15], s28 offen offset:3072 lds
    s_add_u32 m0, s40, 4096
    s_mov_b64 exec, 0xffffffff
    buffer_load_dwordx4 v12, s[12:15], s28 offen lds
    s_mov_b64 exec, -1
    s_add_u32 s28, s28, 221184
    s_waitcnt vmcnt(9)
    s_barrier
    s_add_u32 m0, s52, 34816
    s_add_u32 s53, s36, 0
    buffer_load_dwordx4 v28, s[8:11], s53 offen lds
    s_add_u32 m0, s52, 35840
    s_add_u32 s53, s36, 9216
    buffer_load_dwordx4 v29, s[8:11], s53 offen lds
    s_add_u32 m0, s52, 36864
    s_add_u32 s53, s36, 18432
    buffer_load_dwordx4 v28, s[8:11], s53 offen lds
    s_add_u32 m0, s52, 37888
    s_add_u32 s53, s36, 27648
    buffer_load_dwordx4 v29, s[8:11], s53 offen lds
    s_add_u32 s36, s36, 128
    s_add_u32 m0, s40, 34816
    s_nop 0
    buffer_load_dwordx4 v8, s[12:15], s28 offen offset:0 lds
    buffer_load_dwordx4 v9, s[12:15], s28 offen offset:1024 lds
    buffer_load_dwordx4 v10, s[12:15], s28 offen offset:2048 lds
    buffer_load_dwordx4 v11, s[12:15], s28 offen offset:3072 lds
    s_add_u32 m0, s40, 38912
    s_mov_b64 exec, 0xffffffff
    buffer_load_dwordx4 v12, s[12:15], s28 offen lds
    s_mov_b64 exec, -1
    s_add_u32 s28, s28, 221184
    s_waitcnt vmcnt(9)
    s_barrier
    s_add_u32 m0, s52, 69632
    s_add_u32 s53, s36, 0
    buffer_load_dwordx4 v28, s[8:11], s53 offen lds
    s_add_u32 m0, s52, 70656
    s_add_u32 s53, s36, 9216
    buffer_load_dwordx4 v29, s[8:11], s53 offen lds
    s_add_u32 m0, s52, 71680
    s_add_u32 s53, s36, 18432
    buffer_load_dwordx4 v28, s[8:11], s53 offen lds
    s_add_u32 m0, s52, 72704
    s_add_u32 s53, s36, 27648
    buffer_load_dwordx4 v29, s[8:11], s53 offen lds
    s_add_u32 s36, s36, 128
    s_add_u32 m0, s40, 69632
    s_nop 0
    buffer_load_dwordx4 v8, s[12:15], s28 offen offset:0 lds
    buffer_load_dwordx4 v9, s[12:15], s28 offen offset:1024 lds
    buffer_load_dwordx4 v10, s[12:15], s28 offen offset:2048 lds
    buffer_load_dwordx4 v11, s[12:15], s28 offen offset:3072 lds
    s_add_u32 m0, s40, 73728
    s_mov_b64 exec, 0xffffffff
    buffer_load_dwordx4 v12, s[12:15], s28 offen lds
    s_mov_b64 exec, -1
    s_add_u32 s28, s28, 221184
    s_waitcnt vmcnt(9)
    s_barrier
    s_add_u32 m0, s52, 104448
    s_add_u32 s53, s36, 0
    buffer_load_dwordx4 v28, s[8:11], s53 offen lds
    s_add_u32 m0, s52, 105472
    s_add_u32 s53, s36, 9216
    buffer_load_dwordx4 v29, s[8:11], s53 offen lds
    s_add_u32 m0, s52, 106496
    s_add_u32 s53, s36, 18432
    buffer_load_dwordx4 v28, s[8:11], s53 offen lds
    s_add_u32 m0, s52, 107520
    s_add_u32 s53, s36, 27648
    buffer_load_dwordx4 v29, s[8:11], s53 offen lds
    s_add_u32 s36, s36, 128
    s_add_u32 m0, s40, 104448
    s_nop 0
    buffer_load_dwordx4 v8, s[12:15], s28 offen offset:0 lds
    buffer_load_dwordx4 v9, s[12:15], s28 offen offset:1024 lds
    buffer_load_dwordx4 v10, s[12:15], s28 offen offset:2048 lds
    buffer_load_dwordx4 v11, s[12:15], s28 offen offset:3072 lds
    s_add_u32 m0, s40, 108544
    s_mov_b64 exec, 0xffffffff
    buffer_load_dwordx4 v12, s[12:15], s28 offen lds
    s_mov_b64 exec, -1
    s_add_u32 s28, s28, 221184
    s_waitcnt vmcnt(9)
    s_barrier
    s_add_u32 m0, s52, 0
    s_add_u32 s53, s36, 0
    buffer_load_dwordx4 v28, s[8:11], s53 offen lds
    s_add_u32 m0, s52, 1024
    s_add_u32 s53, s36, 9216
    buffer_load_dwordx4 v29, s[8:11], s53 offen lds
    s_add_u32 m0, s52, 2048
    s_add_u32 s53, s36, 18432
    buffer_load_dwordx4 v28, s[8:11], s53 offen lds
    s_add_u32 m0, s52, 3072
    s_add_u32 s53, s36, 27648
    buffer_load_dwordx4 v29, s[8:11], s53 offen lds
    s_add_u32 s36, s36, 128
    s_add_u32 m0, s40, 0
    s_nop 0
    buffer_load_dwordx4 v8, s[12:15], s28 offen offset:0 lds
    buffer_load_dwordx4 v9, s[12:15], s28 offen offset:1024 lds
    buffer_load_dwordx4 v10, s[12:15], s28 offen offset:2048 lds
    buffer_load_dwordx4 v11, s[12:15], s28 offen offset:3072 lds
    s_add_u32 m0, s40, 4096
    s_mov_b64 exec, 0xffffffff
    buffer_load_dwordx4 v12, s[12:15], s28 offen lds
    s_mov_b64 exec, -1
    s_add_u32 s28, s28, 221184
    s_mov_b32 s20, s68
    s_and_b32 s21, s69, 0xffff
    s_mov_b32 s22, 663552
    s_mov_b32 s23, 0x20000
    s_lshl_b32 s53, s2, 2
    s_add_u32 s53, s53, s38
    s_lshl_b32 s53, s53, 10
    v_lshlrev_b32 v5, 4, v2
    buffer_load_dwordx4 v[20:23], v5, s[20:23], s53 offen
    s_waitcnt vmcnt(9)
    s_barrier
    s_waitcnt vmcnt(0)
    s_barrier
    s_endpgm
L_qkv_kernel_comp:
    s_add_u32 s16, s84, 0
    s_addc_u32 s17, s85, 0
    s_and_b32 s17, s17, 0xffff
    s_mov_b32 s18, 7208960
    s_mov_b32 s19, 0x20000
    v_lshrrev_b32 v5, 1, v3
    v_and_b32 v5, 7, v5
    v_xor_b32 v6, v4, v5
    v_lshrrev_b32 v7, 3, v3
    v_lshlrev_b32 v7, 10, v7
    v_and_b32 v1, 7, v3
    v_lshl_add_u32 v7, v1, 7, v7
    s_lshl_b32 s52, s38, 12
    s_add_u32 s52, s52, 18432
    v_add_u32 v7, s52, v7
    v_lshl_add_u32 v16, v6, 4, v7
    v_xor_b32 v6, 4, v6
    v_lshl_add_u32 v17, v6, 4, v7
    v_add_u32 v18, 34816, v16
    v_add_u32 v19, 34816, v17
    v_add_u32 v20, 69632, v16
    v_add_u32 v21, 69632, v17
    v_add_u32 v22, 104448, v16
    v_add_u32 v23, 104448, v17
    v_lshrrev_b32 v5, 2, v2
    v_and_b32 v5, 3, v5
    v_and_b32 v6, 1, v4
    v_lshl_add_u32 v5, v6, 2, v5
    v_lshrrev_b32 v6, 1, v4
    v_lshl_add_u32 v5, v6, 4, v5
    v_mul_u32_u24 v5, 288, v5
    v_and_b32 v6, 3, v2
    v_lshl_add_u32 v8, v6, 3, v5
    v_add_u32 v9, 34816, v8
    v_add_u32 v10, 69632, v8
    v_add_u32 v11, 104448, v8
    s_lshl_b32 s53, s38, 5
    v_add_u32 v12, s53, v8
    v_add_u32 v13, s53, v9
    v_add_u32 v14, s53, v10
    v_add_u32 v15, s53, v11
    v_accvgpr_write_b32 a0, 0
    v_accvgpr_write_b32 a1, 0
    v_accvgpr_write_b32 a2, 0
    v_accvgpr_write_b32 a3, 0
    v_accvgpr_write_b32 a4, 0
    v_accvgpr_write_b32 a5, 0
    v_accvgpr_write_b32 a6, 0
    v_accvgpr_write_b32 a7, 0
    v_accvgpr_write_b32 a8, 0
    v_accvgpr_write_b32 a9, 0
    v_accvgpr_write_b32 a10, 0
    v_accvgpr_write_b32 a11, 0
    v_accvgpr_write_b32 a12, 0
    v_accvgpr_write_b32 a13, 0
    v_accvgpr_write_b32 a14, 0
    v_accvgpr_write_b32 a15, 0
    v_accvgpr_write_b32 a16, 0
    v_accvgpr_write_b32 a17, 0
    v_accvgpr_write_b32 a18, 0
    v_accvgpr_write_b32 a19, 0
    v_accvgpr_write_b32 a20, 0
    v_accvgpr_write_b32 a21, 0
    v_accvgpr_write_b32 a22, 0
    v_accvgpr_write_b32 a23, 0
    v_accvgpr_write_b32 a24, 0
    v_accvgpr_write_b32 a25, 0
    v_accvgpr_write_b32 a26, 0
    v_accvgpr_write_b32 a27, 0
    v_accvgpr_write_b32 a28, 0
    v_accvgpr_write_b32 a29, 0
    v_accvgpr_write_b32 a30, 0
    v_accvgpr_write_b32 a31, 0
    v_accvgpr_write_b32 a32, 0
    v_accvgpr_write_b32 a33, 0
    v_accvgpr_write_b32 a34, 0
    v_accvgpr_write_b32 a35, 0
    v_accvgpr_write_b32 a36, 0
    v_accvgpr_write_b32 a37, 0
    v_accvgpr_write_b32 a38, 0
    v_accvgpr_write_b32 a39, 0
    v_accvgpr_write_b32 a40, 0
    v_accvgpr_write_b32 a41, 0
    v_accvgpr_write_b32 a42, 0
    v_accvgpr_write_b32 a43, 0
    v_accvgpr_write_b32 a44, 0
    v_accvgpr_write_b32 a45, 0
    v_accvgpr_write_b32 a46, 0
    v_accvgpr_write_b32 a47, 0
    v_accvgpr_write_b32 a48, 0
    v_accvgpr_write_b32 a49, 0
    v_accvgpr_write_b32 a50, 0
    v_accvgpr_write_b32 a51, 0
    v_accvgpr_write_b32 a52, 0
    v_accvgpr_write_b32 a53, 0
    v_accvgpr_write_b32 a54, 0
    v_accvgpr_write_b32 a55, 0
    v_accvgpr_write_b32 a56, 0
    v_accvgpr_write_b32 a57, 0
    v_accvgpr_write_b32 a58, 0
    v_accvgpr_write_b32 a59, 0
    v_accvgpr_write_b32 a60, 0
    v_accvgpr_write_b32 a61, 0
    v_accvgpr_write_b32 a62, 0
    v_accvgpr_write_b32 a63, 0
    v_accvgpr_write_b32 a64, 0
    v_accvgpr_write_b32 a65, 0
    v_accvgpr_write_b32 a66, 0
    v_accvgpr_write_b32 a67, 0
    v_accvgpr_write_b32 a68, 0
    v_accvgpr_write_b32 a69, 0
    v_accvgpr_write_b32 a70, 0
    v_accvgpr_write_b32 a71, 0
    v_accvgpr_write_b32 a156, 0
    v_accvgpr_write_b32 a157, 0
    v_accvgpr_write_b32 a158, 0
    v_accvgpr_write_b32 a159, 0
    v_accvgpr_write_b32 a160, 0
    v_accvgpr_write_b32 a161, 0
    v_accvgpr_write_b32 a162, 0
    v_accvgpr_write_b32 a163, 0
    v_accvgpr_write_b32 a164, 0
    v_accvgpr_write_b32 a165, 0
    v_accvgpr_write_b32 a166, 0
    v_accvgpr_write_b32 a167, 0
    s_mov_b32 s41, 0x3f803f80
    v_mov_b32 v5, s41
    v_accvgpr_write_b32 a168, v5
    v_accvgpr_write_b32 a169, v5
    v_accvgpr_write_b32 a170, v5
    v_accvgpr_write_b32 a171, v5
    v_mov_b32 v48, 0
    v_mov_b32 v49, 0
    v_mov_b32 v50, 0
    v_mov_b32 v51, 0
    v_mov_b32 v52, 0
    v_mov_b32 v53, 0
    v_mov_b32 v54, 0
    v_mov_b32 v55, 0
    v_mov_b32 v56, 0
    v_mov_b32 v57, 0
    v_mov_b32 v58, 0
    v_mov_b32 v59, 0
    v_mov_b32 v60, 0
    v_mov_b32 v61, 0
    v_mov_b32 v62, 0
    v_mov_b32 v63, 0
    s_lshl_b32 s42, s33, 2
    s_add_u32 s42, s42, s38
    s_and_b32 s43, s34, 3
    s_lshl_b32 s43, s43, 3
    s_lshr_b32 s44, s42, 4
    s_mul_i32 s44, s44, 37888
    s_and_b32 s45, s42, 15
    s_mul_i32 s52, s38, 10240
    s_cmp_ge_u32 s34, 8
    s_cbranch_scc1 L_qkv_kernel_v
    s_cmp_ge_u32 s34, 4
    s_cbranch_scc1 L_qkv_kernel_k
    s_lshl_b32 s46, s42, 10
    s_mov_b32 s47, 65536
    s_lshl_b32 s48, s42, 7
    s_add_u32 s48, s48, 2097152
    s_mov_b32 s49, 8192
    s_mov_b32 s50, 0x3eae1a93
    s_branch L_qkv_kernel_qk
L_qkv_kernel_k:
    s_lshl_b32 s46, s45, 10
    s_add_u32 s46, s46, s44
    s_add_u32 s46, s46, 2359296
    s_mov_b32 s47, 151552
    s_lshl_b32 s48, s45, 7
    s_add_u32 s48, s48, s44
    s_add_u32 s48, s48, 2375680
    s_mov_b32 s49, 151552
    s_mov_b32 s50, 1.0
L_qkv_kernel_qk:
    s_mul_i32 s51, s43, s47
    s_add_u32 s46, s46, s51
    s_mul_i32 s51, s43, s49
    s_add_u32 s48, s48, s51
    v_lshl_add_u32 v5, v3, 4, s52
    s_add_u32 s53, s52, 8192
    v_lshl_add_u32 v6, v3, 2, s53
    v_lshlrev_b32 v7, 2, v4
    v_add_u32 v32, 0, v7
    v_mul_u32_u24 v33, 3641, v32
    v_lshrrev_b32 v33, 16, v33
    v_mul_u32_u24 v34, 18, v33
    v_sub_u32 v32, v32, v34
    v_lshl_add_u32 v35, v33, 10, v5
    v_lshrrev_b32 v34, 3, v32
    v_lshl_add_u32 v35, v34, 9, v35
    v_and_b32 v34, 7, v32
    v_lshl_add_u32 v35, v34, 1, v35
    v_lshl_add_u32 v34, v33, 7, v6
    v_cmp_lt_u32 vcc, 15, v32
    v_add_u32 v36, 256, v35
    v_add_u32 v33, 64, v34
    v_cndmask_b32 v35, v35, v34, vcc
    v_cndmask_b32 v36, v36, v33, vcc
    v_lshl_or_b32 v64, v36, 16, v35
    v_add_u32 v32, 2, v7
    v_mul_u32_u24 v33, 3641, v32
    v_lshrrev_b32 v33, 16, v33
    v_mul_u32_u24 v34, 18, v33
    v_sub_u32 v32, v32, v34
    v_lshl_add_u32 v35, v33, 10, v5
    v_lshrrev_b32 v34, 3, v32
    v_lshl_add_u32 v35, v34, 9, v35
    v_and_b32 v34, 7, v32
    v_lshl_add_u32 v35, v34, 1, v35
    v_lshl_add_u32 v34, v33, 7, v6
    v_cmp_lt_u32 vcc, 15, v32
    v_add_u32 v36, 256, v35
    v_add_u32 v33, 64, v34
    v_cndmask_b32 v35, v35, v34, vcc
    v_cndmask_b32 v36, v36, v33, vcc
    v_lshl_or_b32 v65, v36, 16, v35
    v_add_u32 v32, 16, v7
    v_mul_u32_u24 v33, 3641, v32
    v_lshrrev_b32 v33, 16, v33
    v_mul_u32_u24 v34, 18, v33
    v_sub_u32 v32, v32, v34
    v_lshl_add_u32 v35, v33, 10, v5
    v_lshrrev_b32 v34, 3, v32
    v_lshl_add_u32 v35, v34, 9, v35
    v_and_b32 v34, 7, v32
    v_lshl_add_u32 v35, v34, 1, v35
    v_lshl_add_u32 v34, v33, 7, v6
    v_cmp_lt_u32 vcc, 15, v32
    v_add_u32 v36, 256, v35
    v_add_u32 v33, 64, v34
    v_cndmask_b32 v35, v35, v34, vcc
    v_cndmask_b32 v36, v36, v33, vcc
    v_lshl_or_b32 v66, v36, 16, v35
    v_add_u32 v32, 18, v7
    v_mul_u32_u24 v33, 3641, v32
    v_lshrrev_b32 v33, 16, v33
    v_mul_u32_u24 v34, 18, v33
    v_sub_u32 v32, v32, v34
    v_lshl_add_u32 v35, v33, 10, v5
    v_lshrrev_b32 v34, 3, v32
    v_lshl_add_u32 v35, v34, 9, v35
    v_and_b32 v34, 7, v32
    v_lshl_add_u32 v35, v34, 1, v35
    v_lshl_add_u32 v34, v33, 7, v6
    v_cmp_lt_u32 vcc, 15, v32
    v_add_u32 v36, 256, v35
    v_add_u32 v33, 64, v34
    v_cndmask_b32 v35, v35, v34, vcc
    v_cndmask_b32 v36, v36, v33, vcc
    v_lshl_or_b32 v67, v36, 16, v35
    v_add_u32 v32, 32, v7
    v_mul_u32_u24 v33, 3641, v32
    v_lshrrev_b32 v33, 16, v33
    v_mul_u32_u24 v34, 18, v33
    v_sub_u32 v32, v32, v34
    v_lshl_add_u32 v35, v33, 10, v5
    v_lshrrev_b32 v34, 3, v32
    v_lshl_add_u32 v35, v34, 9, v35
    v_and_b32 v34, 7, v32
    v_lshl_add_u32 v35, v34, 1, v35
    v_lshl_add_u32 v34, v33, 7, v6
    v_cmp_lt_u32 vcc, 15, v32
    v_add_u32 v36, 256, v35
    v_add_u32 v33, 64, v34
    v_cndmask_b32 v35, v35, v34, vcc
    v_cndmask_b32 v36, v36, v33, vcc
    v_lshl_or_b32 v68, v36, 16, v35
    v_add_u32 v32, 34, v7
    v_mul_u32_u24 v33, 3641, v32
    v_lshrrev_b32 v33, 16, v33
    v_mul_u32_u24 v34, 18, v33
    v_sub_u32 v32, v32, v34
    v_lshl_add_u32 v35, v33, 10, v5
    v_lshrrev_b32 v34, 3, v32
    v_lshl_add_u32 v35, v34, 9, v35
    v_and_b32 v34, 7, v32
    v_lshl_add_u32 v35, v34, 1, v35
    v_lshl_add_u32 v34, v33, 7, v6
    v_cmp_lt_u32 vcc, 15, v32
    v_add_u32 v36, 256, v35
    v_add_u32 v33, 64, v34
    v_cndmask_b32 v35, v35, v34, vcc
    v_cndmask_b32 v36, v36, v33, vcc
    v_lshl_or_b32 v69, v36, 16, v35
    v_add_u32 v32, 48, v7
    v_mul_u32_u24 v33, 3641, v32
    v_lshrrev_b32 v33, 16, v33
    v_mul_u32_u24 v34, 18, v33
    v_sub_u32 v32, v32, v34
    v_lshl_add_u32 v35, v33, 10, v5
    v_lshrrev_b32 v34, 3, v32
    v_lshl_add_u32 v35, v34, 9, v35
    v_and_b32 v34, 7, v32
    v_lshl_add_u32 v35, v34, 1, v35
    v_lshl_add_u32 v34, v33, 7, v6
    v_cmp_lt_u32 vcc, 15, v32
    v_add_u32 v36, 256, v35
    v_add_u32 v33, 64, v34
    v_cndmask_b32 v35, v35, v34, vcc
    v_cndmask_b32 v36, v36, v33, vcc
    v_lshl_or_b32 v70, v36, 16, v35
    v_add_u32 v32, 50, v7
    v_mul_u32_u24 v33, 3641, v32
    v_lshrrev_b32 v33, 16, v33
    v_mul_u32_u24 v34, 18, v33
    v_sub_u32 v32, v32, v34
    v_lshl_add_u32 v35, v33, 10, v5
    v_lshrrev_b32 v34, 3, v32
    v_lshl_add_u32 v35, v34, 9, v35
    v_and_b32 v34, 7, v32
    v_lshl_add_u32 v35, v34, 1, v35
    v_lshl_add_u32 v34, v33, 7, v6
    v_cmp_lt_u32 vcc, 15, v32
    v_add_u32 v36, 256, v35
    v_add_u32 v33, 64, v34
    v_cndmask_b32 v35, v35, v34, vcc
    v_cndmask_b32 v36, v36, v33, vcc
    v_lshl_or_b32 v71, v36, 16, v35
    v_add_u32 v32, 64, v7
    v_mul_u32_u24 v33, 3641, v32
    v_lshrrev_b32 v33, 16, v33
    v_mul_u32_u24 v34, 18, v33
    v_sub_u32 v32, v32, v34
    v_lshl_add_u32 v35, v33, 10, v5
    v_lshrrev_b32 v34, 3, v32
    v_lshl_add_u32 v35, v34, 9, v35
    v_and_b32 v34, 7, v32
    v_lshl_add_u32 v35, v34, 1, v35
    v_lshl_add_u32 v34, v33, 7, v6
    v_cmp_lt_u32 vcc, 15, v32
    v_add_u32 v36, 256, v35
    v_add_u32 v33, 64, v34
    v_cndmask_b32 v35, v35, v34, vcc
    v_cndmask_b32 v36, v36, v33, vcc
    v_lshl_or_b32 v72, v36, 16, v35
    v_add_u32 v32, 66, v7
    v_mul_u32_u24 v33, 3641, v32
    v_lshrrev_b32 v33, 16, v33
    v_mul_u32_u24 v34, 18, v33
    v_sub_u32 v32, v32, v34
    v_lshl_add_u32 v35, v33, 10, v5
    v_lshrrev_b32 v34, 3, v32
    v_lshl_add_u32 v35, v34, 9, v35
    v_and_b32 v34, 7, v32
    v_lshl_add_u32 v35, v34, 1, v35
    v_lshl_add_u32 v34, v33, 7, v6
    v_cmp_lt_u32 vcc, 15, v32
    v_add_u32 v36, 256, v35
    v_add_u32 v33, 64, v34
    v_cndmask_b32 v35, v35, v34, vcc
    v_cndmask_b32 v36, v36, v33, vcc
    v_lshl_or_b32 v73, v36, 16, v35
    v_add_u32 v32, 80, v7
    v_mul_u32_u24 v33, 3641, v32
    v_lshrrev_b32 v33, 16, v33
    v_mul_u32_u24 v34, 18, v33
    v_sub_u32 v32, v32, v34
    v_lshl_add_u32 v35, v33, 10, v5
    v_lshrrev_b32 v34, 3, v32
    v_lshl_add_u32 v35, v34, 9, v35
    v_and_b32 v34, 7, v32
    v_lshl_add_u32 v35, v34, 1, v35
    v_lshl_add_u32 v34, v33, 7, v6
    v_cmp_lt_u32 vcc, 15, v32
    v_add_u32 v36, 256, v35
    v_add_u32 v33, 64, v34
    v_cndmask_b32 v35, v35, v34, vcc
    v_cndmask_b32 v36, v36, v33, vcc
    v_lshl_or_b32 v74, v36, 16, v35
    v_add_u32 v32, 82, v7
    v_mul_u32_u24 v33, 3641, v32
    v_lshrrev_b32 v33, 16, v33
    v_mul_u32_u24 v34, 18, v33
    v_sub_u32 v32, v32, v34
    v_lshl_add_u32 v35, v33, 10, v5
    v_lshrrev_b32 v34, 3, v32
    v_lshl_add_u32 v35, v34, 9, v35
    v_and_b32 v34, 7, v32
    v_lshl_add_u32 v35, v34, 1, v35
    v_lshl_add_u32 v34, v33, 7, v6
    v_cmp_lt_u32 vcc, 15, v32
    v_add_u32 v36, 256, v35
    v_add_u32 v33, 64, v34
    v_cndmask_b32 v35, v35, v34, vcc
    v_cndmask_b32 v36, v36, v33, vcc
    v_lshl_or_b32 v75, v36, 16, v35
    v_add_u32 v32, 96, v7
    v_mul_u32_u24 v33, 3641, v32
    v_lshrrev_b32 v33, 16, v33
    v_mul_u32_u24 v34, 18, v33
    v_sub_u32 v32, v32, v34
    v_lshl_add_u32 v35, v33, 10, v5
    v_lshrrev_b32 v34, 3, v32
    v_lshl_add_u32 v35, v34, 9, v35
    v_and_b32 v34, 7, v32
    v_lshl_add_u32 v35, v34, 1, v35
    v_lshl_add_u32 v34, v33, 7, v6
    v_cmp_lt_u32 vcc, 15, v32
    v_add_u32 v36, 256, v35
    v_add_u32 v33, 64, v34
    v_cndmask_b32 v35, v35, v34, vcc
    v_cndmask_b32 v36, v36, v33, vcc
    v_lshl_or_b32 v76, v36, 16, v35
    v_add_u32 v32, 98, v7
    v_mul_u32_u24 v33, 3641, v32
    v_lshrrev_b32 v33, 16, v33
    v_mul_u32_u24 v34, 18, v33
    v_sub_u32 v32, v32, v34
    v_lshl_add_u32 v35, v33, 10, v5
    v_lshrrev_b32 v34, 3, v32
    v_lshl_add_u32 v35, v34, 9, v35
    v_and_b32 v34, 7, v32
    v_lshl_add_u32 v35, v34, 1, v35
    v_lshl_add_u32 v34, v33, 7, v6
    v_cmp_lt_u32 vcc, 15, v32
    v_add_u32 v36, 256, v35
    v_add_u32 v33, 64, v34
    v_cndmask_b32 v35, v35, v34, vcc
    v_cndmask_b32 v36, v36, v33, vcc
    v_lshl_or_b32 v77, v36, 16, v35
    v_add_u32 v32, 112, v7
    v_mul_u32_u24 v33, 3641, v32
    v_lshrrev_b32 v33, 16, v33
    v_mul_u32_u24 v34, 18, v33
    v_sub_u32 v32, v32, v34
    v_lshl_add_u32 v35, v33, 10, v5
    v_lshrrev_b32 v34, 3, v32
    v_lshl_add_u32 v35, v34, 9, v35
    v_and_b32 v34, 7, v32
    v_lshl_add_u32 v35, v34, 1, v35
    v_lshl_add_u32 v34, v33, 7, v6
    v_cmp_lt_u32 vcc, 15, v32
    v_add_u32 v36, 256, v35
    v_add_u32 v33, 64, v34
    v_cndmask_b32 v35, v35, v34, vcc
    v_cndmask_b32 v36, v36, v33, vcc
    v_lshl_or_b32 v78, v36, 16, v35
    v_add_u32 v32, 114, v7
    v_mul_u32_u24 v33, 3641, v32
    v_lshrrev_b32 v33, 16, v33
    v_mul_u32_u24 v34, 18, v33
    v_sub_u32 v32, v32, v34
    v_lshl_add_u32 v35, v33, 10, v5
    v_lshrrev_b32 v34, 3, v32
    v_lshl_add_u32 v35, v34, 9, v35
    v_and_b32 v34, 7, v32
    v_lshl_add_u32 v35, v34, 1, v35
    v_lshl_add_u32 v34, v33, 7, v6
    v_cmp_lt_u32 vcc, 15, v32
    v_add_u32 v36, 256, v35
    v_add_u32 v33, 64, v34
    v_cndmask_b32 v35, v35, v34, vcc
    v_cndmask_b32 v36, v36, v33, vcc
    v_lshl_or_b32 v79, v36, 16, v35
    v_add_u32 v32, 128, v7
    v_mul_u32_u24 v33, 3641, v32
    v_lshrrev_b32 v33, 16, v33
    v_mul_u32_u24 v34, 18, v33
    v_sub_u32 v32, v32, v34
    v_lshl_add_u32 v35, v33, 10, v5
    v_lshrrev_b32 v34, 3, v32
    v_lshl_add_u32 v35, v34, 9, v35
    v_and_b32 v34, 7, v32
    v_lshl_add_u32 v35, v34, 1, v35
    v_lshl_add_u32 v34, v33, 7, v6
    v_cmp_lt_u32 vcc, 15, v32
    v_add_u32 v36, 256, v35
    v_add_u32 v33, 64, v34
    v_cndmask_b32 v35, v35, v34, vcc
    v_cndmask_b32 v36, v36, v33, vcc
    v_lshl_or_b32 v80, v36, 16, v35
    v_add_u32 v32, 130, v7
    v_mul_u32_u24 v33, 3641, v32
    v_lshrrev_b32 v33, 16, v33
    v_mul_u32_u24 v34, 18, v33
    v_sub_u32 v32, v32, v34
    v_lshl_add_u32 v35, v33, 10, v5
    v_lshrrev_b32 v34, 3, v32
    v_lshl_add_u32 v35, v34, 9, v35
    v_and_b32 v34, 7, v32
    v_lshl_add_u32 v35, v34, 1, v35
    v_lshl_add_u32 v34, v33, 7, v6
    v_cmp_lt_u32 vcc, 15, v32
    v_add_u32 v36, 256, v35
    v_add_u32 v33, 64, v34
    v_cndmask_b32 v35, v35, v34, vcc
    v_cndmask_b32 v36, v36, v33, vcc
    v_lshl_or_b32 v81, v36, 16, v35
    s_barrier
    ds_read_b64_tr_b16 a[144:145], v12 offset:0
    ds_read_b64_tr_b16 a[146:147], v12 offset:2304
    ds_read_b64_tr_b16 a[148:149], v12 offset:128
    ds_read_b64_tr_b16 a[150:151], v12 offset:2432
    ds_read_b64_tr_b16 a[152:153], v8 offset:256
    ds_read_b64_tr_b16 a[154:155], v8 offset:2560
    ds_read_b128 v[32:35], v16 offset:0
    ds_read_b128 v[36:39], v16 offset:2048
    ds_read_b64_tr_b16 a[72:73], v8 offset:0
    ds_read_b64_tr_b16 a[74:75], v8 offset:2304
    ds_read_b64_tr_b16 a[76:77], v8 offset:32
    ds_read_b64_tr_b16 a[78:79], v8 offset:2336
    ds_read_b64_tr_b16 a[80:81], v8 offset:64
    ds_read_b64_tr_b16 a[82:83], v8 offset:2368
    ds_read_b64_tr_b16 a[84:85], v8 offset:96
    ds_read_b64_tr_b16 a[86:87], v8 offset:2400
    ds_read_b64_tr_b16 a[88:89], v8 offset:128
    ds_read_b64_tr_b16 a[90:91], v8 offset:2432
    ds_read_b64_tr_b16 a[92:93], v8 offset:160
    ds_read_b64_tr_b16 a[94:95], v8 offset:2464
    ds_read_b64_tr_b16 a[96:97], v8 offset:192
    ds_read_b64_tr_b16 a[98:99], v8 offset:2496
    ds_read_b64_tr_b16 a[100:101], v8 offset:224
    ds_read_b64_tr_b16 a[102:103], v8 offset:2528
    ds_read_b64_tr_b16 a[104:105], v8 offset:256
    ds_read_b64_tr_b16 a[106:107], v8 offset:2560
    s_waitcnt lgkmcnt(15)
    v_mfma_f32_16x16x32_bf16 a[156:159], a[144:147], a[168:171], a[156:159]
    v_mfma_f32_16x16x32_bf16 a[160:163], a[148:151], a[168:171], a[160:163]
    v_mfma_f32_16x16x32_bf16 a[164:167], a[152:155], a[168:171], a[164:167]
    v_mfma_f32_16x16x32_bf16 v[48:51], a[168:171], v[32:35], v[48:51]
    ds_read_b128 v[40:43], v17 offset:0
    ds_read_b128 v[44:47], v17 offset:2048
    v_mfma_f32_16x16x32_bf16 v[56:59], v[32:35], v[32:35], v[56:59]
    ds_read_b64_tr_b16 a[108:109], v8 offset:9216
    ds_read_b64_tr_b16 a[110:111], v8 offset:11520
    v_mfma_f32_16x16x32_bf16 v[52:55], a[168:171], v[36:39], v[52:55]
    ds_read_b64_tr_b16 a[112:113], v8 offset:9248
    ds_read_b64_tr_b16 a[114:115], v8 offset:11552
    v_mfma_f32_16x16x32_bf16 v[60:63], v[36:39], v[36:39], v[60:63]
    ds_read_b64_tr_b16 a[116:117], v8 offset:9280
    ds_read_b64_tr_b16 a[118:119], v8 offset:11584
    v_mfma_f32_16x16x32_bf16 a[0:3], a[72:75], v[32:35], a[0:3]
    ds_read_b64_tr_b16 a[120:121], v8 offset:9312
    v_mfma_f32_16x16x32_bf16 a[4:7], a[72:75], v[36:39], a[4:7]
    ds_read_b64_tr_b16 a[122:123], v8 offset:11616
    s_waitcnt lgkmcnt(15)
    v_mfma_f32_16x16x32_bf16 a[8:11], a[76:79], v[32:35], a[8:11]
    ds_read_b64_tr_b16 a[124:125], v8 offset:9344
    v_mfma_f32_16x16x32_bf16 a[12:15], a[76:79], v[36:39], a[12:15]
    ds_read_b64_tr_b16 a[126:127], v8 offset:11648
    v_mfma_f32_16x16x32_bf16 a[16:19], a[80:83], v[32:35], a[16:19]
    ds_read_b64_tr_b16 a[128:129], v8 offset:9376
    v_mfma_f32_16x16x32_bf16 a[20:23], a[80:83], v[36:39], a[20:23]
    ds_read_b64_tr_b16 a[130:131], v8 offset:11680
    v_mfma_f32_16x16x32_bf16 a[24:27], a[84:87], v[32:35], a[24:27]
    ds_read_b64_tr_b16 a[132:133], v8 offset:9408
    v_mfma_f32_16x16x32_bf16 a[28:31], a[84:87], v[36:39], a[28:31]
    ds_read_b64_tr_b16 a[134:135], v8 offset:11712
    v_mfma_f32_16x16x32_bf16 a[32:35], a[88:91], v[32:35], a[32:35]
    ds_read_b64_tr_b16 a[136:137], v8 offset:9440
    v_mfma_f32_16x16x32_bf16 a[36:39], a[88:91], v[36:39], a[36:39]
    ds_read_b64_tr_b16 a[138:139], v8 offset:11744
    v_mfma_f32_16x16x32_bf16 a[40:43], a[92:95], v[32:35], a[40:43]
    ds_read_b64_tr_b16 a[140:141], v8 offset:9472
    v_mfma_f32_16x16x32_bf16 a[44:47], a[92:95], v[36:39], a[44:47]
    ds_read_b64_tr_b16 a[142:143], v8 offset:11776
    s_waitcnt lgkmcnt(15)
    v_mfma_f32_16x16x32_bf16 a[48:51], a[96:99], v[32:35], a[48:51]
    ds_read_b64_tr_b16 a[144:145], v12 offset:9216
    v_mfma_f32_16x16x32_bf16 a[52:55], a[96:99], v[36:39], a[52:55]
    ds_read_b64_tr_b16 a[146:147], v12 offset:11520
    v_mfma_f32_16x16x32_bf16 a[56:59], a[100:103], v[32:35], a[56:59]
    ds_read_b64_tr_b16 a[148:149], v12 offset:9344
    v_mfma_f32_16x16x32_bf16 a[60:63], a[100:103], v[36:39], a[60:63]
    ds_read_b64_tr_b16 a[150:151], v12 offset:11648
    v_mfma_f32_16x16x32_bf16 a[64:67], a[104:107], v[32:35], a[64:67]
    ds_read_b64_tr_b16 a[152:153], v8 offset:9472
    v_mfma_f32_16x16x32_bf16 a[68:71], a[104:107], v[36:39], a[68:71]
    ds_read_b64_tr_b16 a[154:155], v8 offset:11776
    s_barrier
    s_waitcnt lgkmcnt(4)
    v_mfma_f32_16x16x32_bf16 a[156:159], a[144:147], a[168:171], a[156:159]
    s_waitcnt lgkmcnt(2)
    v_mfma_f32_16x16x32_bf16 a[160:163], a[148:151], a[168:171], a[160:163]
    s_waitcnt lgkmcnt(0)
    v_mfma_f32_16x16x32_bf16 a[164:167], a[152:155], a[168:171], a[164:167]
    v_mfma_f32_16x16x32_bf16 v[48:51], a[168:171], v[40:43], v[48:51]
    ds_read_b128 v[32:35], v18 offset:0
    ds_read_b128 v[36:39], v18 offset:2048
    v_mfma_f32_16x16x32_bf16 v[56:59], v[40:43], v[40:43], v[56:59]
    ds_read_b64_tr_b16 a[72:73], v9 offset:0
    ds_read_b64_tr_b16 a[74:75], v9 offset:2304
    v_mfma_f32_16x16x32_bf16 v[52:55], a[168:171], v[44:47], v[52:55]
    ds_read_b64_tr_b16 a[76:77], v9 offset:32
    ds_read_b64_tr_b16 a[78:79], v9 offset:2336
    v_mfma_f32_16x16x32_bf16 v[60:63], v[44:47], v[44:47], v[60:63]
    ds_read_b64_tr_b16 a[80:81], v9 offset:64
    ds_read_b64_tr_b16 a[82:83], v9 offset:2368
    v_mfma_f32_16x16x32_bf16 a[0:3], a[108:111], v[40:43], a[0:3]
    ds_read_b64_tr_b16 a[84:85], v9 offset:96
    v_mfma_f32_16x16x32_bf16 a[4:7], a[108:111], v[44:47], a[4:7]
    ds_read_b64_tr_b16 a[86:87], v9 offset:2400
    v_mfma_f32_16x16x32_bf16 a[8:11], a[112:115], v[40:43], a[8:11]
    ds_read_b64_tr_b16 a[88:89], v9 offset:128
    v_mfma_f32_16x16x32_bf16 a[12:15], a[112:115], v[44:47], a[12:15]
    ds_read_b64_tr_b16 a[90:91], v9 offset:2432
    v_mfma_f32_16x16x32_bf16 a[16:19], a[116:119], v[40:43], a[16:19]
    ds_read_b64_tr_b16 a[92:93], v9 offset:160
    v_mfma_f32_16x16x32_bf16 a[20:23], a[116:119], v[44:47], a[20:23]
    ds_read_b64_tr_b16 a[94:95], v9 offset:2464
    v_mfma_f32_16x16x32_bf16 a[24:27], a[120:123], v[40:43], a[24:27]
    ds_read_b64_tr_b16 a[96:97], v9 offset:192
    v_mfma_f32_16x16x32_bf16 a[28:31], a[120:123], v[44:47], a[28:31]
    ds_read_b64_tr_b16 a[98:99], v9 offset:2496
    v_mfma_f32_16x16x32_bf16 a[32:35], a[124:127], v[40:43], a[32:35]
    ds_read_b64_tr_b16 a[100:101], v9 offset:224
    v_mfma_f32_16x16x32_bf16 a[36:39], a[124:127], v[44:47], a[36:39]
    ds_read_b64_tr_b16 a[102:103], v9 offset:2528
    v_mfma_f32_16x16x32_bf16 a[40:43], a[128:131], v[40:43], a[40:43]
    ds_read_b64_tr_b16 a[104:105], v9 offset:256
    v_mfma_f32_16x16x32_bf16 a[44:47], a[128:131], v[44:47], a[44:47]
    ds_read_b64_tr_b16 a[106:107], v9 offset:2560
    v_mfma_f32_16x16x32_bf16 a[48:51], a[132:135], v[40:43], a[48:51]
    ds_read_b64_tr_b16 a[144:145], v13 offset:0
    v_mfma_f32_16x16x32_bf16 a[52:55], a[132:135], v[44:47], a[52:55]
    ds_read_b64_tr_b16 a[146:147], v13 offset:2304
    v_mfma_f32_16x16x32_bf16 a[56:59], a[136:139], v[40:43], a[56:59]
    ds_read_b64_tr_b16 a[148:149], v13 offset:128
    v_mfma_f32_16x16x32_bf16 a[60:63], a[136:139], v[44:47], a[60:63]
    ds_read_b64_tr_b16 a[150:151], v13 offset:2432
    v_mfma_f32_16x16x32_bf16 a[64:67], a[140:143], v[40:43], a[64:67]
    ds_read_b64_tr_b16 a[152:153], v9 offset:256
    v_mfma_f32_16x16x32_bf16 a[68:71], a[140:143], v[44:47], a[68:71]
    ds_read_b64_tr_b16 a[154:155], v9 offset:2560
    s_waitcnt lgkmcnt(4)
    v_mfma_f32_16x16x32_bf16 a[156:159], a[144:147], a[168:171], a[156:159]
    s_waitcnt lgkmcnt(2)
    v_mfma_f32_16x16x32_bf16 a[160:163], a[148:151], a[168:171], a[160:163]
    s_waitcnt lgkmcnt(0)
    v_mfma_f32_16x16x32_bf16 a[164:167], a[152:155], a[168:171], a[164:167]
    v_mfma_f32_16x16x32_bf16 v[48:51], a[168:171], v[32:35], v[48:51]
    ds_read_b128 v[40:43], v19 offset:0
    ds_read_b128 v[44:47], v19 offset:2048
    v_mfma_f32_16x16x32_bf16 v[56:59], v[32:35], v[32:35], v[56:59]
    ds_read_b64_tr_b16 a[108:109], v9 offset:9216
    ds_read_b64_tr_b16 a[110:111], v9 offset:11520
    v_mfma_f32_16x16x32_bf16 v[52:55], a[168:171], v[36:39], v[52:55]
    ds_read_b64_tr_b16 a[112:113], v9 offset:9248
    ds_read_b64_tr_b16 a[114:115], v9 offset:11552
    v_mfma_f32_16x16x32_bf16 v[60:63], v[36:39], v[36:39], v[60:63]
    ds_read_b64_tr_b16 a[116:117], v9 offset:9280
    ds_read_b64_tr_b16 a[118:119], v9 offset:11584
    v_mfma_f32_16x16x32_bf16 a[0:3], a[72:75], v[32:35], a[0:3]
    ds_read_b64_tr_b16 a[120:121], v9 offset:9312
    v_mfma_f32_16x16x32_bf16 a[4:7], a[72:75], v[36:39], a[4:7]
    ds_read_b64_tr_b16 a[122:123], v9 offset:11616
    v_mfma_f32_16x16x32_bf16 a[8:11], a[76:79], v[32:35], a[8:11]
    ds_read_b64_tr_b16 a[124:125], v9 offset:9344
    v_mfma_f32_16x16x32_bf16 a[12:15], a[76:79], v[36:39], a[12:15]
    ds_read_b64_tr_b16 a[126:127], v9 offset:11648
    v_mfma_f32_16x16x32_bf16 a[16:19], a[80:83], v[32:35], a[16:19]
    ds_read_b64_tr_b16 a[128:129], v9 offset:9376
    v_mfma_f32_16x16x32_bf16 a[20:23], a[80:83], v[36:39], a[20:23]
    ds_read_b64_tr_b16 a[130:131], v9 offset:11680
    v_mfma_f32_16x16x32_bf16 a[24:27], a[84:87], v[32:35], a[24:27]
    ds_read_b64_tr_b16 a[132:133], v9 offset:9408
    v_mfma_f32_16x16x32_bf16 a[28:31], a[84:87], v[36:39], a[28:31]
    ds_read_b64_tr_b16 a[134:135], v9 offset:11712
    v_mfma_f32_16x16x32_bf16 a[32:35], a[88:91], v[32:35], a[32:35]
    ds_read_b64_tr_b16 a[136:137], v9 offset:9440
    v_mfma_f32_16x16x32_bf16 a[36:39], a[88:91], v[36:39], a[36:39]
    ds_read_b64_tr_b16 a[138:139], v9 offset:11744
    v_mfma_f32_16x16x32_bf16 a[40:43], a[92:95], v[32:35], a[40:43]
    ds_read_b64_tr_b16 a[140:141], v9 offset:9472
    v_mfma_f32_16x16x32_bf16 a[44:47], a[92:95], v[36:39], a[44:47]
    ds_read_b64_tr_b16 a[142:143], v9 offset:11776
    v_mfma_f32_16x16x32_bf16 a[48:51], a[96:99], v[32:35], a[48:51]
    ds_read_b64_tr_b16 a[144:145], v13 offset:9216
    v_mfma_f32_16x16x32_bf16 a[52:55], a[96:99], v[36:39], a[52:55]
    ds_read_b64_tr_b16 a[146:147], v13 offset:11520
    v_mfma_f32_16x16x32_bf16 a[56:59], a[100:103], v[32:35], a[56:59]
    ds_read_b64_tr_b16 a[148:149], v13 offset:9344
    v_mfma_f32_16x16x32_bf16 a[60:63], a[100:103], v[36:39], a[60:63]
    ds_read_b64_tr_b16 a[150:151], v13 offset:11648
    v_mfma_f32_16x16x32_bf16 a[64:67], a[104:107], v[32:35], a[64:67]
    ds_read_b64_tr_b16 a[152:153], v9 offset:9472
    v_mfma_f32_16x16x32_bf16 a[68:71], a[104:107], v[36:39], a[68:71]
    ds_read_b64_tr_b16 a[154:155], v9 offset:11776
    s_barrier
    s_waitcnt lgkmcnt(4)
    v_mfma_f32_16x16x32_bf16 a[156:159], a[144:147], a[168:171], a[156:159]
    s_waitcnt lgkmcnt(2)
    v_mfma_f32_16x16x32_bf16 a[160:163], a[148:151], a[168:171], a[160:163]
    s_waitcnt lgkmcnt(0)
    v_mfma_f32_16x16x32_bf16 a[164:167], a[152:155], a[168:171], a[164:167]
    v_mfma_f32_16x16x32_bf16 v[48:51], a[168:171], v[40:43], v[48:51]
    ds_read_b128 v[32:35], v20 offset:0
    ds_read_b128 v[36:39], v20 offset:2048
    v_mfma_f32_16x16x32_bf16 v[56:59], v[40:43], v[40:43], v[56:59]
    ds_read_b64_tr_b16 a[72:73], v10 offset:0
    ds_read_b64_tr_b16 a[74:75], v10 offset:2304
    v_mfma_f32_16x16x32_bf16 v[52:55], a[168:171], v[44:47], v[52:55]
    ds_read_b64_tr_b16 a[76:77], v10 offset:32
    ds_read_b64_tr_b16 a[78:79], v10 offset:2336
    v_mfma_f32_16x16x32_bf16 v[60:63], v[44:47], v[44:47], v[60:63]
    ds_read_b64_tr_b16 a[80:81], v10 offset:64
    ds_read_b64_tr_b16 a[82:83], v10 offset:2368
    v_mfma_f32_16x16x32_bf16 a[0:3], a[108:111], v[40:43], a[0:3]
    ds_read_b64_tr_b16 a[84:85], v10 offset:96
    v_mfma_f32_16x16x32_bf16 a[4:7], a[108:111], v[44:47], a[4:7]
    ds_read_b64_tr_b16 a[86:87], v10 offset:2400
    v_mfma_f32_16x16x32_bf16 a[8:11], a[112:115], v[40:43], a[8:11]
    ds_read_b64_tr_b16 a[88:89], v10 offset:128
    v_mfma_f32_16x16x32_bf16 a[12:15], a[112:115], v[44:47], a[12:15]
    ds_read_b64_tr_b16 a[90:91], v10 offset:2432
    v_mfma_f32_16x16x32_bf16 a[16:19], a[116:119], v[40:43], a[16:19]
    ds_read_b64_tr_b16 a[92:93], v10 offset:160
    v_mfma_f32_16x16x32_bf16 a[20:23], a[116:119], v[44:47], a[20:23]
    ds_read_b64_tr_b16 a[94:95], v10 offset:2464
    v_mfma_f32_16x16x32_bf16 a[24:27], a[120:123], v[40:43], a[24:27]
    ds_read_b64_tr_b16 a[96:97], v10 offset:192
    v_mfma_f32_16x16x32_bf16 a[28:31], a[120:123], v[44:47], a[28:31]
    ds_read_b64_tr_b16 a[98:99], v10 offset:2496
    v_mfma_f32_16x16x32_bf16 a[32:35], a[124:127], v[40:43], a[32:35]
    ds_read_b64_tr_b16 a[100:101], v10 offset:224
    v_mfma_f32_16x16x32_bf16 a[36:39], a[124:127], v[44:47], a[36:39]
    ds_read_b64_tr_b16 a[102:103], v10 offset:2528
    v_mfma_f32_16x16x32_bf16 a[40:43], a[128:131], v[40:43], a[40:43]
    ds_read_b64_tr_b16 a[104:105], v10 offset:256
    v_mfma_f32_16x16x32_bf16 a[44:47], a[128:131], v[44:47], a[44:47]
    ds_read_b64_tr_b16 a[106:107], v10 offset:2560
    v_mfma_f32_16x16x32_bf16 a[48:51], a[132:135], v[40:43], a[48:51]
    ds_read_b64_tr_b16 a[144:145], v14 offset:0
    v_mfma_f32_16x16x32_bf16 a[52:55], a[132:135], v[44:47], a[52:55]
    ds_read_b64_tr_b16 a[146:147], v14 offset:2304
    v_mfma_f32_16x16x32_bf16 a[56:59], a[136:139], v[40:43], a[56:59]
    ds_read_b64_tr_b16 a[148:149], v14 offset:128
    v_mfma_f32_16x16x32_bf16 a[60:63], a[136:139], v[44:47], a[60:63]
    ds_read_b64_tr_b16 a[150:151], v14 offset:2432
    v_mfma_f32_16x16x32_bf16 a[64:67], a[140:143], v[40:43], a[64:67]
    ds_read_b64_tr_b16 a[152:153], v10 offset:256
    v_mfma_f32_16x16x32_bf16 a[68:71], a[140:143], v[44:47], a[68:71]
    ds_read_b64_tr_b16 a[154:155], v10 offset:2560
    s_waitcnt lgkmcnt(4)
    v_mfma_f32_16x16x32_bf16 a[156:159], a[144:147], a[168:171], a[156:159]
    s_waitcnt lgkmcnt(2)
    v_mfma_f32_16x16x32_bf16 a[160:163], a[148:151], a[168:171], a[160:163]
    s_waitcnt lgkmcnt(0)
    v_mfma_f32_16x16x32_bf16 a[164:167], a[152:155], a[168:171], a[164:167]
    v_mfma_f32_16x16x32_bf16 v[48:51], a[168:171], v[32:35], v[48:51]
    ds_read_b128 v[40:43], v21 offset:0
    ds_read_b128 v[44:47], v21 offset:2048
    v_mfma_f32_16x16x32_bf16 v[56:59], v[32:35], v[32:35], v[56:59]
    ds_read_b64_tr_b16 a[108:109], v10 offset:9216
    ds_read_b64_tr_b16 a[110:111], v10 offset:11520
    v_mfma_f32_16x16x32_bf16 v[52:55], a[168:171], v[36:39], v[52:55]
    ds_read_b64_tr_b16 a[112:113], v10 offset:9248
    ds_read_b64_tr_b16 a[114:115], v10 offset:11552
    v_mfma_f32_16x16x32_bf16 v[60:63], v[36:39], v[36:39], v[60:63]
    ds_read_b64_tr_b16 a[116:117], v10 offset:9280
    ds_read_b64_tr_b16 a[118:119], v10 offset:11584
    v_mfma_f32_16x16x32_bf16 a[0:3], a[72:75], v[32:35], a[0:3]
    ds_read_b64_tr_b16 a[120:121], v10 offset:9312
    v_mfma_f32_16x16x32_bf16 a[4:7], a[72:75], v[36:39], a[4:7]
    ds_read_b64_tr_b16 a[122:123], v10 offset:11616
    v_mfma_f32_16x16x32_bf16 a[8:11], a[76:79], v[32:35], a[8:11]
    ds_read_b64_tr_b16 a[124:125], v10 offset:9344
    v_mfma_f32_16x16x32_bf16 a[12:15], a[76:79], v[36:39], a[12:15]
    ds_read_b64_tr_b16 a[126:127], v10 offset:11648
    v_mfma_f32_16x16x32_bf16 a[16:19], a[80:83], v[32:35], a[16:19]
    ds_read_b64_tr_b16 a[128:129], v10 offset:9376
    v_mfma_f32_16x16x32_bf16 a[20:23], a[80:83], v[36:39], a[20:23]
    ds_read_b64_tr_b16 a[130:131], v10 offset:11680
    v_mfma_f32_16x16x32_bf16 a[24:27], a[84:87], v[32:35], a[24:27]
    ds_read_b64_tr_b16 a[132:133], v10 offset:9408
    v_mfma_f32_16x16x32_bf16 a[28:31], a[84:87], v[36:39], a[28:31]
    ds_read_b64_tr_b16 a[134:135], v10 offset:11712
    v_mfma_f32_16x16x32_bf16 a[32:35], a[88:91], v[32:35], a[32:35]
    ds_read_b64_tr_b16 a[136:137], v10 offset:9440
    v_mfma_f32_16x16x32_bf16 a[36:39], a[88:91], v[36:39], a[36:39]
    ds_read_b64_tr_b16 a[138:139], v10 offset:11744
    v_mfma_f32_16x16x32_bf16 a[40:43], a[92:95], v[32:35], a[40:43]
    ds_read_b64_tr_b16 a[140:141], v10 offset:9472
    v_mfma_f32_16x16x32_bf16 a[44:47], a[92:95], v[36:39], a[44:47]
    ds_read_b64_tr_b16 a[142:143], v10 offset:11776
    v_mfma_f32_16x16x32_bf16 a[48:51], a[96:99], v[32:35], a[48:51]
    ds_read_b64_tr_b16 a[144:145], v14 offset:9216
    v_mfma_f32_16x16x32_bf16 a[52:55], a[96:99], v[36:39], a[52:55]
    ds_read_b64_tr_b16 a[146:147], v14 offset:11520
    v_mfma_f32_16x16x32_bf16 a[56:59], a[100:103], v[32:35], a[56:59]
    ds_read_b64_tr_b16 a[148:149], v14 offset:9344
    v_mfma_f32_16x16x32_bf16 a[60:63], a[100:103], v[36:39], a[60:63]
    ds_read_b64_tr_b16 a[150:151], v14 offset:11648
    v_mfma_f32_16x16x32_bf16 a[64:67], a[104:107], v[32:35], a[64:67]
    ds_read_b64_tr_b16 a[152:153], v10 offset:9472
    v_mfma_f32_16x16x32_bf16 a[68:71], a[104:107], v[36:39], a[68:71]
    ds_read_b64_tr_b16 a[154:155], v10 offset:11776
    s_barrier
    s_waitcnt lgkmcnt(4)
    v_mfma_f32_16x16x32_bf16 a[156:159], a[144:147], a[168:171], a[156:159]
    s_waitcnt lgkmcnt(2)
    v_mfma_f32_16x16x32_bf16 a[160:163], a[148:151], a[168:171], a[160:163]
    s_waitcnt lgkmcnt(0)
    v_mfma_f32_16x16x32_bf16 a[164:167], a[152:155], a[168:171], a[164:167]
    v_mfma_f32_16x16x32_bf16 v[48:51], a[168:171], v[40:43], v[48:51]
    ds_read_b128 v[32:35], v22 offset:0
    ds_read_b128 v[36:39], v22 offset:2048
    v_mfma_f32_16x16x32_bf16 v[56:59], v[40:43], v[40:43], v[56:59]
    ds_read_b64_tr_b16 a[72:73], v11 offset:0
    ds_read_b64_tr_b16 a[74:75], v11 offset:2304
    v_mfma_f32_16x16x32_bf16 v[52:55], a[168:171], v[44:47], v[52:55]
    ds_read_b64_tr_b16 a[76:77], v11 offset:32
    ds_read_b64_tr_b16 a[78:79], v11 offset:2336
    v_mfma_f32_16x16x32_bf16 v[60:63], v[44:47], v[44:47], v[60:63]
    ds_read_b64_tr_b16 a[80:81], v11 offset:64
    ds_read_b64_tr_b16 a[82:83], v11 offset:2368
    v_mfma_f32_16x16x32_bf16 a[0:3], a[108:111], v[40:43], a[0:3]
    ds_read_b64_tr_b16 a[84:85], v11 offset:96
    v_mfma_f32_16x16x32_bf16 a[4:7], a[108:111], v[44:47], a[4:7]
    ds_read_b64_tr_b16 a[86:87], v11 offset:2400
    v_mfma_f32_16x16x32_bf16 a[8:11], a[112:115], v[40:43], a[8:11]
    ds_read_b64_tr_b16 a[88:89], v11 offset:128
    v_mfma_f32_16x16x32_bf16 a[12:15], a[112:115], v[44:47], a[12:15]
    ds_read_b64_tr_b16 a[90:91], v11 offset:2432
    v_mfma_f32_16x16x32_bf16 a[16:19], a[116:119], v[40:43], a[16:19]
    ds_read_b64_tr_b16 a[92:93], v11 offset:160
    v_mfma_f32_16x16x32_bf16 a[20:23], a[116:119], v[44:47], a[20:23]
    ds_read_b64_tr_b16 a[94:95], v11 offset:2464
    v_mfma_f32_16x16x32_bf16 a[24:27], a[120:123], v[40:43], a[24:27]
    ds_read_b64_tr_b16 a[96:97], v11 offset:192
    v_mfma_f32_16x16x32_bf16 a[28:31], a[120:123], v[44:47], a[28:31]
    ds_read_b64_tr_b16 a[98:99], v11 offset:2496
    v_mfma_f32_16x16x32_bf16 a[32:35], a[124:127], v[40:43], a[32:35]
    ds_read_b64_tr_b16 a[100:101], v11 offset:224
    v_mfma_f32_16x16x32_bf16 a[36:39], a[124:127], v[44:47], a[36:39]
    ds_read_b64_tr_b16 a[102:103], v11 offset:2528
    v_mfma_f32_16x16x32_bf16 a[40:43], a[128:131], v[40:43], a[40:43]
    ds_read_b64_tr_b16 a[104:105], v11 offset:256
    v_mfma_f32_16x16x32_bf16 a[44:47], a[128:131], v[44:47], a[44:47]
    ds_read_b64_tr_b16 a[106:107], v11 offset:2560
    v_mfma_f32_16x16x32_bf16 a[48:51], a[132:135], v[40:43], a[48:51]
    ds_read_b64_tr_b16 a[144:145], v15 offset:0
    v_mfma_f32_16x16x32_bf16 a[52:55], a[132:135], v[44:47], a[52:55]
    ds_read_b64_tr_b16 a[146:147], v15 offset:2304
    v_mfma_f32_16x16x32_bf16 a[56:59], a[136:139], v[40:43], a[56:59]
    ds_read_b64_tr_b16 a[148:149], v15 offset:128
    v_mfma_f32_16x16x32_bf16 a[60:63], a[136:139], v[44:47], a[60:63]
    ds_read_b64_tr_b16 a[150:151], v15 offset:2432
    v_mfma_f32_16x16x32_bf16 a[64:67], a[140:143], v[40:43], a[64:67]
    ds_read_b64_tr_b16 a[152:153], v11 offset:256
    v_mfma_f32_16x16x32_bf16 a[68:71], a[140:143], v[44:47], a[68:71]
    ds_read_b64_tr_b16 a[154:155], v11 offset:2560
    s_waitcnt lgkmcnt(4)
    v_mfma_f32_16x16x32_bf16 a[156:159], a[144:147], a[168:171], a[156:159]
    s_waitcnt lgkmcnt(2)
    v_mfma_f32_16x16x32_bf16 a[160:163], a[148:151], a[168:171], a[160:163]
    s_waitcnt lgkmcnt(0)
    v_mfma_f32_16x16x32_bf16 a[164:167], a[152:155], a[168:171], a[164:167]
    v_mfma_f32_16x16x32_bf16 v[48:51], a[168:171], v[32:35], v[48:51]
    ds_read_b128 v[40:43], v23 offset:0
    ds_read_b128 v[44:47], v23 offset:2048
    v_mfma_f32_16x16x32_bf16 v[56:59], v[32:35], v[32:35], v[56:59]
    ds_read_b64_tr_b16 a[108:109], v11 offset:9216
    ds_read_b64_tr_b16 a[110:111], v11 offset:11520
    v_mfma_f32_16x16x32_bf16 v[52:55], a[168:171], v[36:39], v[52:55]
    ds_read_b64_tr_b16 a[112:113], v11 offset:9248
    ds_read_b64_tr_b16 a[114:115], v11 offset:11552
    v_mfma_f32_16x16x32_bf16 v[60:63], v[36:39], v[36:39], v[60:63]
    ds_read_b64_tr_b16 a[116:117], v11 offset:9280
    ds_read_b64_tr_b16 a[118:119], v11 offset:11584
    v_mfma_f32_16x16x32_bf16 a[0:3], a[72:75], v[32:35], a[0:3]
    ds_read_b64_tr_b16 a[120:121], v11 offset:9312
    v_mfma_f32_16x16x32_bf16 a[4:7], a[72:75], v[36:39], a[4:7]
    ds_read_b64_tr_b16 a[122:123], v11 offset:11616
    v_mfma_f32_16x16x32_bf16 a[8:11], a[76:79], v[32:35], a[8:11]
    ds_read_b64_tr_b16 a[124:125], v11 offset:9344
    v_mfma_f32_16x16x32_bf16 a[12:15], a[76:79], v[36:39], a[12:15]
    ds_read_b64_tr_b16 a[126:127], v11 offset:11648
    v_mfma_f32_16x16x32_bf16 a[16:19], a[80:83], v[32:35], a[16:19]
    ds_read_b64_tr_b16 a[128:129], v11 offset:9376
    v_mfma_f32_16x16x32_bf16 a[20:23], a[80:83], v[36:39], a[20:23]
    ds_read_b64_tr_b16 a[130:131], v11 offset:11680
    v_mfma_f32_16x16x32_bf16 a[24:27], a[84:87], v[32:35], a[24:27]
    ds_read_b64_tr_b16 a[132:133], v11 offset:9408
    v_mfma_f32_16x16x32_bf16 a[28:31], a[84:87], v[36:39], a[28:31]
    ds_read_b64_tr_b16 a[134:135], v11 offset:11712
    v_mfma_f32_16x16x32_bf16 a[32:35], a[88:91], v[32:35], a[32:35]
    ds_read_b64_tr_b16 a[136:137], v11 offset:9440
    v_mfma_f32_16x16x32_bf16 a[36:39], a[88:91], v[36:39], a[36:39]
    ds_read_b64_tr_b16 a[138:139], v11 offset:11744
    v_mfma_f32_16x16x32_bf16 a[40:43], a[92:95], v[32:35], a[40:43]
    ds_read_b64_tr_b16 a[140:141], v11 offset:9472
    v_mfma_f32_16x16x32_bf16 a[44:47], a[92:95], v[36:39], a[44:47]
    ds_read_b64_tr_b16 a[142:143], v11 offset:11776
    v_mfma_f32_16x16x32_bf16 a[48:51], a[96:99], v[32:35], a[48:51]
    ds_read_b64_tr_b16 a[144:145], v15 offset:9216
    v_mfma_f32_16x16x32_bf16 a[52:55], a[96:99], v[36:39], a[52:55]
    ds_read_b64_tr_b16 a[146:147], v15 offset:11520
    v_mfma_f32_16x16x32_bf16 a[56:59], a[100:103], v[32:35], a[56:59]
    ds_read_b64_tr_b16 a[148:149], v15 offset:9344
    v_mfma_f32_16x16x32_bf16 a[60:63], a[100:103], v[36:39], a[60:63]
    ds_read_b64_tr_b16 a[150:151], v15 offset:11648
    v_mfma_f32_16x16x32_bf16 a[64:67], a[104:107], v[32:35], a[64:67]
    ds_read_b64_tr_b16 a[152:153], v11 offset:9472
    v_mfma_f32_16x16x32_bf16 a[68:71], a[104:107], v[36:39], a[68:71]
    ds_read_b64_tr_b16 a[154:155], v11 offset:11776
    s_barrier
    s_waitcnt lgkmcnt(4)
    v_mfma_f32_16x16x32_bf16 a[156:159], a[144:147], a[168:171], a[156:159]
    s_waitcnt lgkmcnt(2)
    v_mfma_f32_16x16x32_bf16 a[160:163], a[148:151], a[168:171], a[160:163]
    s_waitcnt lgkmcnt(0)
    v_mfma_f32_16x16x32_bf16 a[164:167], a[152:155], a[168:171], a[164:167]
    v_mfma_f32_16x16x32_bf16 v[48:51], a[168:171], v[40:43], v[48:51]
    ds_read_b128 v[32:35], v16 offset:0
    ds_read_b128 v[36:39], v16 offset:2048
    v_mfma_f32_16x16x32_bf16 v[56:59], v[40:43], v[40:43], v[56:59]
    ds_read_b64_tr_b16 a[72:73], v8 offset:0
    ds_read_b64_tr_b16 a[74:75], v8 offset:2304
    v_mfma_f32_16x16x32_bf16 v[52:55], a[168:171], v[44:47], v[52:55]
    ds_read_b64_tr_b16 a[76:77], v8 offset:32
    ds_read_b64_tr_b16 a[78:79], v8 offset:2336
    v_mfma_f32_16x16x32_bf16 v[60:63], v[44:47], v[44:47], v[60:63]
    ds_read_b64_tr_b16 a[80:81], v8 offset:64
    ds_read_b64_tr_b16 a[82:83], v8 offset:2368
    v_mfma_f32_16x16x32_bf16 a[0:3], a[108:111], v[40:43], a[0:3]
    ds_read_b64_tr_b16 a[84:85], v8 offset:96
    v_mfma_f32_16x16x32_bf16 a[4:7], a[108:111], v[44:47], a[4:7]
    ds_read_b64_tr_b16 a[86:87], v8 offset:2400
    v_mfma_f32_16x16x32_bf16 a[8:11], a[112:115], v[40:43], a[8:11]
    ds_read_b64_tr_b16 a[88:89], v8 offset:128
    v_mfma_f32_16x16x32_bf16 a[12:15], a[112:115], v[44:47], a[12:15]
    ds_read_b64_tr_b16 a[90:91], v8 offset:2432
    v_mfma_f32_16x16x32_bf16 a[16:19], a[116:119], v[40:43], a[16:19]
    ds_read_b64_tr_b16 a[92:93], v8 offset:160
    v_mfma_f32_16x16x32_bf16 a[20:23], a[116:119], v[44:47], a[20:23]
    ds_read_b64_tr_b16 a[94:95], v8 offset:2464
    v_mfma_f32_16x16x32_bf16 a[24:27], a[120:123], v[40:43], a[24:27]
    ds_read_b64_tr_b16 a[96:97], v8 offset:192
    v_mfma_f32_16x16x32_bf16 a[28:31], a[120:123], v[44:47], a[28:31]
    ds_read_b64_tr_b16 a[98:99], v8 offset:2496
    v_mfma_f32_16x16x32_bf16 a[32:35], a[124:127], v[40:43], a[32:35]
    ds_read_b64_tr_b16 a[100:101], v8 offset:224
    v_mfma_f32_16x16x32_bf16 a[36:39], a[124:127], v[44:47], a[36:39]
    ds_read_b64_tr_b16 a[102:103], v8 offset:2528
    v_mfma_f32_16x16x32_bf16 a[40:43], a[128:131], v[40:43], a[40:43]
    ds_read_b64_tr_b16 a[104:105], v8 offset:256
    v_mfma_f32_16x16x32_bf16 a[44:47], a[128:131], v[44:47], a[44:47]
    ds_read_b64_tr_b16 a[106:107], v8 offset:2560
    v_mfma_f32_16x16x32_bf16 a[48:51], a[132:135], v[40:43], a[48:51]
    ds_read_b64_tr_b16 a[144:145], v12 offset:0
    v_mfma_f32_16x16x32_bf16 a[52:55], a[132:135], v[44:47], a[52:55]
    ds_read_b64_tr_b16 a[146:147], v12 offset:2304
    v_mfma_f32_16x16x32_bf16 a[56:59], a[136:139], v[40:43], a[56:59]
    ds_read_b64_tr_b16 a[148:149], v12 offset:128
    v_mfma_f32_16x16x32_bf16 a[60:63], a[136:139], v[44:47], a[60:63]
    ds_read_b64_tr_b16 a[150:151], v12 offset:2432
    v_mfma_f32_16x16x32_bf16 a[64:67], a[140:143], v[40:43], a[64:67]
    ds_read_b64_tr_b16 a[152:153], v8 offset:256
    v_mfma_f32_16x16x32_bf16 a[68:71], a[140:143], v[44:47], a[68:71]
    ds_read_b64_tr_b16 a[154:155], v8 offset:2560
    s_waitcnt lgkmcnt(4)
    v_mfma_f32_16x16x32_bf16 a[156:159], a[144:147], a[168:171], a[156:159]
    s_waitcnt lgkmcnt(2)
    v_mfma_f32_16x16x32_bf16 a[160:163], a[148:151], a[168:171], a[160:163]
    s_waitcnt lgkmcnt(0)
    v_mfma_f32_16x16x32_bf16 a[164:167], a[152:155], a[168:171], a[164:167]
    v_mfma_f32_16x16x32_bf16 v[48:51], a[168:171], v[32:35], v[48:51]
    ds_read_b128 v[40:43], v17 offset:0
    ds_read_b128 v[44:47], v17 offset:2048
    v_mfma_f32_16x16x32_bf16 v[56:59], v[32:35], v[32:35], v[56:59]
    ds_read_b64_tr_b16 a[108:109], v8 offset:9216
    ds_read_b64_tr_b16 a[110:111], v8 offset:11520
    v_mfma_f32_16x16x32_bf16 v[52:55], a[168:171], v[36:39], v[52:55]
    ds_read_b64_tr_b16 a[112:113], v8 offset:9248
    ds_read_b64_tr_b16 a[114:115], v8 offset:11552
    v_mfma_f32_16x16x32_bf16 v[60:63], v[36:39], v[36:39], v[60:63]
    ds_read_b64_tr_b16 a[116:117], v8 offset:9280
    ds_read_b64_tr_b16 a[118:119], v8 offset:11584
    v_mfma_f32_16x16x32_bf16 a[0:3], a[72:75], v[32:35], a[0:3]
    ds_read_b64_tr_b16 a[120:121], v8 offset:9312
    v_mfma_f32_16x16x32_bf16 a[4:7], a[72:75], v[36:39], a[4:7]
    ds_read_b64_tr_b16 a[122:123], v8 offset:11616
    v_mfma_f32_16x16x32_bf16 a[8:11], a[76:79], v[32:35], a[8:11]
    ds_read_b64_tr_b16 a[124:125], v8 offset:9344
    v_mfma_f32_16x16x32_bf16 a[12:15], a[76:79], v[36:39], a[12:15]
    ds_read_b64_tr_b16 a[126:127], v8 offset:11648
    v_mfma_f32_16x16x32_bf16 a[16:19], a[80:83], v[32:35], a[16:19]
    ds_read_b64_tr_b16 a[128:129], v8 offset:9376
    v_mfma_f32_16x16x32_bf16 a[20:23], a[80:83], v[36:39], a[20:23]
    ds_read_b64_tr_b16 a[130:131], v8 offset:11680
    v_mfma_f32_16x16x32_bf16 a[24:27], a[84:87], v[32:35], a[24:27]
    ds_read_b64_tr_b16 a[132:133], v8 offset:9408
    v_mfma_f32_16x16x32_bf16 a[28:31], a[84:87], v[36:39], a[28:31]
    ds_read_b64_tr_b16 a[134:135], v8 offset:11712
    v_mfma_f32_16x16x32_bf16 a[32:35], a[88:91], v[32:35], a[32:35]
    ds_read_b64_tr_b16 a[136:137], v8 offset:9440
    v_mfma_f32_16x16x32_bf16 a[36:39], a[88:91], v[36:39], a[36:39]
    ds_read_b64_tr_b16 a[138:139], v8 offset:11744
    v_mfma_f32_16x16x32_bf16 a[40:43], a[92:95], v[32:35], a[40:43]
    ds_read_b64_tr_b16 a[140:141], v8 offset:9472
    v_mfma_f32_16x16x32_bf16 a[44:47], a[92:95], v[36:39], a[44:47]
    ds_read_b64_tr_b16 a[142:143], v8 offset:11776
    v_mfma_f32_16x16x32_bf16 a[48:51], a[96:99], v[32:35], a[48:51]
    ds_read_b64_tr_b16 a[144:145], v12 offset:9216
    v_mfma_f32_16x16x32_bf16 a[52:55], a[96:99], v[36:39], a[52:55]
    ds_read_b64_tr_b16 a[146:147], v12 offset:11520
    v_mfma_f32_16x16x32_bf16 a[56:59], a[100:103], v[32:35], a[56:59]
    ds_read_b64_tr_b16 a[148:149], v12 offset:9344
    v_mfma_f32_16x16x32_bf16 a[60:63], a[100:103], v[36:39], a[60:63]
    ds_read_b64_tr_b16 a[150:151], v12 offset:11648
    v_mfma_f32_16x16x32_bf16 a[64:67], a[104:107], v[32:35], a[64:67]
    ds_read_b64_tr_b16 a[152:153], v8 offset:9472
    v_mfma_f32_16x16x32_bf16 a[68:71], a[104:107], v[36:39], a[68:71]
    ds_read_b64_tr_b16 a[154:155], v8 offset:11776
    s_barrier
    s_waitcnt lgkmcnt(4)
    v_mfma_f32_16x16x32_bf16 a[156:159], a[144:147], a[168:171], a[156:159]
    s_waitcnt lgkmcnt(2)
    v_mfma_f32_16x16x32_bf16 a[160:163], a[148:151], a[168:171], a[160:163]
    s_waitcnt lgkmcnt(0)
    v_mfma_f32_16x16x32_bf16 a[164:167], a[152:155], a[168:171], a[164:167]
    v_mfma_f32_16x16x32_bf16 v[48:51], a[168:171], v[40:43], v[48:51]
    ds_read_b128 v[32:35], v18 offset:0
    ds_read_b128 v[36:39], v18 offset:2048
    v_mfma_f32_16x16x32_bf16 v[56:59], v[40:43], v[40:43], v[56:59]
    ds_read_b64_tr_b16 a[72:73], v9 offset:0
    ds_read_b64_tr_b16 a[74:75], v9 offset:2304
    v_mfma_f32_16x16x32_bf16 v[52:55], a[168:171], v[44:47], v[52:55]
    ds_read_b64_tr_b16 a[76:77], v9 offset:32
    ds_read_b64_tr_b16 a[78:79], v9 offset:2336
    v_mfma_f32_16x16x32_bf16 v[60:63], v[44:47], v[44:47], v[60:63]
    ds_read_b64_tr_b16 a[80:81], v9 offset:64
    ds_read_b64_tr_b16 a[82:83], v9 offset:2368
    v_mfma_f32_16x16x32_bf16 a[0:3], a[108:111], v[40:43], a[0:3]
    ds_read_b64_tr_b16 a[84:85], v9 offset:96
    v_mfma_f32_16x16x32_bf16 a[4:7], a[108:111], v[44:47], a[4:7]
    ds_read_b64_tr_b16 a[86:87], v9 offset:2400
    v_mfma_f32_16x16x32_bf16 a[8:11], a[112:115], v[40:43], a[8:11]
    ds_read_b64_tr_b16 a[88:89], v9 offset:128
    v_mfma_f32_16x16x32_bf16 a[12:15], a[112:115], v[44:47], a[12:15]
    ds_read_b64_tr_b16 a[90:91], v9 offset:2432
    v_mfma_f32_16x16x32_bf16 a[16:19], a[116:119], v[40:43], a[16:19]
    ds_read_b64_tr_b16 a[92:93], v9 offset:160
    v_mfma_f32_16x16x32_bf16 a[20:23], a[116:119], v[44:47], a[20:23]
    ds_read_b64_tr_b16 a[94:95], v9 offset:2464
    v_mfma_f32_16x16x32_bf16 a[24:27], a[120:123], v[40:43], a[24:27]
    ds_read_b64_tr_b16 a[96:97], v9 offset:192
    v_mfma_f32_16x16x32_bf16 a[28:31], a[120:123], v[44:47], a[28:31]
    ds_read_b64_tr_b16 a[98:99], v9 offset:2496
    v_mfma_f32_16x16x32_bf16 a[32:35], a[124:127], v[40:43], a[32:35]
    ds_read_b64_tr_b16 a[100:101], v9 offset:224
    v_mfma_f32_16x16x32_bf16 a[36:39], a[124:127], v[44:47], a[36:39]
    ds_read_b64_tr_b16 a[102:103], v9 offset:2528
    v_mfma_f32_16x16x32_bf16 a[40:43], a[128:131], v[40:43], a[40:43]
    ds_read_b64_tr_b16 a[104:105], v9 offset:256
    v_mfma_f32_16x16x32_bf16 a[44:47], a[128:131], v[44:47], a[44:47]
    ds_read_b64_tr_b16 a[106:107], v9 offset:2560
    v_mfma_f32_16x16x32_bf16 a[48:51], a[132:135], v[40:43], a[48:51]
    ds_read_b64_tr_b16 a[144:145], v13 offset:0
    v_mfma_f32_16x16x32_bf16 a[52:55], a[132:135], v[44:47], a[52:55]
    ds_read_b64_tr_b16 a[146:147], v13 offset:2304
    v_mfma_f32_16x16x32_bf16 a[56:59], a[136:139], v[40:43], a[56:59]
    ds_read_b64_tr_b16 a[148:149], v13 offset:128
    v_mfma_f32_16x16x32_bf16 a[60:63], a[136:139], v[44:47], a[60:63]
    ds_read_b64_tr_b16 a[150:151], v13 offset:2432
    v_mfma_f32_16x16x32_bf16 a[64:67], a[140:143], v[40:43], a[64:67]
    ds_read_b64_tr_b16 a[152:153], v9 offset:256
    v_mfma_f32_16x16x32_bf16 a[68:71], a[140:143], v[44:47], a[68:71]
    ds_read_b64_tr_b16 a[154:155], v9 offset:2560
    s_waitcnt lgkmcnt(4)
    v_mfma_f32_16x16x32_bf16 a[156:159], a[144:147], a[168:171], a[156:159]
    s_waitcnt lgkmcnt(2)
    v_mfma_f32_16x16x32_bf16 a[160:163], a[148:151], a[168:171], a[160:163]
    s_waitcnt lgkmcnt(0)
    v_mfma_f32_16x16x32_bf16 a[164:167], a[152:155], a[168:171], a[164:167]
    v_mfma_f32_16x16x32_bf16 v[48:51], a[168:171], v[32:35], v[48:51]
    ds_read_b128 v[40:43], v19 offset:0
    ds_read_b128 v[44:47], v19 offset:2048
    v_mfma_f32_16x16x32_bf16 v[56:59], v[32:35], v[32:35], v[56:59]
    ds_read_b64_tr_b16 a[108:109], v9 offset:9216
    ds_read_b64_tr_b16 a[110:111], v9 offset:11520
    v_mfma_f32_16x16x32_bf16 v[52:55], a[168:171], v[36:39], v[52:55]
    ds_read_b64_tr_b16 a[112:113], v9 offset:9248
    ds_read_b64_tr_b16 a[114:115], v9 offset:11552
    v_mfma_f32_16x16x32_bf16 v[60:63], v[36:39], v[36:39], v[60:63]
    ds_read_b64_tr_b16 a[116:117], v9 offset:9280
    ds_read_b64_tr_b16 a[118:119], v9 offset:11584
    v_mfma_f32_16x16x32_bf16 a[0:3], a[72:75], v[32:35], a[0:3]
    ds_read_b64_tr_b16 a[120:121], v9 offset:9312
    v_mfma_f32_16x16x32_bf16 a[4:7], a[72:75], v[36:39], a[4:7]
    ds_read_b64_tr_b16 a[122:123], v9 offset:11616
    v_mfma_f32_16x16x32_bf16 a[8:11], a[76:79], v[32:35], a[8:11]
    ds_read_b64_tr_b16 a[124:125], v9 offset:9344
    v_mfma_f32_16x16x32_bf16 a[12:15], a[76:79], v[36:39], a[12:15]
    ds_read_b64_tr_b16 a[126:127], v9 offset:11648
    v_mfma_f32_16x16x32_bf16 a[16:19], a[80:83], v[32:35], a[16:19]
    ds_read_b64_tr_b16 a[128:129], v9 offset:9376
    v_mfma_f32_16x16x32_bf16 a[20:23], a[80:83], v[36:39], a[20:23]
    ds_read_b64_tr_b16 a[130:131], v9 offset:11680
    v_mfma_f32_16x16x32_bf16 a[24:27], a[84:87], v[32:35], a[24:27]
    ds_read_b64_tr_b16 a[132:133], v9 offset:9408
    v_mfma_f32_16x16x32_bf16 a[28:31], a[84:87], v[36:39], a[28:31]
    ds_read_b64_tr_b16 a[134:135], v9 offset:11712
    v_mfma_f32_16x16x32_bf16 a[32:35], a[88:91], v[32:35], a[32:35]
    ds_read_b64_tr_b16 a[136:137], v9 offset:9440
    v_mfma_f32_16x16x32_bf16 a[36:39], a[88:91], v[36:39], a[36:39]
    ds_read_b64_tr_b16 a[138:139], v9 offset:11744
    v_mfma_f32_16x16x32_bf16 a[40:43], a[92:95], v[32:35], a[40:43]
    ds_read_b64_tr_b16 a[140:141], v9 offset:9472
    v_mfma_f32_16x16x32_bf16 a[44:47], a[92:95], v[36:39], a[44:47]
    ds_read_b64_tr_b16 a[142:143], v9 offset:11776
    v_mfma_f32_16x16x32_bf16 a[48:51], a[96:99], v[32:35], a[48:51]
    ds_read_b64_tr_b16 a[144:145], v13 offset:9216
    v_mfma_f32_16x16x32_bf16 a[52:55], a[96:99], v[36:39], a[52:55]
    ds_read_b64_tr_b16 a[146:147], v13 offset:11520
    v_mfma_f32_16x16x32_bf16 a[56:59], a[100:103], v[32:35], a[56:59]
    ds_read_b64_tr_b16 a[148:149], v13 offset:9344
    v_mfma_f32_16x16x32_bf16 a[60:63], a[100:103], v[36:39], a[60:63]
    ds_read_b64_tr_b16 a[150:151], v13 offset:11648
    v_mfma_f32_16x16x32_bf16 a[64:67], a[104:107], v[32:35], a[64:67]
    ds_read_b64_tr_b16 a[152:153], v9 offset:9472
    v_mfma_f32_16x16x32_bf16 a[68:71], a[104:107], v[36:39], a[68:71]
    ds_read_b64_tr_b16 a[154:155], v9 offset:11776
    s_barrier
    s_waitcnt lgkmcnt(4)
    v_mfma_f32_16x16x32_bf16 a[156:159], a[144:147], a[168:171], a[156:159]
    s_waitcnt lgkmcnt(2)
    v_mfma_f32_16x16x32_bf16 a[160:163], a[148:151], a[168:171], a[160:163]
    s_waitcnt lgkmcnt(0)
    v_mfma_f32_16x16x32_bf16 a[164:167], a[152:155], a[168:171], a[164:167]
    v_mfma_f32_16x16x32_bf16 v[48:51], a[168:171], v[40:43], v[48:51]
    ds_read_b128 v[32:35], v20 offset:0
    ds_read_b128 v[36:39], v20 offset:2048
    v_mfma_f32_16x16x32_bf16 v[56:59], v[40:43], v[40:43], v[56:59]
    ds_read_b64_tr_b16 a[72:73], v10 offset:0
    ds_read_b64_tr_b16 a[74:75], v10 offset:2304
    v_mfma_f32_16x16x32_bf16 v[52:55], a[168:171], v[44:47], v[52:55]
    ds_read_b64_tr_b16 a[76:77], v10 offset:32
    ds_read_b64_tr_b16 a[78:79], v10 offset:2336
    v_mfma_f32_16x16x32_bf16 v[60:63], v[44:47], v[44:47], v[60:63]
    ds_read_b64_tr_b16 a[80:81], v10 offset:64
    ds_read_b64_tr_b16 a[82:83], v10 offset:2368
    v_mfma_f32_16x16x32_bf16 a[0:3], a[108:111], v[40:43], a[0:3]
    ds_read_b64_tr_b16 a[84:85], v10 offset:96
    v_mfma_f32_16x16x32_bf16 a[4:7], a[108:111], v[44:47], a[4:7]
    ds_read_b64_tr_b16 a[86:87], v10 offset:2400
    v_mfma_f32_16x16x32_bf16 a[8:11], a[112:115], v[40:43], a[8:11]
    ds_read_b64_tr_b16 a[88:89], v10 offset:128
    v_mfma_f32_16x16x32_bf16 a[12:15], a[112:115], v[44:47], a[12:15]
    ds_read_b64_tr_b16 a[90:91], v10 offset:2432
    v_mfma_f32_16x16x32_bf16 a[16:19], a[116:119], v[40:43], a[16:19]
    ds_read_b64_tr_b16 a[92:93], v10 offset:160
    v_mfma_f32_16x16x32_bf16 a[20:23], a[116:119], v[44:47], a[20:23]
    ds_read_b64_tr_b16 a[94:95], v10 offset:2464
    v_mfma_f32_16x16x32_bf16 a[24:27], a[120:123], v[40:43], a[24:27]
    ds_read_b64_tr_b16 a[96:97], v10 offset:192
    v_mfma_f32_16x16x32_bf16 a[28:31], a[120:123], v[44:47], a[28:31]
    ds_read_b64_tr_b16 a[98:99], v10 offset:2496
    v_mfma_f32_16x16x32_bf16 a[32:35], a[124:127], v[40:43], a[32:35]
    ds_read_b64_tr_b16 a[100:101], v10 offset:224
    v_mfma_f32_16x16x32_bf16 a[36:39], a[124:127], v[44:47], a[36:39]
    ds_read_b64_tr_b16 a[102:103], v10 offset:2528
    v_mfma_f32_16x16x32_bf16 a[40:43], a[128:131], v[40:43], a[40:43]
    ds_read_b64_tr_b16 a[104:105], v10 offset:256
    v_mfma_f32_16x16x32_bf16 a[44:47], a[128:131], v[44:47], a[44:47]
    ds_read_b64_tr_b16 a[106:107], v10 offset:2560
    v_mfma_f32_16x16x32_bf16 a[48:51], a[132:135], v[40:43], a[48:51]
    ds_read_b64_tr_b16 a[144:145], v14 offset:0
    v_mfma_f32_16x16x32_bf16 a[52:55], a[132:135], v[44:47], a[52:55]
    ds_read_b64_tr_b16 a[146:147], v14 offset:2304
    v_mfma_f32_16x16x32_bf16 a[56:59], a[136:139], v[40:43], a[56:59]
    ds_read_b64_tr_b16 a[148:149], v14 offset:128
    v_mfma_f32_16x16x32_bf16 a[60:63], a[136:139], v[44:47], a[60:63]
    ds_read_b64_tr_b16 a[150:151], v14 offset:2432
    v_mfma_f32_16x16x32_bf16 a[64:67], a[140:143], v[40:43], a[64:67]
    ds_read_b64_tr_b16 a[152:153], v10 offset:256
    v_mfma_f32_16x16x32_bf16 a[68:71], a[140:143], v[44:47], a[68:71]
    ds_read_b64_tr_b16 a[154:155], v10 offset:2560
    s_waitcnt lgkmcnt(4)
    v_mfma_f32_16x16x32_bf16 a[156:159], a[144:147], a[168:171], a[156:159]
    s_waitcnt lgkmcnt(2)
    v_mfma_f32_16x16x32_bf16 a[160:163], a[148:151], a[168:171], a[160:163]
    s_waitcnt lgkmcnt(0)
    v_mfma_f32_16x16x32_bf16 a[164:167], a[152:155], a[168:171], a[164:167]
    v_mfma_f32_16x16x32_bf16 v[48:51], a[168:171], v[32:35], v[48:51]
    ds_read_b128 v[40:43], v21 offset:0
    ds_read_b128 v[44:47], v21 offset:2048
    v_mfma_f32_16x16x32_bf16 v[56:59], v[32:35], v[32:35], v[56:59]
    ds_read_b64_tr_b16 a[108:109], v10 offset:9216
    ds_read_b64_tr_b16 a[110:111], v10 offset:11520
    v_mfma_f32_16x16x32_bf16 v[52:55], a[168:171], v[36:39], v[52:55]
    ds_read_b64_tr_b16 a[112:113], v10 offset:9248
    ds_read_b64_tr_b16 a[114:115], v10 offset:11552
    v_mfma_f32_16x16x32_bf16 v[60:63], v[36:39], v[36:39], v[60:63]
    ds_read_b64_tr_b16 a[116:117], v10 offset:9280
    ds_read_b64_tr_b16 a[118:119], v10 offset:11584
    v_mfma_f32_16x16x32_bf16 a[0:3], a[72:75], v[32:35], a[0:3]
    ds_read_b64_tr_b16 a[120:121], v10 offset:9312
    v_mfma_f32_16x16x32_bf16 a[4:7], a[72:75], v[36:39], a[4:7]
    ds_read_b64_tr_b16 a[122:123], v10 offset:11616
    v_mfma_f32_16x16x32_bf16 a[8:11], a[76:79], v[32:35], a[8:11]
    ds_read_b64_tr_b16 a[124:125], v10 offset:9344
    v_mfma_f32_16x16x32_bf16 a[12:15], a[76:79], v[36:39], a[12:15]
    ds_read_b64_tr_b16 a[126:127], v10 offset:11648
    v_mfma_f32_16x16x32_bf16 a[16:19], a[80:83], v[32:35], a[16:19]
    ds_read_b64_tr_b16 a[128:129], v10 offset:9376
    v_mfma_f32_16x16x32_bf16 a[20:23], a[80:83], v[36:39], a[20:23]
    ds_read_b64_tr_b16 a[130:131], v10 offset:11680
    v_mfma_f32_16x16x32_bf16 a[24:27], a[84:87], v[32:35], a[24:27]
    ds_read_b64_tr_b16 a[132:133], v10 offset:9408
    v_mfma_f32_16x16x32_bf16 a[28:31], a[84:87], v[36:39], a[28:31]
    ds_read_b64_tr_b16 a[134:135], v10 offset:11712
    v_mfma_f32_16x16x32_bf16 a[32:35], a[88:91], v[32:35], a[32:35]
    ds_read_b64_tr_b16 a[136:137], v10 offset:9440
    v_mfma_f32_16x16x32_bf16 a[36:39], a[88:91], v[36:39], a[36:39]
    ds_read_b64_tr_b16 a[138:139], v10 offset:11744
    v_mfma_f32_16x16x32_bf16 a[40:43], a[92:95], v[32:35], a[40:43]
    ds_read_b64_tr_b16 a[140:141], v10 offset:9472
    v_mfma_f32_16x16x32_bf16 a[44:47], a[92:95], v[36:39], a[44:47]
    ds_read_b64_tr_b16 a[142:143], v10 offset:11776
    v_mfma_f32_16x16x32_bf16 a[48:51], a[96:99], v[32:35], a[48:51]
    ds_read_b64_tr_b16 a[144:145], v14 offset:9216
    v_mfma_f32_16x16x32_bf16 a[52:55], a[96:99], v[36:39], a[52:55]
    ds_read_b64_tr_b16 a[146:147], v14 offset:11520
    v_mfma_f32_16x16x32_bf16 a[56:59], a[100:103], v[32:35], a[56:59]
    ds_read_b64_tr_b16 a[148:149], v14 offset:9344
    v_mfma_f32_16x16x32_bf16 a[60:63], a[100:103], v[36:39], a[60:63]
    ds_read_b64_tr_b16 a[150:151], v14 offset:11648
    v_mfma_f32_16x16x32_bf16 a[64:67], a[104:107], v[32:35], a[64:67]
    ds_read_b64_tr_b16 a[152:153], v10 offset:9472
    v_mfma_f32_16x16x32_bf16 a[68:71], a[104:107], v[36:39], a[68:71]
    ds_read_b64_tr_b16 a[154:155], v10 offset:11776
    s_barrier
    s_waitcnt lgkmcnt(4)
    v_mfma_f32_16x16x32_bf16 a[156:159], a[144:147], a[168:171], a[156:159]
    s_waitcnt lgkmcnt(2)
    v_mfma_f32_16x16x32_bf16 a[160:163], a[148:151], a[168:171], a[160:163]
    s_waitcnt lgkmcnt(0)
    v_mfma_f32_16x16x32_bf16 a[164:167], a[152:155], a[168:171], a[164:167]
    v_mfma_f32_16x16x32_bf16 v[48:51], a[168:171], v[40:43], v[48:51]
    ds_read_b128 v[32:35], v22 offset:0
    ds_read_b128 v[36:39], v22 offset:2048
    v_mfma_f32_16x16x32_bf16 v[56:59], v[40:43], v[40:43], v[56:59]
    ds_read_b64_tr_b16 a[72:73], v11 offset:0
    ds_read_b64_tr_b16 a[74:75], v11 offset:2304
    v_mfma_f32_16x16x32_bf16 v[52:55], a[168:171], v[44:47], v[52:55]
    ds_read_b64_tr_b16 a[76:77], v11 offset:32
    ds_read_b64_tr_b16 a[78:79], v11 offset:2336
    v_mfma_f32_16x16x32_bf16 v[60:63], v[44:47], v[44:47], v[60:63]
    ds_read_b64_tr_b16 a[80:81], v11 offset:64
    ds_read_b64_tr_b16 a[82:83], v11 offset:2368
    v_mfma_f32_16x16x32_bf16 a[0:3], a[108:111], v[40:43], a[0:3]
    ds_read_b64_tr_b16 a[84:85], v11 offset:96
    v_mfma_f32_16x16x32_bf16 a[4:7], a[108:111], v[44:47], a[4:7]
    ds_read_b64_tr_b16 a[86:87], v11 offset:2400
    v_mfma_f32_16x16x32_bf16 a[8:11], a[112:115], v[40:43], a[8:11]
    ds_read_b64_tr_b16 a[88:89], v11 offset:128
    v_mfma_f32_16x16x32_bf16 a[12:15], a[112:115], v[44:47], a[12:15]
    ds_read_b64_tr_b16 a[90:91], v11 offset:2432
    v_mfma_f32_16x16x32_bf16 a[16:19], a[116:119], v[40:43], a[16:19]
    ds_read_b64_tr_b16 a[92:93], v11 offset:160
    v_mfma_f32_16x16x32_bf16 a[20:23], a[116:119], v[44:47], a[20:23]
    ds_read_b64_tr_b16 a[94:95], v11 offset:2464
    v_mfma_f32_16x16x32_bf16 a[24:27], a[120:123], v[40:43], a[24:27]
    ds_read_b64_tr_b16 a[96:97], v11 offset:192
    v_mfma_f32_16x16x32_bf16 a[28:31], a[120:123], v[44:47], a[28:31]
    ds_read_b64_tr_b16 a[98:99], v11 offset:2496
    v_mfma_f32_16x16x32_bf16 a[32:35], a[124:127], v[40:43], a[32:35]
    ds_read_b64_tr_b16 a[100:101], v11 offset:224
    v_mfma_f32_16x16x32_bf16 a[36:39], a[124:127], v[44:47], a[36:39]
    ds_read_b64_tr_b16 a[102:103], v11 offset:2528
    v_mfma_f32_16x16x32_bf16 a[40:43], a[128:131], v[40:43], a[40:43]
    ds_read_b64_tr_b16 a[104:105], v11 offset:256
    v_mfma_f32_16x16x32_bf16 a[44:47], a[128:131], v[44:47], a[44:47]
    ds_read_b64_tr_b16 a[106:107], v11 offset:2560
    v_mfma_f32_16x16x32_bf16 a[48:51], a[132:135], v[40:43], a[48:51]
    ds_read_b64_tr_b16 a[144:145], v15 offset:0
    v_mfma_f32_16x16x32_bf16 a[52:55], a[132:135], v[44:47], a[52:55]
    ds_read_b64_tr_b16 a[146:147], v15 offset:2304
    v_mfma_f32_16x16x32_bf16 a[56:59], a[136:139], v[40:43], a[56:59]
    ds_read_b64_tr_b16 a[148:149], v15 offset:128
    v_mfma_f32_16x16x32_bf16 a[60:63], a[136:139], v[44:47], a[60:63]
    ds_read_b64_tr_b16 a[150:151], v15 offset:2432
    v_mfma_f32_16x16x32_bf16 a[64:67], a[140:143], v[40:43], a[64:67]
    ds_read_b64_tr_b16 a[152:153], v11 offset:256
    v_mfma_f32_16x16x32_bf16 a[68:71], a[140:143], v[44:47], a[68:71]
    ds_read_b64_tr_b16 a[154:155], v11 offset:2560
    s_waitcnt lgkmcnt(4)
    v_mfma_f32_16x16x32_bf16 a[156:159], a[144:147], a[168:171], a[156:159]
    s_waitcnt lgkmcnt(2)
    v_mfma_f32_16x16x32_bf16 a[160:163], a[148:151], a[168:171], a[160:163]
    s_waitcnt lgkmcnt(0)
    v_mfma_f32_16x16x32_bf16 a[164:167], a[152:155], a[168:171], a[164:167]
    v_mfma_f32_16x16x32_bf16 v[48:51], a[168:171], v[32:35], v[48:51]
    ds_read_b128 v[40:43], v23 offset:0
    ds_read_b128 v[44:47], v23 offset:2048
    v_mfma_f32_16x16x32_bf16 v[56:59], v[32:35], v[32:35], v[56:59]
    ds_read_b64_tr_b16 a[108:109], v11 offset:9216
    ds_read_b64_tr_b16 a[110:111], v11 offset:11520
    v_mfma_f32_16x16x32_bf16 v[52:55], a[168:171], v[36:39], v[52:55]
    ds_read_b64_tr_b16 a[112:113], v11 offset:9248
    ds_read_b64_tr_b16 a[114:115], v11 offset:11552
    v_mfma_f32_16x16x32_bf16 v[60:63], v[36:39], v[36:39], v[60:63]
    ds_read_b64_tr_b16 a[116:117], v11 offset:9280
    ds_read_b64_tr_b16 a[118:119], v11 offset:11584
    v_mfma_f32_16x16x32_bf16 a[0:3], a[72:75], v[32:35], a[0:3]
    ds_read_b64_tr_b16 a[120:121], v11 offset:9312
    v_mfma_f32_16x16x32_bf16 a[4:7], a[72:75], v[36:39], a[4:7]
    ds_read_b64_tr_b16 a[122:123], v11 offset:11616
    v_mfma_f32_16x16x32_bf16 a[8:11], a[76:79], v[32:35], a[8:11]
    ds_read_b64_tr_b16 a[124:125], v11 offset:9344
    v_mfma_f32_16x16x32_bf16 a[12:15], a[76:79], v[36:39], a[12:15]
    ds_read_b64_tr_b16 a[126:127], v11 offset:11648
    v_mfma_f32_16x16x32_bf16 a[16:19], a[80:83], v[32:35], a[16:19]
    ds_read_b64_tr_b16 a[128:129], v11 offset:9376
    v_mfma_f32_16x16x32_bf16 a[20:23], a[80:83], v[36:39], a[20:23]
    ds_read_b64_tr_b16 a[130:131], v11 offset:11680
    v_mfma_f32_16x16x32_bf16 a[24:27], a[84:87], v[32:35], a[24:27]
    ds_read_b64_tr_b16 a[132:133], v11 offset:9408
    v_mfma_f32_16x16x32_bf16 a[28:31], a[84:87], v[36:39], a[28:31]
    ds_read_b64_tr_b16 a[134:135], v11 offset:11712
    v_mfma_f32_16x16x32_bf16 a[32:35], a[88:91], v[32:35], a[32:35]
    ds_read_b64_tr_b16 a[136:137], v11 offset:9440
    v_mfma_f32_16x16x32_bf16 a[36:39], a[88:91], v[36:39], a[36:39]
    ds_read_b64_tr_b16 a[138:139], v11 offset:11744
    v_mfma_f32_16x16x32_bf16 a[40:43], a[92:95], v[32:35], a[40:43]
    ds_read_b64_tr_b16 a[140:141], v11 offset:9472
    v_mfma_f32_16x16x32_bf16 a[44:47], a[92:95], v[36:39], a[44:47]
    ds_read_b64_tr_b16 a[142:143], v11 offset:11776
    v_mfma_f32_16x16x32_bf16 a[48:51], a[96:99], v[32:35], a[48:51]
    ds_read_b64_tr_b16 a[144:145], v15 offset:9216
    v_mfma_f32_16x16x32_bf16 a[52:55], a[96:99], v[36:39], a[52:55]
    ds_read_b64_tr_b16 a[146:147], v15 offset:11520
    v_mfma_f32_16x16x32_bf16 a[56:59], a[100:103], v[32:35], a[56:59]
    ds_read_b64_tr_b16 a[148:149], v15 offset:9344
    v_mfma_f32_16x16x32_bf16 a[60:63], a[100:103], v[36:39], a[60:63]
    ds_read_b64_tr_b16 a[150:151], v15 offset:11648
    v_mfma_f32_16x16x32_bf16 a[64:67], a[104:107], v[32:35], a[64:67]
    ds_read_b64_tr_b16 a[152:153], v11 offset:9472
    v_mfma_f32_16x16x32_bf16 a[68:71], a[104:107], v[36:39], a[68:71]
    ds_read_b64_tr_b16 a[154:155], v11 offset:11776
    s_barrier
    s_waitcnt lgkmcnt(4)
    v_mfma_f32_16x16x32_bf16 a[156:159], a[144:147], a[168:171], a[156:159]
    s_waitcnt lgkmcnt(2)
    v_mfma_f32_16x16x32_bf16 a[160:163], a[148:151], a[168:171], a[160:163]
    s_waitcnt lgkmcnt(0)
    v_mfma_f32_16x16x32_bf16 a[164:167], a[152:155], a[168:171], a[164:167]
    v_mfma_f32_16x16x32_bf16 v[48:51], a[168:171], v[40:43], v[48:51]
    ds_read_b128 v[32:35], v16 offset:0
    ds_read_b128 v[36:39], v16 offset:2048
    v_mfma_f32_16x16x32_bf16 v[56:59], v[40:43], v[40:43], v[56:59]
    ds_read_b64_tr_b16 a[72:73], v8 offset:0
    ds_read_b64_tr_b16 a[74:75], v8 offset:2304
    v_mfma_f32_16x16x32_bf16 v[52:55], a[168:171], v[44:47], v[52:55]
    ds_read_b64_tr_b16 a[76:77], v8 offset:32
    ds_read_b64_tr_b16 a[78:79], v8 offset:2336
    v_mfma_f32_16x16x32_bf16 v[60:63], v[44:47], v[44:47], v[60:63]
    ds_read_b64_tr_b16 a[80:81], v8 offset:64
    ds_read_b64_tr_b16 a[82:83], v8 offset:2368
    v_mfma_f32_16x16x32_bf16 a[0:3], a[108:111], v[40:43], a[0:3]
    ds_read_b64_tr_b16 a[84:85], v8 offset:96
    v_mfma_f32_16x16x32_bf16 a[4:7], a[108:111], v[44:47], a[4:7]
    ds_read_b64_tr_b16 a[86:87], v8 offset:2400
    v_mfma_f32_16x16x32_bf16 a[8:11], a[112:115], v[40:43], a[8:11]
    ds_read_b64_tr_b16 a[88:89], v8 offset:128
    v_mfma_f32_16x16x32_bf16 a[12:15], a[112:115], v[44:47], a[12:15]
    ds_read_b64_tr_b16 a[90:91], v8 offset:2432
    v_mfma_f32_16x16x32_bf16 a[16:19], a[116:119], v[40:43], a[16:19]
    ds_read_b64_tr_b16 a[92:93], v8 offset:160
    v_mfma_f32_16x16x32_bf16 a[20:23], a[116:119], v[44:47], a[20:23]
    ds_read_b64_tr_b16 a[94:95], v8 offset:2464
    v_mfma_f32_16x16x32_bf16 a[24:27], a[120:123], v[40:43], a[24:27]
    ds_read_b64_tr_b16 a[96:97], v8 offset:192
    v_mfma_f32_16x16x32_bf16 a[28:31], a[120:123], v[44:47], a[28:31]
    ds_read_b64_tr_b16 a[98:99], v8 offset:2496
    v_mfma_f32_16x16x32_bf16 a[32:35], a[124:127], v[40:43], a[32:35]
    ds_read_b64_tr_b16 a[100:101], v8 offset:224
    v_mfma_f32_16x16x32_bf16 a[36:39], a[124:127], v[44:47], a[36:39]
    ds_read_b64_tr_b16 a[102:103], v8 offset:2528
    v_mfma_f32_16x16x32_bf16 a[40:43], a[128:131], v[40:43], a[40:43]
    ds_read_b64_tr_b16 a[104:105], v8 offset:256
    v_mfma_f32_16x16x32_bf16 a[44:47], a[128:131], v[44:47], a[44:47]
    ds_read_b64_tr_b16 a[106:107], v8 offset:2560
    v_mfma_f32_16x16x32_bf16 a[48:51], a[132:135], v[40:43], a[48:51]
    ds_read_b64_tr_b16 a[144:145], v12 offset:0
    v_mfma_f32_16x16x32_bf16 a[52:55], a[132:135], v[44:47], a[52:55]
    ds_read_b64_tr_b16 a[146:147], v12 offset:2304
    v_mfma_f32_16x16x32_bf16 a[56:59], a[136:139], v[40:43], a[56:59]
    ds_read_b64_tr_b16 a[148:149], v12 offset:128
    v_mfma_f32_16x16x32_bf16 a[60:63], a[136:139], v[44:47], a[60:63]
    ds_read_b64_tr_b16 a[150:151], v12 offset:2432
    v_mfma_f32_16x16x32_bf16 a[64:67], a[140:143], v[40:43], a[64:67]
    ds_read_b64_tr_b16 a[152:153], v8 offset:256
    v_mfma_f32_16x16x32_bf16 a[68:71], a[140:143], v[44:47], a[68:71]
    ds_read_b64_tr_b16 a[154:155], v8 offset:2560
    s_waitcnt lgkmcnt(4)
    v_mfma_f32_16x16x32_bf16 a[156:159], a[144:147], a[168:171], a[156:159]
    s_waitcnt lgkmcnt(2)
    v_mfma_f32_16x16x32_bf16 a[160:163], a[148:151], a[168:171], a[160:163]
    s_waitcnt lgkmcnt(0)
    v_mfma_f32_16x16x32_bf16 a[164:167], a[152:155], a[168:171], a[164:167]
    v_mfma_f32_16x16x32_bf16 v[48:51], a[168:171], v[32:35], v[48:51]
    ds_read_b128 v[40:43], v17 offset:0
    ds_read_b128 v[44:47], v17 offset:2048
    v_mfma_f32_16x16x32_bf16 v[56:59], v[32:35], v[32:35], v[56:59]
    ds_read_b64_tr_b16 a[108:109], v8 offset:9216
    ds_read_b64_tr_b16 a[110:111], v8 offset:11520
    v_mfma_f32_16x16x32_bf16 v[52:55], a[168:171], v[36:39], v[52:55]
    ds_read_b64_tr_b16 a[112:113], v8 offset:9248
    ds_read_b64_tr_b16 a[114:115], v8 offset:11552
    v_mfma_f32_16x16x32_bf16 v[60:63], v[36:39], v[36:39], v[60:63]
    ds_read_b64_tr_b16 a[116:117], v8 offset:9280
    ds_read_b64_tr_b16 a[118:119], v8 offset:11584
    v_mfma_f32_16x16x32_bf16 a[0:3], a[72:75], v[32:35], a[0:3]
    ds_read_b64_tr_b16 a[120:121], v8 offset:9312
    v_mfma_f32_16x16x32_bf16 a[4:7], a[72:75], v[36:39], a[4:7]
    ds_read_b64_tr_b16 a[122:123], v8 offset:11616
    v_mfma_f32_16x16x32_bf16 a[8:11], a[76:79], v[32:35], a[8:11]
    ds_read_b64_tr_b16 a[124:125], v8 offset:9344
    v_mfma_f32_16x16x32_bf16 a[12:15], a[76:79], v[36:39], a[12:15]
    ds_read_b64_tr_b16 a[126:127], v8 offset:11648
    v_mfma_f32_16x16x32_bf16 a[16:19], a[80:83], v[32:35], a[16:19]
    ds_read_b64_tr_b16 a[128:129], v8 offset:9376
    v_mfma_f32_16x16x32_bf16 a[20:23], a[80:83], v[36:39], a[20:23]
    ds_read_b64_tr_b16 a[130:131], v8 offset:11680
    v_mfma_f32_16x16x32_bf16 a[24:27], a[84:87], v[32:35], a[24:27]
    ds_read_b64_tr_b16 a[132:133], v8 offset:9408
    v_mfma_f32_16x16x32_bf16 a[28:31], a[84:87], v[36:39], a[28:31]
    ds_read_b64_tr_b16 a[134:135], v8 offset:11712
    v_mfma_f32_16x16x32_bf16 a[32:35], a[88:91], v[32:35], a[32:35]
    ds_read_b64_tr_b16 a[136:137], v8 offset:9440
    v_mfma_f32_16x16x32_bf16 a[36:39], a[88:91], v[36:39], a[36:39]
    ds_read_b64_tr_b16 a[138:139], v8 offset:11744
    v_mfma_f32_16x16x32_bf16 a[40:43], a[92:95], v[32:35], a[40:43]
    ds_read_b64_tr_b16 a[140:141], v8 offset:9472
    v_mfma_f32_16x16x32_bf16 a[44:47], a[92:95], v[36:39], a[44:47]
    ds_read_b64_tr_b16 a[142:143], v8 offset:11776
    v_mfma_f32_16x16x32_bf16 a[48:51], a[96:99], v[32:35], a[48:51]
    ds_read_b64_tr_b16 a[144:145], v12 offset:9216
    v_mfma_f32_16x16x32_bf16 a[52:55], a[96:99], v[36:39], a[52:55]
    ds_read_b64_tr_b16 a[146:147], v12 offset:11520
    v_mfma_f32_16x16x32_bf16 a[56:59], a[100:103], v[32:35], a[56:59]
    ds_read_b64_tr_b16 a[148:149], v12 offset:9344
    v_mfma_f32_16x16x32_bf16 a[60:63], a[100:103], v[36:39], a[60:63]
    ds_read_b64_tr_b16 a[150:151], v12 offset:11648
    v_mfma_f32_16x16x32_bf16 a[64:67], a[104:107], v[32:35], a[64:67]
    ds_read_b64_tr_b16 a[152:153], v8 offset:9472
    v_mfma_f32_16x16x32_bf16 a[68:71], a[104:107], v[36:39], a[68:71]
    ds_read_b64_tr_b16 a[154:155], v8 offset:11776
    s_waitcnt lgkmcnt(4)
    v_mfma_f32_16x16x32_bf16 a[156:159], a[144:147], a[168:171], a[156:159]
    s_waitcnt lgkmcnt(2)
    v_mfma_f32_16x16x32_bf16 a[160:163], a[148:151], a[168:171], a[160:163]
    s_waitcnt lgkmcnt(0)
    v_mfma_f32_16x16x32_bf16 a[164:167], a[152:155], a[168:171], a[164:167]
    v_mfma_f32_16x16x32_bf16 v[48:51], a[168:171], v[40:43], v[48:51]
    v_mfma_f32_16x16x32_bf16 v[56:59], v[40:43], v[40:43], v[56:59]
    v_mfma_f32_16x16x32_bf16 v[52:55], a[168:171], v[44:47], v[52:55]
    v_mfma_f32_16x16x32_bf16 v[60:63], v[44:47], v[44:47], v[60:63]
    v_mfma_f32_16x16x32_bf16 a[0:3], a[108:111], v[40:43], a[0:3]
    v_mfma_f32_16x16x32_bf16 a[4:7], a[108:111], v[44:47], a[4:7]
    v_mfma_f32_16x16x32_bf16 a[8:11], a[112:115], v[40:43], a[8:11]
    v_mfma_f32_16x16x32_bf16 a[12:15], a[112:115], v[44:47], a[12:15]
    v_mfma_f32_16x16x32_bf16 a[16:19], a[116:119], v[40:43], a[16:19]
    v_mfma_f32_16x16x32_bf16 a[20:23], a[116:119], v[44:47], a[20:23]
    v_mfma_f32_16x16x32_bf16 a[24:27], a[120:123], v[40:43], a[24:27]
    v_mfma_f32_16x16x32_bf16 a[28:31], a[120:123], v[44:47], a[28:31]
    v_mfma_f32_16x16x32_bf16 a[32:35], a[124:127], v[40:43], a[32:35]
    v_mfma_f32_16x16x32_bf16 a[36:39], a[124:127], v[44:47], a[36:39]
    v_mfma_f32_16x16x32_bf16 a[40:43], a[128:131], v[40:43], a[40:43]
    v_mfma_f32_16x16x32_bf16 a[44:47], a[128:131], v[44:47], a[44:47]
    v_mfma_f32_16x16x32_bf16 a[48:51], a[132:135], v[40:43], a[48:51]
    v_mfma_f32_16x16x32_bf16 a[52:55], a[132:135], v[44:47], a[52:55]
    v_mfma_f32_16x16x32_bf16 a[56:59], a[136:139], v[40:43], a[56:59]
    v_mfma_f32_16x16x32_bf16 a[60:63], a[136:139], v[44:47], a[60:63]
    v_mfma_f32_16x16x32_bf16 a[64:67], a[140:143], v[40:43], a[64:67]
    v_mfma_f32_16x16x32_bf16 a[68:71], a[140:143], v[44:47], a[68:71]
    v_mov_b32 v24, v48
    v_and_b32 v5, 3, v3
    v_mov_b32 v26, v56
    v_cmp_eq_u32 vcc, 1, v5
    s_nop 1
    v_cndmask_b32 v26, v26, v57, vcc
    v_cmp_eq_u32 vcc, 2, v5
    s_nop 1
    v_cndmask_b32 v26, v26, v58, vcc
    v_cmp_eq_u32 vcc, 3, v5
    s_nop 1
    v_cndmask_b32 v26, v26, v59, vcc
    v_lshrrev_b32 v5, 2, v3
    v_cmp_eq_u32 vcc, v5, v4
    s_nop 1
    v_cndmask_b32 v26, 0, v26, vcc
    v_mov_b32 v27, v26
    s_nop 1
    v_permlane16_swap_b32 v26, v27
    v_add_f32 v26, v26, v27
    v_mov_b32 v27, v26
    s_nop 1
    v_permlane32_swap_b32 v26, v27
    v_add_f32 v26, v26, v27
    v_mul_f32 v25, 0x3ae38e39, v24
    v_mul_f32 v26, 0x3ae38e39, v26
    v_fma_f32 v26, -v25, v25, v26
    v_max_f32 v26, 0, v26
    v_add_f32 v26, 0x3727c5ac, v26
    v_rsq_f32 v24, v26
    s_nop 0
    v_mul_f32 v24, s50, v24
    v_mul_f32 v25, v25, v24
    v_sub_f32 v25, 0, v25
    v_mov_b32 v28, v52
    v_and_b32 v5, 3, v3
    v_mov_b32 v30, v60
    v_cmp_eq_u32 vcc, 1, v5
    s_nop 1
    v_cndmask_b32 v30, v30, v61, vcc
    v_cmp_eq_u32 vcc, 2, v5
    s_nop 1
    v_cndmask_b32 v30, v30, v62, vcc
    v_cmp_eq_u32 vcc, 3, v5
    s_nop 1
    v_cndmask_b32 v30, v30, v63, vcc
    v_lshrrev_b32 v5, 2, v3
    v_cmp_eq_u32 vcc, v5, v4
    s_nop 1
    v_cndmask_b32 v30, 0, v30, vcc
    v_mov_b32 v31, v30
    s_nop 1
    v_permlane16_swap_b32 v30, v31
    v_add_f32 v30, v30, v31
    v_mov_b32 v31, v30
    s_nop 1
    v_permlane32_swap_b32 v30, v31
    v_add_f32 v30, v30, v31
    v_mul_f32 v29, 0x3ae38e39, v28
    v_mul_f32 v30, 0x3ae38e39, v30
    v_fma_f32 v30, -v29, v29, v30
    v_max_f32 v30, 0, v30
    v_add_f32 v30, 0x3727c5ac, v30
    v_rsq_f32 v28, v30
    s_nop 0
    v_mul_f32 v28, s50, v28
    v_mul_f32 v29, v29, v28
    v_sub_f32 v29, 0, v29
    v_lshlrev_b32 v5, 4, v4
    s_lshl_b32 s53, s38, 6
    s_add_u32 s53, s53, 139264
    v_add_u32 v6, s53, v5
    v_add_u32 v7, 139776, v5
    ds_write_b128 v6, a[156:159]
    ds_write_b128 v6, a[160:163] offset:256
    ds_write_b128 v7, a[164:167]
    s_waitcnt lgkmcnt(0)
    s_barrier
    v_lshlrev_b32 v5, 4, v4
    v_add_u32 v5, 139264, v5
    ds_read_b128 v[32:35], v5
    ds_read_b128 v[36:39], v5 offset:64
    v_and_b32 v8, 0xffff, v64
    v_lshrrev_b32 v9, 16, v64
    v_and_b32 v10, 0xffff, v65
    v_lshrrev_b32 v11, 16, v65
    v_accvgpr_read_b32 v40, a0
    v_accvgpr_read_b32 v41, a1
    v_accvgpr_read_b32 v42, a2
    v_accvgpr_read_b32 v43, a3
    s_waitcnt lgkmcnt(1)
    v_mul_f32 v44, v25, v32
    v_mul_f32 v45, v25, v33
    v_mul_f32 v46, v25, v34
    v_mul_f32 v47, v25, v35
    v_fma_f32 v40, v40, v24, v44
    v_fma_f32 v41, v41, v24, v45
    v_fma_f32 v42, v42, v24, v46
    v_fma_f32 v43, v43, v24, v47
    v_cvt_pk_bf16_f32 v44, v40, v41
    ds_write_b32 v8, v44
    v_cvt_pk_bf16_f32 v45, v42, v43
    ds_write_b32 v10, v45
    v_accvgpr_read_b32 v48, a4
    v_accvgpr_read_b32 v49, a5
    v_accvgpr_read_b32 v50, a6
    v_accvgpr_read_b32 v51, a7
    v_mul_f32 v52, v29, v32
    v_mul_f32 v53, v29, v33
    v_mul_f32 v54, v29, v34
    v_mul_f32 v55, v29, v35
    v_fma_f32 v48, v48, v28, v52
    v_fma_f32 v49, v49, v28, v53
    v_fma_f32 v50, v50, v28, v54
    v_fma_f32 v51, v51, v28, v55
    v_cvt_pk_bf16_f32 v52, v48, v49
    ds_write_b32 v9, v52
    v_cvt_pk_bf16_f32 v53, v50, v51
    ds_write_b32 v11, v53
    ds_read_b128 v[32:35], v5 offset:128
    v_and_b32 v8, 0xffff, v66
    v_lshrrev_b32 v9, 16, v66
    v_and_b32 v10, 0xffff, v67
    v_lshrrev_b32 v11, 16, v67
    v_accvgpr_read_b32 v40, a8
    v_accvgpr_read_b32 v41, a9
    v_accvgpr_read_b32 v42, a10
    v_accvgpr_read_b32 v43, a11
    s_waitcnt lgkmcnt(5)
    v_mul_f32 v44, v25, v36
    v_mul_f32 v45, v25, v37
    v_mul_f32 v46, v25, v38
    v_mul_f32 v47, v25, v39
    v_fma_f32 v40, v40, v24, v44
    v_fma_f32 v41, v41, v24, v45
    v_fma_f32 v42, v42, v24, v46
    v_fma_f32 v43, v43, v24, v47
    v_cvt_pk_bf16_f32 v44, v40, v41
    ds_write_b32 v8, v44
    v_cvt_pk_bf16_f32 v45, v42, v43
    ds_write_b32 v10, v45
    v_accvgpr_read_b32 v48, a12
    v_accvgpr_read_b32 v49, a13
    v_accvgpr_read_b32 v50, a14
    v_accvgpr_read_b32 v51, a15
    v_mul_f32 v52, v29, v36
    v_mul_f32 v53, v29, v37
    v_mul_f32 v54, v29, v38
    v_mul_f32 v55, v29, v39
    v_fma_f32 v48, v48, v28, v52
    v_fma_f32 v49, v49, v28, v53
    v_fma_f32 v50, v50, v28, v54
    v_fma_f32 v51, v51, v28, v55
    v_cvt_pk_bf16_f32 v52, v48, v49
    ds_write_b32 v9, v52
    v_cvt_pk_bf16_f32 v53, v50, v51
    ds_write_b32 v11, v53
    ds_read_b128 v[36:39], v5 offset:192
    v_and_b32 v8, 0xffff, v68
    v_lshrrev_b32 v9, 16, v68
    v_and_b32 v10, 0xffff, v69
    v_lshrrev_b32 v11, 16, v69
    v_accvgpr_read_b32 v40, a16
    v_accvgpr_read_b32 v41, a17
    v_accvgpr_read_b32 v42, a18
    v_accvgpr_read_b32 v43, a19
    s_waitcnt lgkmcnt(5)
    v_mul_f32 v44, v25, v32
    v_mul_f32 v45, v25, v33
    v_mul_f32 v46, v25, v34
    v_mul_f32 v47, v25, v35
    v_fma_f32 v40, v40, v24, v44
    v_fma_f32 v41, v41, v24, v45
    v_fma_f32 v42, v42, v24, v46
    v_fma_f32 v43, v43, v24, v47
    v_cvt_pk_bf16_f32 v44, v40, v41
    ds_write_b32 v8, v44
    v_cvt_pk_bf16_f32 v45, v42, v43
    ds_write_b32 v10, v45
    v_accvgpr_read_b32 v48, a20
    v_accvgpr_read_b32 v49, a21
    v_accvgpr_read_b32 v50, a22
    v_accvgpr_read_b32 v51, a23
    v_mul_f32 v52, v29, v32
    v_mul_f32 v53, v29, v33
    v_mul_f32 v54, v29, v34
    v_mul_f32 v55, v29, v35
    v_fma_f32 v48, v48, v28, v52
    v_fma_f32 v49, v49, v28, v53
    v_fma_f32 v50, v50, v28, v54
    v_fma_f32 v51, v51, v28, v55
    v_cvt_pk_bf16_f32 v52, v48, v49
    ds_write_b32 v9, v52
    v_cvt_pk_bf16_f32 v53, v50, v51
    ds_write_b32 v11, v53
    ds_read_b128 v[32:35], v5 offset:256
    v_and_b32 v8, 0xffff, v70
    v_lshrrev_b32 v9, 16, v70
    v_and_b32 v10, 0xffff, v71
    v_lshrrev_b32 v11, 16, v71
    v_accvgpr_read_b32 v40, a24
    v_accvgpr_read_b32 v41, a25
    v_accvgpr_read_b32 v42, a26
    v_accvgpr_read_b32 v43, a27
    s_waitcnt lgkmcnt(5)
    v_mul_f32 v44, v25, v36
    v_mul_f32 v45, v25, v37
    v_mul_f32 v46, v25, v38
    v_mul_f32 v47, v25, v39
    v_fma_f32 v40, v40, v24, v44
    v_fma_f32 v41, v41, v24, v45
    v_fma_f32 v42, v42, v24, v46
    v_fma_f32 v43, v43, v24, v47
    v_cvt_pk_bf16_f32 v44, v40, v41
    ds_write_b32 v8, v44
    v_cvt_pk_bf16_f32 v45, v42, v43
    ds_write_b32 v10, v45
    v_accvgpr_read_b32 v48, a28
    v_accvgpr_read_b32 v49, a29
    v_accvgpr_read_b32 v50, a30
    v_accvgpr_read_b32 v51, a31
    v_mul_f32 v52, v29, v36
    v_mul_f32 v53, v29, v37
    v_mul_f32 v54, v29, v38
    v_mul_f32 v55, v29, v39
    v_fma_f32 v48, v48, v28, v52
    v_fma_f32 v49, v49, v28, v53
    v_fma_f32 v50, v50, v28, v54
    v_fma_f32 v51, v51, v28, v55
    v_cvt_pk_bf16_f32 v52, v48, v49
    ds_write_b32 v9, v52
    v_cvt_pk_bf16_f32 v53, v50, v51
    ds_write_b32 v11, v53
    ds_read_b128 v[36:39], v5 offset:320
    v_and_b32 v8, 0xffff, v72
    v_lshrrev_b32 v9, 16, v72
    v_and_b32 v10, 0xffff, v73
    v_lshrrev_b32 v11, 16, v73
    v_accvgpr_read_b32 v40, a32
    v_accvgpr_read_b32 v41, a33
    v_accvgpr_read_b32 v42, a34
    v_accvgpr_read_b32 v43, a35
    s_waitcnt lgkmcnt(5)
    v_mul_f32 v44, v25, v32
    v_mul_f32 v45, v25, v33
    v_mul_f32 v46, v25, v34
    v_mul_f32 v47, v25, v35
    v_fma_f32 v40, v40, v24, v44
    v_fma_f32 v41, v41, v24, v45
    v_fma_f32 v42, v42, v24, v46
    v_fma_f32 v43, v43, v24, v47
    v_cvt_pk_bf16_f32 v44, v40, v41
    ds_write_b32 v8, v44
    v_cvt_pk_bf16_f32 v45, v42, v43
    ds_write_b32 v10, v45
    v_accvgpr_read_b32 v48, a36
    v_accvgpr_read_b32 v49, a37
    v_accvgpr_read_b32 v50, a38
    v_accvgpr_read_b32 v51, a39
    v_mul_f32 v52, v29, v32
    v_mul_f32 v53, v29, v33
    v_mul_f32 v54, v29, v34
    v_mul_f32 v55, v29, v35
    v_fma_f32 v48, v48, v28, v52
    v_fma_f32 v49, v49, v28, v53
    v_fma_f32 v50, v50, v28, v54
    v_fma_f32 v51, v51, v28, v55
    v_cvt_pk_bf16_f32 v52, v48, v49
    ds_write_b32 v9, v52
    v_cvt_pk_bf16_f32 v53, v50, v51
    ds_write_b32 v11, v53
    ds_read_b128 v[32:35], v5 offset:384
    v_and_b32 v8, 0xffff, v74
    v_lshrrev_b32 v9, 16, v74
    v_and_b32 v10, 0xffff, v75
    v_lshrrev_b32 v11, 16, v75
    v_accvgpr_read_b32 v40, a40
    v_accvgpr_read_b32 v41, a41
    v_accvgpr_read_b32 v42, a42
    v_accvgpr_read_b32 v43, a43
    s_waitcnt lgkmcnt(5)
    v_mul_f32 v44, v25, v36
    v_mul_f32 v45, v25, v37
    v_mul_f32 v46, v25, v38
    v_mul_f32 v47, v25, v39
    v_fma_f32 v40, v40, v24, v44
    v_fma_f32 v41, v41, v24, v45
    v_fma_f32 v42, v42, v24, v46
    v_fma_f32 v43, v43, v24, v47
    v_cvt_pk_bf16_f32 v44, v40, v41
    ds_write_b32 v8, v44
    v_cvt_pk_bf16_f32 v45, v42, v43
    ds_write_b32 v10, v45
    v_accvgpr_read_b32 v48, a44
    v_accvgpr_read_b32 v49, a45
    v_accvgpr_read_b32 v50, a46
    v_accvgpr_read_b32 v51, a47
    v_mul_f32 v52, v29, v36
    v_mul_f32 v53, v29, v37
    v_mul_f32 v54, v29, v38
    v_mul_f32 v55, v29, v39
    v_fma_f32 v48, v48, v28, v52
    v_fma_f32 v49, v49, v28, v53
    v_fma_f32 v50, v50, v28, v54
    v_fma_f32 v51, v51, v28, v55
    v_cvt_pk_bf16_f32 v52, v48, v49
    ds_write_b32 v9, v52
    v_cvt_pk_bf16_f32 v53, v50, v51
    ds_write_b32 v11, v53
    ds_read_b128 v[36:39], v5 offset:448
    v_and_b32 v8, 0xffff, v76
    v_lshrrev_b32 v9, 16, v76
    v_and_b32 v10, 0xffff, v77
    v_lshrrev_b32 v11, 16, v77
    v_accvgpr_read_b32 v40, a48
    v_accvgpr_read_b32 v41, a49
    v_accvgpr_read_b32 v42, a50
    v_accvgpr_read_b32 v43, a51
    s_waitcnt lgkmcnt(5)
    v_mul_f32 v44, v25, v32
    v_mul_f32 v45, v25, v33
    v_mul_f32 v46, v25, v34
    v_mul_f32 v47, v25, v35
    v_fma_f32 v40, v40, v24, v44
    v_fma_f32 v41, v41, v24, v45
    v_fma_f32 v42, v42, v24, v46
    v_fma_f32 v43, v43, v24, v47
    v_cvt_pk_bf16_f32 v44, v40, v41
    ds_write_b32 v8, v44
    v_cvt_pk_bf16_f32 v45, v42, v43
    ds_write_b32 v10, v45
    v_accvgpr_read_b32 v48, a52
    v_accvgpr_read_b32 v49, a53
    v_accvgpr_read_b32 v50, a54
    v_accvgpr_read_b32 v51, a55
    v_mul_f32 v52, v29, v32
    v_mul_f32 v53, v29, v33
    v_mul_f32 v54, v29, v34
    v_mul_f32 v55, v29, v35
    v_fma_f32 v48, v48, v28, v52
    v_fma_f32 v49, v49, v28, v53
    v_fma_f32 v50, v50, v28, v54
    v_fma_f32 v51, v51, v28, v55
    v_cvt_pk_bf16_f32 v52, v48, v49
    ds_write_b32 v9, v52
    v_cvt_pk_bf16_f32 v53, v50, v51
    ds_write_b32 v11, v53
    ds_read_b128 v[32:35], v5 offset:512
    v_and_b32 v8, 0xffff, v78
    v_lshrrev_b32 v9, 16, v78
    v_and_b32 v10, 0xffff, v79
    v_lshrrev_b32 v11, 16, v79
    v_accvgpr_read_b32 v40, a56
    v_accvgpr_read_b32 v41, a57
    v_accvgpr_read_b32 v42, a58
    v_accvgpr_read_b32 v43, a59
    s_waitcnt lgkmcnt(5)
    v_mul_f32 v44, v25, v36
    v_mul_f32 v45, v25, v37
    v_mul_f32 v46, v25, v38
    v_mul_f32 v47, v25, v39
    v_fma_f32 v40, v40, v24, v44
    v_fma_f32 v41, v41, v24, v45
    v_fma_f32 v42, v42, v24, v46
    v_fma_f32 v43, v43, v24, v47
    v_cvt_pk_bf16_f32 v44, v40, v41
    ds_write_b32 v8, v44
    v_cvt_pk_bf16_f32 v45, v42, v43
    ds_write_b32 v10, v45
    v_accvgpr_read_b32 v48, a60
    v_accvgpr_read_b32 v49, a61
    v_accvgpr_read_b32 v50, a62
    v_accvgpr_read_b32 v51, a63
    v_mul_f32 v52, v29, v36
    v_mul_f32 v53, v29, v37
    v_mul_f32 v54, v29, v38
    v_mul_f32 v55, v29, v39
    v_fma_f32 v48, v48, v28, v52
    v_fma_f32 v49, v49, v28, v53
    v_fma_f32 v50, v50, v28, v54
    v_fma_f32 v51, v51, v28, v55
    v_cvt_pk_bf16_f32 v52, v48, v49
    ds_write_b32 v9, v52
    v_cvt_pk_bf16_f32 v53, v50, v51
    ds_write_b32 v11, v53
    v_and_b32 v8, 0xffff, v80
    v_lshrrev_b32 v9, 16, v80
    v_and_b32 v10, 0xffff, v81
    v_lshrrev_b32 v11, 16, v81
    v_accvgpr_read_b32 v40, a64
    v_accvgpr_read_b32 v41, a65
    v_accvgpr_read_b32 v42, a66
    v_accvgpr_read_b32 v43, a67
    s_waitcnt lgkmcnt(4)
    v_mul_f32 v44, v25, v32
    v_mul_f32 v45, v25, v33
    v_mul_f32 v46, v25, v34
    v_mul_f32 v47, v25, v35
    v_fma_f32 v40, v40, v24, v44
    v_fma_f32 v41, v41, v24, v45
    v_fma_f32 v42, v42, v24, v46
    v_fma_f32 v43, v43, v24, v47
    v_cvt_pk_bf16_f32 v44, v40, v41
    ds_write_b32 v8, v44
    v_cvt_pk_bf16_f32 v45, v42, v43
    ds_write_b32 v10, v45
    v_accvgpr_read_b32 v48, a68
    v_accvgpr_read_b32 v49, a69
    v_accvgpr_read_b32 v50, a70
    v_accvgpr_read_b32 v51, a71
    v_mul_f32 v52, v29, v32
    v_mul_f32 v53, v29, v33
    v_mul_f32 v54, v29, v34
    v_mul_f32 v55, v29, v35
    v_fma_f32 v48, v48, v28, v52
    v_fma_f32 v49, v49, v28, v53
    v_fma_f32 v50, v50, v28, v54
    v_fma_f32 v51, v51, v28, v55
    v_cvt_pk_bf16_f32 v52, v48, v49
    ds_write_b32 v9, v52
    v_cvt_pk_bf16_f32 v53, v50, v51
    ds_write_b32 v11, v53
    v_lshlrev_b32 v8, 4, v2
    v_add_u32 v9, s52, v8
    v_lshrrev_b32 v10, 3, v2
    v_mul_lo_u32 v10, v10, s49
    v_and_b32 v11, 7, v2
    v_lshl_add_u32 v10, v11, 4, v10
    s_waitcnt lgkmcnt(0)
    ds_read_b128 v[32:35], v9 offset:0
    ds_read_b128 v[36:39], v9 offset:1024
    ds_read_b128 v[40:43], v9 offset:2048
    ds_read_b128 v[44:47], v9 offset:3072
    ds_read_b128 v[48:51], v9 offset:4096
    ds_read_b128 v[52:55], v9 offset:5120
    ds_read_b128 v[56:59], v9 offset:6144
    ds_read_b128 v[60:63], v9 offset:7168
    ds_read_b128 v[64:67], v9 offset:8192
    s_waitcnt lgkmcnt(8)
    buffer_store_dwordx4 v[32:35], v8, s[16:19], s46 offen
    s_add_u32 s46, s46, s47
    s_waitcnt lgkmcnt(7)
    buffer_store_dwordx4 v[36:39], v8, s[16:19], s46 offen
    s_add_u32 s46, s46, s47
    s_waitcnt lgkmcnt(6)
    buffer_store_dwordx4 v[40:43], v8, s[16:19], s46 offen
    s_add_u32 s46, s46, s47
    s_waitcnt lgkmcnt(5)
    buffer_store_dwordx4 v[44:47], v8, s[16:19], s46 offen
    s_add_u32 s46, s46, s47
    s_waitcnt lgkmcnt(4)
    buffer_store_dwordx4 v[48:51], v8, s[16:19], s46 offen
    s_add_u32 s46, s46, s47
    s_waitcnt lgkmcnt(3)
    buffer_store_dwordx4 v[52:55], v8, s[16:19], s46 offen
    s_add_u32 s46, s46, s47
    s_waitcnt lgkmcnt(2)
    buffer_store_dwordx4 v[56:59], v8, s[16:19], s46 offen
    s_add_u32 s46, s46, s47
    s_waitcnt lgkmcnt(1)
    buffer_store_dwordx4 v[60:63], v8, s[16:19], s46 offen
    s_add_u32 s46, s46, s47
    s_waitcnt lgkmcnt(0)
    buffer_store_dwordx4 v[64:67], v10, s[16:19], s48 offen
    s_cmp_lt_u32 s34, 4
    s_cbranch_scc1 L_qkv_kernel_nokn
    s_add_u32 s20, s84, 19595264
    s_addc_u32 s21, s85, 0
    s_and_b32 s21, s21, 0xffff
    s_mov_b32 s22, 8192
    s_mov_b32 s23, 0x20000
    v_dot2_f32_bf16 v68, v32, v32, 0
    v_dot2_f32_bf16 v68, v33, v33, v68
    v_dot2_f32_bf16 v68, v34, v34, v68
    v_dot2_f32_bf16 v68, v35, v35, v68
    v_dot2_f32_bf16 v69, v36, v36, 0
    v_dot2_f32_bf16 v69, v37, v37, v69
    v_dot2_f32_bf16 v69, v38, v38, v69
    v_dot2_f32_bf16 v69, v39, v39, v69
    v_dot2_f32_bf16 v70, v40, v40, 0
    v_dot2_f32_bf16 v70, v41, v41, v70
    v_dot2_f32_bf16 v70, v42, v42, v70
    v_dot2_f32_bf16 v70, v43, v43, v70
    v_dot2_f32_bf16 v71, v44, v44, 0
    v_dot2_f32_bf16 v71, v45, v45, v71
    v_dot2_f32_bf16 v71, v46, v46, v71
    v_dot2_f32_bf16 v71, v47, v47, v71
    v_dot2_f32_bf16 v72, v48, v48, 0
    v_dot2_f32_bf16 v72, v49, v49, v72
    v_dot2_f32_bf16 v72, v50, v50, v72
    v_dot2_f32_bf16 v72, v51, v51, v72
    v_dot2_f32_bf16 v73, v52, v52, 0
    v_dot2_f32_bf16 v73, v53, v53, v73
    v_dot2_f32_bf16 v73, v54, v54, v73
    v_dot2_f32_bf16 v73, v55, v55, v73
    v_dot2_f32_bf16 v74, v56, v56, 0
    v_dot2_f32_bf16 v74, v57, v57, v74
    v_dot2_f32_bf16 v74, v58, v58, v74
    v_dot2_f32_bf16 v74, v59, v59, v74
    v_dot2_f32_bf16 v75, v60, v60, 0
    v_dot2_f32_bf16 v75, v61, v61, v75
    v_dot2_f32_bf16 v75, v62, v62, v75
    v_dot2_f32_bf16 v75, v63, v63, v75
    v_dot2_f32_bf16 v76, v64, v64, 0
    v_dot2_f32_bf16 v77, v65, v65, 0
    v_dot2_f32_bf16 v78, v66, v66, 0
    v_dot2_f32_bf16 v79, v67, v67, 0
    v_mov_b32 v80, v68
    s_nop 1
    v_permlane32_swap_b32 v68, v80
    v_add_f32 v68, v68, v80
    s_nop 1
    v_max_f32_dpp v68, v68, v68 quad_perm:[1,0,3,2] row_mask:0xf bank_mask:0xf
    s_nop 1
    v_max_f32_dpp v68, v68, v68 quad_perm:[2,3,0,1] row_mask:0xf bank_mask:0xf
    s_nop 1
    v_max_f32_dpp v68, v68, v68 row_half_mirror row_mask:0xf bank_mask:0xf
    s_nop 1
    v_max_f32_dpp v68, v68, v68 row_mirror row_mask:0xf bank_mask:0xf
    v_mov_b32 v80, v68
    s_nop 1
    v_permlane16_swap_b32 v68, v80
    v_max_f32 v68, v68, v80
    v_mov_b32 v80, v69
    s_nop 1
    v_permlane32_swap_b32 v69, v80
    v_add_f32 v69, v69, v80
    s_nop 1
    v_max_f32_dpp v69, v69, v69 quad_perm:[1,0,3,2] row_mask:0xf bank_mask:0xf
    s_nop 1
    v_max_f32_dpp v69, v69, v69 quad_perm:[2,3,0,1] row_mask:0xf bank_mask:0xf
    s_nop 1
    v_max_f32_dpp v69, v69, v69 row_half_mirror row_mask:0xf bank_mask:0xf
    s_nop 1
    v_max_f32_dpp v69, v69, v69 row_mirror row_mask:0xf bank_mask:0xf
    v_mov_b32 v80, v69
    s_nop 1
    v_permlane16_swap_b32 v69, v80
    v_max_f32 v69, v69, v80
    v_mov_b32 v80, v70
    s_nop 1
    v_permlane32_swap_b32 v70, v80
    v_add_f32 v70, v70, v80
    s_nop 1
    v_max_f32_dpp v70, v70, v70 quad_perm:[1,0,3,2] row_mask:0xf bank_mask:0xf
    s_nop 1
    v_max_f32_dpp v70, v70, v70 quad_perm:[2,3,0,1] row_mask:0xf bank_mask:0xf
    s_nop 1
    v_max_f32_dpp v70, v70, v70 row_half_mirror row_mask:0xf bank_mask:0xf
    s_nop 1
    v_max_f32_dpp v70, v70, v70 row_mirror row_mask:0xf bank_mask:0xf
    v_mov_b32 v80, v70
    s_nop 1
    v_permlane16_swap_b32 v70, v80
    v_max_f32 v70, v70, v80
    v_mov_b32 v80, v71
    s_nop 1
    v_permlane32_swap_b32 v71, v80
    v_add_f32 v71, v71, v80
    s_nop 1
    v_max_f32_dpp v71, v71, v71 quad_perm:[1,0,3,2] row_mask:0xf bank_mask:0xf
    s_nop 1
    v_max_f32_dpp v71, v71, v71 quad_perm:[2,3,0,1] row_mask:0xf bank_mask:0xf
    s_nop 1
    v_max_f32_dpp v71, v71, v71 row_half_mirror row_mask:0xf bank_mask:0xf
    s_nop 1
    v_max_f32_dpp v71, v71, v71 row_mirror row_mask:0xf bank_mask:0xf
    v_mov_b32 v80, v71
    s_nop 1
    v_permlane16_swap_b32 v71, v80
    v_max_f32 v71, v71, v80
    v_mov_b32 v80, v72
    s_nop 1
    v_permlane32_swap_b32 v72, v80
    v_add_f32 v72, v72, v80
    s_nop 1
    v_max_f32_dpp v72, v72, v72 quad_perm:[1,0,3,2] row_mask:0xf bank_mask:0xf
    s_nop 1
    v_max_f32_dpp v72, v72, v72 quad_perm:[2,3,0,1] row_mask:0xf bank_mask:0xf
    s_nop 1
    v_max_f32_dpp v72, v72, v72 row_half_mirror row_mask:0xf bank_mask:0xf
    s_nop 1
    v_max_f32_dpp v72, v72, v72 row_mirror row_mask:0xf bank_mask:0xf
    v_mov_b32 v80, v72
    s_nop 1
    v_permlane16_swap_b32 v72, v80
    v_max_f32 v72, v72, v80
    v_mov_b32 v80, v73
    s_nop 1
    v_permlane32_swap_b32 v73, v80
    v_add_f32 v73, v73, v80
    s_nop 1
    v_max_f32_dpp v73, v73, v73 quad_perm:[1,0,3,2] row_mask:0xf bank_mask:0xf
    s_nop 1
    v_max_f32_dpp v73, v73, v73 quad_perm:[2,3,0,1] row_mask:0xf bank_mask:0xf
    s_nop 1
    v_max_f32_dpp v73, v73, v73 row_half_mirror row_mask:0xf bank_mask:0xf
    s_nop 1
    v_max_f32_dpp v73, v73, v73 row_mirror row_mask:0xf bank_mask:0xf
    v_mov_b32 v80, v73
    s_nop 1
    v_permlane16_swap_b32 v73, v80
    v_max_f32 v73, v73, v80
    v_mov_b32 v80, v74
    s_nop 1
    v_permlane32_swap_b32 v74, v80
    v_add_f32 v74, v74, v80
    s_nop 1
    v_max_f32_dpp v74, v74, v74 quad_perm:[1,0,3,2] row_mask:0xf bank_mask:0xf
    s_nop 1
    v_max_f32_dpp v74, v74, v74 quad_perm:[2,3,0,1] row_mask:0xf bank_mask:0xf
    s_nop 1
    v_max_f32_dpp v74, v74, v74 row_half_mirror row_mask:0xf bank_mask:0xf
    s_nop 1
    v_max_f32_dpp v74, v74, v74 row_mirror row_mask:0xf bank_mask:0xf
    v_mov_b32 v80, v74
    s_nop 1
    v_permlane16_swap_b32 v74, v80
    v_max_f32 v74, v74, v80
    v_mov_b32 v80, v75
    s_nop 1
    v_permlane32_swap_b32 v75, v80
    v_add_f32 v75, v75, v80
    s_nop 1
    v_max_f32_dpp v75, v75, v75 quad_perm:[1,0,3,2] row_mask:0xf bank_mask:0xf
    s_nop 1
    v_max_f32_dpp v75, v75, v75 quad_perm:[2,3,0,1] row_mask:0xf bank_mask:0xf
    s_nop 1
    v_max_f32_dpp v75, v75, v75 row_half_mirror row_mask:0xf bank_mask:0xf
    s_nop 1
    v_max_f32_dpp v75, v75, v75 row_mirror row_mask:0xf bank_mask:0xf
    v_mov_b32 v80, v75
    s_nop 1
    v_permlane16_swap_b32 v75, v80
    v_max_f32 v75, v75, v80
    v_max3_f32 v76, v76, v77, v78
    v_max_f32 v76, v76, v79
    s_nop 1
    v_max_f32_dpp v76, v76, v76 quad_perm:[1,0,3,2] row_mask:0xf bank_mask:0xf
    s_nop 1
    v_max_f32_dpp v76, v76, v76 quad_perm:[2,3,0,1] row_mask:0xf bank_mask:0xf
    s_nop 1
    v_max_f32_dpp v76, v76, v76 row_half_mirror row_mask:0xf bank_mask:0xf
    v_lshrrev_b32 v81, 3, v2
    v_mov_b32 v82, v68
    v_cmp_eq_u32 vcc, 1, v81
    s_nop 1
    v_cndmask_b32 v82, v82, v69, vcc
    v_cmp_eq_u32 vcc, 2, v81
    s_nop 1
    v_cndmask_b32 v82, v82, v70, vcc
    v_cmp_eq_u32 vcc, 3, v81
    s_nop 1
    v_cndmask_b32 v82, v82, v71, vcc
    v_cmp_eq_u32 vcc, 4, v81
    s_nop 1
    v_cndmask_b32 v82, v82, v72, vcc
    v_cmp_eq_u32 vcc, 5, v81
    s_nop 1
    v_cndmask_b32 v82, v82, v73, vcc
    v_cmp_eq_u32 vcc, 6, v81
    s_nop 1
    v_cndmask_b32 v82, v82, v74, vcc
    v_cmp_eq_u32 vcc, 7, v81
    s_nop 1
    v_cndmask_b32 v82, v82, v75, vcc
    v_add_f32 v82, v82, v76
    v_add_u32 v81, s43, v81
    v_lshlrev_b32 v81, 8, v81
    s_lshl_b32 s53, s42, 2
    buffer_store_dword v82, v81, s[20:23], s53 offen
L_qkv_kernel_nokn:
    s_endpgm
L_qkv_kernel_v:
    s_mov_b32 s50, 1.0
    s_mul_i32 s46, s45, 1216
    s_add_u32 s46, s46, s44
    s_add_u32 s46, s46, 2377728
    s_mov_b32 s47, 151552
    s_mul_i32 s51, s43, s47
    s_add_u32 s46, s46, s51
    s_barrier
    ds_read_b64_tr_b16 a[144:145], v12 offset:0
    ds_read_b64_tr_b16 a[146:147], v12 offset:2304
    ds_read_b64_tr_b16 a[148:149], v12 offset:128
    ds_read_b64_tr_b16 a[150:151], v12 offset:2432
    ds_read_b64_tr_b16 a[152:153], v8 offset:256
    ds_read_b64_tr_b16 a[154:155], v8 offset:2560
    ds_read_b128 v[32:35], v16 offset:0
    ds_read_b128 v[36:39], v16 offset:2048
    ds_read_b64_tr_b16 a[72:73], v8 offset:0
    ds_read_b64_tr_b16 a[74:75], v8 offset:2304
    ds_read_b64_tr_b16 a[76:77], v8 offset:32
    ds_read_b64_tr_b16 a[78:79], v8 offset:2336
    ds_read_b64_tr_b16 a[80:81], v8 offset:64
    ds_read_b64_tr_b16 a[82:83], v8 offset:2368
    ds_read_b64_tr_b16 a[84:85], v8 offset:96
    ds_read_b64_tr_b16 a[86:87], v8 offset:2400
    ds_read_b64_tr_b16 a[88:89], v8 offset:128
    ds_read_b64_tr_b16 a[90:91], v8 offset:2432
    ds_read_b64_tr_b16 a[92:93], v8 offset:160
    ds_read_b64_tr_b16 a[94:95], v8 offset:2464
    ds_read_b64_tr_b16 a[96:97], v8 offset:192
    ds_read_b64_tr_b16 a[98:99], v8 offset:2496
    ds_read_b64_tr_b16 a[100:101], v8 offset:224
    ds_read_b64_tr_b16 a[102:103], v8 offset:2528
    ds_read_b64_tr_b16 a[104:105], v8 offset:256
    ds_read_b64_tr_b16 a[106:107], v8 offset:2560
    s_waitcnt lgkmcnt(15)
    v_mfma_f32_16x16x32_bf16 a[156:159], a[144:147], a[168:171], a[156:159]
    v_mfma_f32_16x16x32_bf16 a[160:163], a[148:151], a[168:171], a[160:163]
    v_mfma_f32_16x16x32_bf16 a[164:167], a[152:155], a[168:171], a[164:167]
    v_mfma_f32_16x16x32_bf16 v[48:51], a[168:171], v[32:35], v[48:51]
    ds_read_b128 v[40:43], v17 offset:0
    ds_read_b128 v[44:47], v17 offset:2048
    v_mfma_f32_16x16x32_bf16 v[56:59], v[32:35], v[32:35], v[56:59]
    ds_read_b64_tr_b16 a[108:109], v8 offset:9216
    ds_read_b64_tr_b16 a[110:111], v8 offset:11520
    v_mfma_f32_16x16x32_bf16 v[52:55], a[168:171], v[36:39], v[52:55]
    ds_read_b64_tr_b16 a[112:113], v8 offset:9248
    ds_read_b64_tr_b16 a[114:115], v8 offset:11552
    v_mfma_f32_16x16x32_bf16 v[60:63], v[36:39], v[36:39], v[60:63]
    ds_read_b64_tr_b16 a[116:117], v8 offset:9280
    ds_read_b64_tr_b16 a[118:119], v8 offset:11584
    v_mfma_f32_16x16x32_bf16 a[0:3], v[32:35], a[72:75], a[0:3]
    ds_read_b64_tr_b16 a[120:121], v8 offset:9312
    v_mfma_f32_16x16x32_bf16 a[4:7], v[36:39], a[72:75], a[4:7]
    ds_read_b64_tr_b16 a[122:123], v8 offset:11616
    s_waitcnt lgkmcnt(15)
    v_mfma_f32_16x16x32_bf16 a[8:11], v[32:35], a[76:79], a[8:11]
    ds_read_b64_tr_b16 a[124:125], v8 offset:9344
    v_mfma_f32_16x16x32_bf16 a[12:15], v[36:39], a[76:79], a[12:15]
    ds_read_b64_tr_b16 a[126:127], v8 offset:11648
    v_mfma_f32_16x16x32_bf16 a[16:19], v[32:35], a[80:83], a[16:19]
    ds_read_b64_tr_b16 a[128:129], v8 offset:9376
    v_mfma_f32_16x16x32_bf16 a[20:23], v[36:39], a[80:83], a[20:23]
    ds_read_b64_tr_b16 a[130:131], v8 offset:11680
    v_mfma_f32_16x16x32_bf16 a[24:27], v[32:35], a[84:87], a[24:27]
    ds_read_b64_tr_b16 a[132:133], v8 offset:9408
    v_mfma_f32_16x16x32_bf16 a[28:31], v[36:39], a[84:87], a[28:31]
    ds_read_b64_tr_b16 a[134:135], v8 offset:11712
    v_mfma_f32_16x16x32_bf16 a[32:35], v[32:35], a[88:91], a[32:35]
    ds_read_b64_tr_b16 a[136:137], v8 offset:9440
    v_mfma_f32_16x16x32_bf16 a[36:39], v[36:39], a[88:91], a[36:39]
    ds_read_b64_tr_b16 a[138:139], v8 offset:11744
    v_mfma_f32_16x16x32_bf16 a[40:43], v[32:35], a[92:95], a[40:43]
    ds_read_b64_tr_b16 a[140:141], v8 offset:9472
    v_mfma_f32_16x16x32_bf16 a[44:47], v[36:39], a[92:95], a[44:47]
    ds_read_b64_tr_b16 a[142:143], v8 offset:11776
    s_waitcnt lgkmcnt(15)
    v_mfma_f32_16x16x32_bf16 a[48:51], v[32:35], a[96:99], a[48:51]
    ds_read_b64_tr_b16 a[144:145], v12 offset:9216
    v_mfma_f32_16x16x32_bf16 a[52:55], v[36:39], a[96:99], a[52:55]
    ds_read_b64_tr_b16 a[146:147], v12 offset:11520
    v_mfma_f32_16x16x32_bf16 a[56:59], v[32:35], a[100:103], a[56:59]
    ds_read_b64_tr_b16 a[148:149], v12 offset:9344
    v_mfma_f32_16x16x32_bf16 a[60:63], v[36:39], a[100:103], a[60:63]
    ds_read_b64_tr_b16 a[150:151], v12 offset:11648
    v_mfma_f32_16x16x32_bf16 a[64:67], v[32:35], a[104:107], a[64:67]
    ds_read_b64_tr_b16 a[152:153], v8 offset:9472
    v_mfma_f32_16x16x32_bf16 a[68:71], v[36:39], a[104:107], a[68:71]
    ds_read_b64_tr_b16 a[154:155], v8 offset:11776
    s_barrier
    s_waitcnt lgkmcnt(4)
    v_mfma_f32_16x16x32_bf16 a[156:159], a[144:147], a[168:171], a[156:159]
    s_waitcnt lgkmcnt(2)
    v_mfma_f32_16x16x32_bf16 a[160:163], a[148:151], a[168:171], a[160:163]
    s_waitcnt lgkmcnt(0)
    v_mfma_f32_16x16x32_bf16 a[164:167], a[152:155], a[168:171], a[164:167]
    v_mfma_f32_16x16x32_bf16 v[48:51], a[168:171], v[40:43], v[48:51]
    ds_read_b128 v[32:35], v18 offset:0
    ds_read_b128 v[36:39], v18 offset:2048
    v_mfma_f32_16x16x32_bf16 v[56:59], v[40:43], v[40:43], v[56:59]
    ds_read_b64_tr_b16 a[72:73], v9 offset:0
    ds_read_b64_tr_b16 a[74:75], v9 offset:2304
    v_mfma_f32_16x16x32_bf16 v[52:55], a[168:171], v[44:47], v[52:55]
    ds_read_b64_tr_b16 a[76:77], v9 offset:32
    ds_read_b64_tr_b16 a[78:79], v9 offset:2336
    v_mfma_f32_16x16x32_bf16 v[60:63], v[44:47], v[44:47], v[60:63]
    ds_read_b64_tr_b16 a[80:81], v9 offset:64
    ds_read_b64_tr_b16 a[82:83], v9 offset:2368
    v_mfma_f32_16x16x32_bf16 a[0:3], v[40:43], a[108:111], a[0:3]
    ds_read_b64_tr_b16 a[84:85], v9 offset:96
    v_mfma_f32_16x16x32_bf16 a[4:7], v[44:47], a[108:111], a[4:7]
    ds_read_b64_tr_b16 a[86:87], v9 offset:2400
    v_mfma_f32_16x16x32_bf16 a[8:11], v[40:43], a[112:115], a[8:11]
    ds_read_b64_tr_b16 a[88:89], v9 offset:128
    v_mfma_f32_16x16x32_bf16 a[12:15], v[44:47], a[112:115], a[12:15]
    ds_read_b64_tr_b16 a[90:91], v9 offset:2432
    v_mfma_f32_16x16x32_bf16 a[16:19], v[40:43], a[116:119], a[16:19]
    ds_read_b64_tr_b16 a[92:93], v9 offset:160
    v_mfma_f32_16x16x32_bf16 a[20:23], v[44:47], a[116:119], a[20:23]
    ds_read_b64_tr_b16 a[94:95], v9 offset:2464
    v_mfma_f32_16x16x32_bf16 a[24:27], v[40:43], a[120:123], a[24:27]
    ds_read_b64_tr_b16 a[96:97], v9 offset:192
    v_mfma_f32_16x16x32_bf16 a[28:31], v[44:47], a[120:123], a[28:31]
    ds_read_b64_tr_b16 a[98:99], v9 offset:2496
    v_mfma_f32_16x16x32_bf16 a[32:35], v[40:43], a[124:127], a[32:35]
    ds_read_b64_tr_b16 a[100:101], v9 offset:224
    v_mfma_f32_16x16x32_bf16 a[36:39], v[44:47], a[124:127], a[36:39]
    ds_read_b64_tr_b16 a[102:103], v9 offset:2528
    v_mfma_f32_16x16x32_bf16 a[40:43], v[40:43], a[128:131], a[40:43]
    ds_read_b64_tr_b16 a[104:105], v9 offset:256
    v_mfma_f32_16x16x32_bf16 a[44:47], v[44:47], a[128:131], a[44:47]
    ds_read_b64_tr_b16 a[106:107], v9 offset:2560
    v_mfma_f32_16x16x32_bf16 a[48:51], v[40:43], a[132:135], a[48:51]
    ds_read_b64_tr_b16 a[144:145], v13 offset:0
    v_mfma_f32_16x16x32_bf16 a[52:55], v[44:47], a[132:135], a[52:55]
    ds_read_b64_tr_b16 a[146:147], v13 offset:2304
    v_mfma_f32_16x16x32_bf16 a[56:59], v[40:43], a[136:139], a[56:59]
    ds_read_b64_tr_b16 a[148:149], v13 offset:128
    v_mfma_f32_16x16x32_bf16 a[60:63], v[44:47], a[136:139], a[60:63]
    ds_read_b64_tr_b16 a[150:151], v13 offset:2432
    v_mfma_f32_16x16x32_bf16 a[64:67], v[40:43], a[140:143], a[64:67]
    ds_read_b64_tr_b16 a[152:153], v9 offset:256
    v_mfma_f32_16x16x32_bf16 a[68:71], v[44:47], a[140:143], a[68:71]
    ds_read_b64_tr_b16 a[154:155], v9 offset:2560
    s_waitcnt lgkmcnt(4)
    v_mfma_f32_16x16x32_bf16 a[156:159], a[144:147], a[168:171], a[156:159]
    s_waitcnt lgkmcnt(2)
    v_mfma_f32_16x16x32_bf16 a[160:163], a[148:151], a[168:171], a[160:163]
    s_waitcnt lgkmcnt(0)
    v_mfma_f32_16x16x32_bf16 a[164:167], a[152:155], a[168:171], a[164:167]
    v_mfma_f32_16x16x32_bf16 v[48:51], a[168:171], v[32:35], v[48:51]
    ds_read_b128 v[40:43], v19 offset:0
    ds_read_b128 v[44:47], v19 offset:2048
    v_mfma_f32_16x16x32_bf16 v[56:59], v[32:35], v[32:35], v[56:59]
    ds_read_b64_tr_b16 a[108:109], v9 offset:9216
    ds_read_b64_tr_b16 a[110:111], v9 offset:11520
    v_mfma_f32_16x16x32_bf16 v[52:55], a[168:171], v[36:39], v[52:55]
    ds_read_b64_tr_b16 a[112:113], v9 offset:9248
    ds_read_b64_tr_b16 a[114:115], v9 offset:11552
    v_mfma_f32_16x16x32_bf16 v[60:63], v[36:39], v[36:39], v[60:63]
    ds_read_b64_tr_b16 a[116:117], v9 offset:9280
    ds_read_b64_tr_b16 a[118:119], v9 offset:11584
    v_mfma_f32_16x16x32_bf16 a[0:3], v[32:35], a[72:75], a[0:3]
    ds_read_b64_tr_b16 a[120:121], v9 offset:9312
    v_mfma_f32_16x16x32_bf16 a[4:7], v[36:39], a[72:75], a[4:7]
    ds_read_b64_tr_b16 a[122:123], v9 offset:11616
    v_mfma_f32_16x16x32_bf16 a[8:11], v[32:35], a[76:79], a[8:11]
    ds_read_b64_tr_b16 a[124:125], v9 offset:9344
    v_mfma_f32_16x16x32_bf16 a[12:15], v[36:39], a[76:79], a[12:15]
    ds_read_b64_tr_b16 a[126:127], v9 offset:11648
    v_mfma_f32_16x16x32_bf16 a[16:19], v[32:35], a[80:83], a[16:19]
    ds_read_b64_tr_b16 a[128:129], v9 offset:9376
    v_mfma_f32_16x16x32_bf16 a[20:23], v[36:39], a[80:83], a[20:23]
    ds_read_b64_tr_b16 a[130:131], v9 offset:11680
    v_mfma_f32_16x16x32_bf16 a[24:27], v[32:35], a[84:87], a[24:27]
    ds_read_b64_tr_b16 a[132:133], v9 offset:9408
    v_mfma_f32_16x16x32_bf16 a[28:31], v[36:39], a[84:87], a[28:31]
    ds_read_b64_tr_b16 a[134:135], v9 offset:11712
    v_mfma_f32_16x16x32_bf16 a[32:35], v[32:35], a[88:91], a[32:35]
    ds_read_b64_tr_b16 a[136:137], v9 offset:9440
    v_mfma_f32_16x16x32_bf16 a[36:39], v[36:39], a[88:91], a[36:39]
    ds_read_b64_tr_b16 a[138:139], v9 offset:11744
    v_mfma_f32_16x16x32_bf16 a[40:43], v[32:35], a[92:95], a[40:43]
    ds_read_b64_tr_b16 a[140:141], v9 offset:9472
    v_mfma_f32_16x16x32_bf16 a[44:47], v[36:39], a[92:95], a[44:47]
    ds_read_b64_tr_b16 a[142:143], v9 offset:11776
    v_mfma_f32_16x16x32_bf16 a[48:51], v[32:35], a[96:99], a[48:51]
    ds_read_b64_tr_b16 a[144:145], v13 offset:9216
    v_mfma_f32_16x16x32_bf16 a[52:55], v[36:39], a[96:99], a[52:55]
    ds_read_b64_tr_b16 a[146:147], v13 offset:11520
    v_mfma_f32_16x16x32_bf16 a[56:59], v[32:35], a[100:103], a[56:59]
    ds_read_b64_tr_b16 a[148:149], v13 offset:9344
    v_mfma_f32_16x16x32_bf16 a[60:63], v[36:39], a[100:103], a[60:63]
    ds_read_b64_tr_b16 a[150:151], v13 offset:11648
    v_mfma_f32_16x16x32_bf16 a[64:67], v[32:35], a[104:107], a[64:67]
    ds_read_b64_tr_b16 a[152:153], v9 offset:9472
    v_mfma_f32_16x16x32_bf16 a[68:71], v[36:39], a[104:107], a[68:71]
    ds_read_b64_tr_b16 a[154:155], v9 offset:11776
    s_barrier
    s_waitcnt lgkmcnt(4)
    v_mfma_f32_16x16x32_bf16 a[156:159], a[144:147], a[168:171], a[156:159]
    s_waitcnt lgkmcnt(2)
    v_mfma_f32_16x16x32_bf16 a[160:163], a[148:151], a[168:171], a[160:163]
    s_waitcnt lgkmcnt(0)
    v_mfma_f32_16x16x32_bf16 a[164:167], a[152:155], a[168:171], a[164:167]
    v_mfma_f32_16x16x32_bf16 v[48:51], a[168:171], v[40:43], v[48:51]
    ds_read_b128 v[32:35], v20 offset:0
    ds_read_b128 v[36:39], v20 offset:2048
    v_mfma_f32_16x16x32_bf16 v[56:59], v[40:43], v[40:43], v[56:59]
    ds_read_b64_tr_b16 a[72:73], v10 offset:0
    ds_read_b64_tr_b16 a[74:75], v10 offset:2304
    v_mfma_f32_16x16x32_bf16 v[52:55], a[168:171], v[44:47], v[52:55]
    ds_read_b64_tr_b16 a[76:77], v10 offset:32
    ds_read_b64_tr_b16 a[78:79], v10 offset:2336
    v_mfma_f32_16x16x32_bf16 v[60:63], v[44:47], v[44:47], v[60:63]
    ds_read_b64_tr_b16 a[80:81], v10 offset:64
    ds_read_b64_tr_b16 a[82:83], v10 offset:2368
    v_mfma_f32_16x16x32_bf16 a[0:3], v[40:43], a[108:111], a[0:3]
    ds_read_b64_tr_b16 a[84:85], v10 offset:96
    v_mfma_f32_16x16x32_bf16 a[4:7], v[44:47], a[108:111], a[4:7]
    ds_read_b64_tr_b16 a[86:87], v10 offset:2400
    v_mfma_f32_16x16x32_bf16 a[8:11], v[40:43], a[112:115], a[8:11]
    ds_read_b64_tr_b16 a[88:89], v10 offset:128
    v_mfma_f32_16x16x32_bf16 a[12:15], v[44:47], a[112:115], a[12:15]
    ds_read_b64_tr_b16 a[90:91], v10 offset:2432
    v_mfma_f32_16x16x32_bf16 a[16:19], v[40:43], a[116:119], a[16:19]
    ds_read_b64_tr_b16 a[92:93], v10 offset:160
    v_mfma_f32_16x16x32_bf16 a[20:23], v[44:47], a[116:119], a[20:23]
    ds_read_b64_tr_b16 a[94:95], v10 offset:2464
    v_mfma_f32_16x16x32_bf16 a[24:27], v[40:43], a[120:123], a[24:27]
    ds_read_b64_tr_b16 a[96:97], v10 offset:192
    v_mfma_f32_16x16x32_bf16 a[28:31], v[44:47], a[120:123], a[28:31]
    ds_read_b64_tr_b16 a[98:99], v10 offset:2496
    v_mfma_f32_16x16x32_bf16 a[32:35], v[40:43], a[124:127], a[32:35]
    ds_read_b64_tr_b16 a[100:101], v10 offset:224
    v_mfma_f32_16x16x32_bf16 a[36:39], v[44:47], a[124:127], a[36:39]
    ds_read_b64_tr_b16 a[102:103], v10 offset:2528
    v_mfma_f32_16x16x32_bf16 a[40:43], v[40:43], a[128:131], a[40:43]
    ds_read_b64_tr_b16 a[104:105], v10 offset:256
    v_mfma_f32_16x16x32_bf16 a[44:47], v[44:47], a[128:131], a[44:47]
    ds_read_b64_tr_b16 a[106:107], v10 offset:2560
    v_mfma_f32_16x16x32_bf16 a[48:51], v[40:43], a[132:135], a[48:51]
    ds_read_b64_tr_b16 a[144:145], v14 offset:0
    v_mfma_f32_16x16x32_bf16 a[52:55], v[44:47], a[132:135], a[52:55]
    ds_read_b64_tr_b16 a[146:147], v14 offset:2304
    v_mfma_f32_16x16x32_bf16 a[56:59], v[40:43], a[136:139], a[56:59]
    ds_read_b64_tr_b16 a[148:149], v14 offset:128
    v_mfma_f32_16x16x32_bf16 a[60:63], v[44:47], a[136:139], a[60:63]
    ds_read_b64_tr_b16 a[150:151], v14 offset:2432
    v_mfma_f32_16x16x32_bf16 a[64:67], v[40:43], a[140:143], a[64:67]
    ds_read_b64_tr_b16 a[152:153], v10 offset:256
    v_mfma_f32_16x16x32_bf16 a[68:71], v[44:47], a[140:143], a[68:71]
    ds_read_b64_tr_b16 a[154:155], v10 offset:2560
    s_waitcnt lgkmcnt(4)
    v_mfma_f32_16x16x32_bf16 a[156:159], a[144:147], a[168:171], a[156:159]
    s_waitcnt lgkmcnt(2)
    v_mfma_f32_16x16x32_bf16 a[160:163], a[148:151], a[168:171], a[160:163]
    s_waitcnt lgkmcnt(0)
    v_mfma_f32_16x16x32_bf16 a[164:167], a[152:155], a[168:171], a[164:167]
    v_mfma_f32_16x16x32_bf16 v[48:51], a[168:171], v[32:35], v[48:51]
    ds_read_b128 v[40:43], v21 offset:0
    ds_read_b128 v[44:47], v21 offset:2048
    v_mfma_f32_16x16x32_bf16 v[56:59], v[32:35], v[32:35], v[56:59]
    ds_read_b64_tr_b16 a[108:109], v10 offset:9216
    ds_read_b64_tr_b16 a[110:111], v10 offset:11520
    v_mfma_f32_16x16x32_bf16 v[52:55], a[168:171], v[36:39], v[52:55]
    ds_read_b64_tr_b16 a[112:113], v10 offset:9248
    ds_read_b64_tr_b16 a[114:115], v10 offset:11552
    v_mfma_f32_16x16x32_bf16 v[60:63], v[36:39], v[36:39], v[60:63]
    ds_read_b64_tr_b16 a[116:117], v10 offset:9280
    ds_read_b64_tr_b16 a[118:119], v10 offset:11584
    v_mfma_f32_16x16x32_bf16 a[0:3], v[32:35], a[72:75], a[0:3]
    ds_read_b64_tr_b16 a[120:121], v10 offset:9312
    v_mfma_f32_16x16x32_bf16 a[4:7], v[36:39], a[72:75], a[4:7]
    ds_read_b64_tr_b16 a[122:123], v10 offset:11616
    v_mfma_f32_16x16x32_bf16 a[8:11], v[32:35], a[76:79], a[8:11]
    ds_read_b64_tr_b16 a[124:125], v10 offset:9344
    v_mfma_f32_16x16x32_bf16 a[12:15], v[36:39], a[76:79], a[12:15]
    ds_read_b64_tr_b16 a[126:127], v10 offset:11648
    v_mfma_f32_16x16x32_bf16 a[16:19], v[32:35], a[80:83], a[16:19]
    ds_read_b64_tr_b16 a[128:129], v10 offset:9376
    v_mfma_f32_16x16x32_bf16 a[20:23], v[36:39], a[80:83], a[20:23]
    ds_read_b64_tr_b16 a[130:131], v10 offset:11680
    v_mfma_f32_16x16x32_bf16 a[24:27], v[32:35], a[84:87], a[24:27]
    ds_read_b64_tr_b16 a[132:133], v10 offset:9408
    v_mfma_f32_16x16x32_bf16 a[28:31], v[36:39], a[84:87], a[28:31]
    ds_read_b64_tr_b16 a[134:135], v10 offset:11712
    v_mfma_f32_16x16x32_bf16 a[32:35], v[32:35], a[88:91], a[32:35]
    ds_read_b64_tr_b16 a[136:137], v10 offset:9440
    v_mfma_f32_16x16x32_bf16 a[36:39], v[36:39], a[88:91], a[36:39]
    ds_read_b64_tr_b16 a[138:139], v10 offset:11744
    v_mfma_f32_16x16x32_bf16 a[40:43], v[32:35], a[92:95], a[40:43]
    ds_read_b64_tr_b16 a[140:141], v10 offset:9472
    v_mfma_f32_16x16x32_bf16 a[44:47], v[36:39], a[92:95], a[44:47]
    ds_read_b64_tr_b16 a[142:143], v10 offset:11776
    v_mfma_f32_16x16x32_bf16 a[48:51], v[32:35], a[96:99], a[48:51]
    ds_read_b64_tr_b16 a[144:145], v14 offset:9216
    v_mfma_f32_16x16x32_bf16 a[52:55], v[36:39], a[96:99], a[52:55]
    ds_read_b64_tr_b16 a[146:147], v14 offset:11520
    v_mfma_f32_16x16x32_bf16 a[56:59], v[32:35], a[100:103], a[56:59]
    ds_read_b64_tr_b16 a[148:149], v14 offset:9344
    v_mfma_f32_16x16x32_bf16 a[60:63], v[36:39], a[100:103], a[60:63]
    ds_read_b64_tr_b16 a[150:151], v14 offset:11648
    v_mfma_f32_16x16x32_bf16 a[64:67], v[32:35], a[104:107], a[64:67]
    ds_read_b64_tr_b16 a[152:153], v10 offset:9472
    v_mfma_f32_16x16x32_bf16 a[68:71], v[36:39], a[104:107], a[68:71]
    ds_read_b64_tr_b16 a[154:155], v10 offset:11776
    s_barrier
    s_waitcnt lgkmcnt(4)
    v_mfma_f32_16x16x32_bf16 a[156:159], a[144:147], a[168:171], a[156:159]
    s_waitcnt lgkmcnt(2)
    v_mfma_f32_16x16x32_bf16 a[160:163], a[148:151], a[168:171], a[160:163]
    s_waitcnt lgkmcnt(0)
    v_mfma_f32_16x16x32_bf16 a[164:167], a[152:155], a[168:171], a[164:167]
    v_mfma_f32_16x16x32_bf16 v[48:51], a[168:171], v[40:43], v[48:51]
    ds_read_b128 v[32:35], v22 offset:0
    ds_read_b128 v[36:39], v22 offset:2048
    v_mfma_f32_16x16x32_bf16 v[56:59], v[40:43], v[40:43], v[56:59]
    ds_read_b64_tr_b16 a[72:73], v11 offset:0
    ds_read_b64_tr_b16 a[74:75], v11 offset:2304
    v_mfma_f32_16x16x32_bf16 v[52:55], a[168:171], v[44:47], v[52:55]
    ds_read_b64_tr_b16 a[76:77], v11 offset:32
    ds_read_b64_tr_b16 a[78:79], v11 offset:2336
    v_mfma_f32_16x16x32_bf16 v[60:63], v[44:47], v[44:47], v[60:63]
    ds_read_b64_tr_b16 a[80:81], v11 offset:64
    ds_read_b64_tr_b16 a[82:83], v11 offset:2368
    v_mfma_f32_16x16x32_bf16 a[0:3], v[40:43], a[108:111], a[0:3]
    ds_read_b64_tr_b16 a[84:85], v11 offset:96
    v_mfma_f32_16x16x32_bf16 a[4:7], v[44:47], a[108:111], a[4:7]
    ds_read_b64_tr_b16 a[86:87], v11 offset:2400
    v_mfma_f32_16x16x32_bf16 a[8:11], v[40:43], a[112:115], a[8:11]
    ds_read_b64_tr_b16 a[88:89], v11 offset:128
    v_mfma_f32_16x16x32_bf16 a[12:15], v[44:47], a[112:115], a[12:15]
    ds_read_b64_tr_b16 a[90:91], v11 offset:2432
    v_mfma_f32_16x16x32_bf16 a[16:19], v[40:43], a[116:119], a[16:19]
    ds_read_b64_tr_b16 a[92:93], v11 offset:160
    v_mfma_f32_16x16x32_bf16 a[20:23], v[44:47], a[116:119], a[20:23]
    ds_read_b64_tr_b16 a[94:95], v11 offset:2464
    v_mfma_f32_16x16x32_bf16 a[24:27], v[40:43], a[120:123], a[24:27]
    ds_read_b64_tr_b16 a[96:97], v11 offset:192
    v_mfma_f32_16x16x32_bf16 a[28:31], v[44:47], a[120:123], a[28:31]
    ds_read_b64_tr_b16 a[98:99], v11 offset:2496
    v_mfma_f32_16x16x32_bf16 a[32:35], v[40:43], a[124:127], a[32:35]
    ds_read_b64_tr_b16 a[100:101], v11 offset:224
    v_mfma_f32_16x16x32_bf16 a[36:39], v[44:47], a[124:127], a[36:39]
    ds_read_b64_tr_b16 a[102:103], v11 offset:2528
    v_mfma_f32_16x16x32_bf16 a[40:43], v[40:43], a[128:131], a[40:43]
    ds_read_b64_tr_b16 a[104:105], v11 offset:256
    v_mfma_f32_16x16x32_bf16 a[44:47], v[44:47], a[128:131], a[44:47]
    ds_read_b64_tr_b16 a[106:107], v11 offset:2560
    v_mfma_f32_16x16x32_bf16 a[48:51], v[40:43], a[132:135], a[48:51]
    ds_read_b64_tr_b16 a[144:145], v15 offset:0
    v_mfma_f32_16x16x32_bf16 a[52:55], v[44:47], a[132:135], a[52:55]
    ds_read_b64_tr_b16 a[146:147], v15 offset:2304
    v_mfma_f32_16x16x32_bf16 a[56:59], v[40:43], a[136:139], a[56:59]
    ds_read_b64_tr_b16 a[148:149], v15 offset:128
    v_mfma_f32_16x16x32_bf16 a[60:63], v[44:47], a[136:139], a[60:63]
    ds_read_b64_tr_b16 a[150:151], v15 offset:2432
    v_mfma_f32_16x16x32_bf16 a[64:67], v[40:43], a[140:143], a[64:67]
    ds_read_b64_tr_b16 a[152:153], v11 offset:256
    v_mfma_f32_16x16x32_bf16 a[68:71], v[44:47], a[140:143], a[68:71]
    ds_read_b64_tr_b16 a[154:155], v11 offset:2560
    s_waitcnt lgkmcnt(4)
    v_mfma_f32_16x16x32_bf16 a[156:159], a[144:147], a[168:171], a[156:159]
    s_waitcnt lgkmcnt(2)
    v_mfma_f32_16x16x32_bf16 a[160:163], a[148:151], a[168:171], a[160:163]
    s_waitcnt lgkmcnt(0)
    v_mfma_f32_16x16x32_bf16 a[164:167], a[152:155], a[168:171], a[164:167]
    v_mfma_f32_16x16x32_bf16 v[48:51], a[168:171], v[32:35], v[48:51]
    ds_read_b128 v[40:43], v23 offset:0
    ds_read_b128 v[44:47], v23 offset:2048
    v_mfma_f32_16x16x32_bf16 v[56:59], v[32:35], v[32:35], v[56:59]
    ds_read_b64_tr_b16 a[108:109], v11 offset:9216
    ds_read_b64_tr_b16 a[110:111], v11 offset:11520
    v_mfma_f32_16x16x32_bf16 v[52:55], a[168:171], v[36:39], v[52:55]
    ds_read_b64_tr_b16 a[112:113], v11 offset:9248
    ds_read_b64_tr_b16 a[114:115], v11 offset:11552
    v_mfma_f32_16x16x32_bf16 v[60:63], v[36:39], v[36:39], v[60:63]
    ds_read_b64_tr_b16 a[116:117], v11 offset:9280
    ds_read_b64_tr_b16 a[118:119], v11 offset:11584
    v_mfma_f32_16x16x32_bf16 a[0:3], v[32:35], a[72:75], a[0:3]
    ds_read_b64_tr_b16 a[120:121], v11 offset:9312
    v_mfma_f32_16x16x32_bf16 a[4:7], v[36:39], a[72:75], a[4:7]
    ds_read_b64_tr_b16 a[122:123], v11 offset:11616
    v_mfma_f32_16x16x32_bf16 a[8:11], v[32:35], a[76:79], a[8:11]
    ds_read_b64_tr_b16 a[124:125], v11 offset:9344
    v_mfma_f32_16x16x32_bf16 a[12:15], v[36:39], a[76:79], a[12:15]
    ds_read_b64_tr_b16 a[126:127], v11 offset:11648
    v_mfma_f32_16x16x32_bf16 a[16:19], v[32:35], a[80:83], a[16:19]
    ds_read_b64_tr_b16 a[128:129], v11 offset:9376
    v_mfma_f32_16x16x32_bf16 a[20:23], v[36:39], a[80:83], a[20:23]
    ds_read_b64_tr_b16 a[130:131], v11 offset:11680
    v_mfma_f32_16x16x32_bf16 a[24:27], v[32:35], a[84:87], a[24:27]
    ds_read_b64_tr_b16 a[132:133], v11 offset:9408
    v_mfma_f32_16x16x32_bf16 a[28:31], v[36:39], a[84:87], a[28:31]
    ds_read_b64_tr_b16 a[134:135], v11 offset:11712
    v_mfma_f32_16x16x32_bf16 a[32:35], v[32:35], a[88:91], a[32:35]
    ds_read_b64_tr_b16 a[136:137], v11 offset:9440
    v_mfma_f32_16x16x32_bf16 a[36:39], v[36:39], a[88:91], a[36:39]
    ds_read_b64_tr_b16 a[138:139], v11 offset:11744
    v_mfma_f32_16x16x32_bf16 a[40:43], v[32:35], a[92:95], a[40:43]
    ds_read_b64_tr_b16 a[140:141], v11 offset:9472
    v_mfma_f32_16x16x32_bf16 a[44:47], v[36:39], a[92:95], a[44:47]
    ds_read_b64_tr_b16 a[142:143], v11 offset:11776
    v_mfma_f32_16x16x32_bf16 a[48:51], v[32:35], a[96:99], a[48:51]
    ds_read_b64_tr_b16 a[144:145], v15 offset:9216
    v_mfma_f32_16x16x32_bf16 a[52:55], v[36:39], a[96:99], a[52:55]
    ds_read_b64_tr_b16 a[146:147], v15 offset:11520
    v_mfma_f32_16x16x32_bf16 a[56:59], v[32:35], a[100:103], a[56:59]
    ds_read_b64_tr_b16 a[148:149], v15 offset:9344
    v_mfma_f32_16x16x32_bf16 a[60:63], v[36:39], a[100:103], a[60:63]
    ds_read_b64_tr_b16 a[150:151], v15 offset:11648
    v_mfma_f32_16x16x32_bf16 a[64:67], v[32:35], a[104:107], a[64:67]
    ds_read_b64_tr_b16 a[152:153], v11 offset:9472
    v_mfma_f32_16x16x32_bf16 a[68:71], v[36:39], a[104:107], a[68:71]
    ds_read_b64_tr_b16 a[154:155], v11 offset:11776
    s_barrier
    s_waitcnt lgkmcnt(4)
    v_mfma_f32_16x16x32_bf16 a[156:159], a[144:147], a[168:171], a[156:159]
    s_waitcnt lgkmcnt(2)
    v_mfma_f32_16x16x32_bf16 a[160:163], a[148:151], a[168:171], a[160:163]
    s_waitcnt lgkmcnt(0)
    v_mfma_f32_16x16x32_bf16 a[164:167], a[152:155], a[168:171], a[164:167]
    v_mfma_f32_16x16x32_bf16 v[48:51], a[168:171], v[40:43], v[48:51]
    ds_read_b128 v[32:35], v16 offset:0
    ds_read_b128 v[36:39], v16 offset:2048
    v_mfma_f32_16x16x32_bf16 v[56:59], v[40:43], v[40:43], v[56:59]
    ds_read_b64_tr_b16 a[72:73], v8 offset:0
    ds_read_b64_tr_b16 a[74:75], v8 offset:2304
    v_mfma_f32_16x16x32_bf16 v[52:55], a[168:171], v[44:47], v[52:55]
    ds_read_b64_tr_b16 a[76:77], v8 offset:32
    ds_read_b64_tr_b16 a[78:79], v8 offset:2336
    v_mfma_f32_16x16x32_bf16 v[60:63], v[44:47], v[44:47], v[60:63]
    ds_read_b64_tr_b16 a[80:81], v8 offset:64
    ds_read_b64_tr_b16 a[82:83], v8 offset:2368
    v_mfma_f32_16x16x32_bf16 a[0:3], v[40:43], a[108:111], a[0:3]
    ds_read_b64_tr_b16 a[84:85], v8 offset:96
    v_mfma_f32_16x16x32_bf16 a[4:7], v[44:47], a[108:111], a[4:7]
    ds_read_b64_tr_b16 a[86:87], v8 offset:2400
    v_mfma_f32_16x16x32_bf16 a[8:11], v[40:43], a[112:115], a[8:11]
    ds_read_b64_tr_b16 a[88:89], v8 offset:128
    v_mfma_f32_16x16x32_bf16 a[12:15], v[44:47], a[112:115], a[12:15]
    ds_read_b64_tr_b16 a[90:91], v8 offset:2432
    v_mfma_f32_16x16x32_bf16 a[16:19], v[40:43], a[116:119], a[16:19]
    ds_read_b64_tr_b16 a[92:93], v8 offset:160
    v_mfma_f32_16x16x32_bf16 a[20:23], v[44:47], a[116:119], a[20:23]
    ds_read_b64_tr_b16 a[94:95], v8 offset:2464
    v_mfma_f32_16x16x32_bf16 a[24:27], v[40:43], a[120:123], a[24:27]
    ds_read_b64_tr_b16 a[96:97], v8 offset:192
    v_mfma_f32_16x16x32_bf16 a[28:31], v[44:47], a[120:123], a[28:31]
    ds_read_b64_tr_b16 a[98:99], v8 offset:2496
    v_mfma_f32_16x16x32_bf16 a[32:35], v[40:43], a[124:127], a[32:35]
    ds_read_b64_tr_b16 a[100:101], v8 offset:224
    v_mfma_f32_16x16x32_bf16 a[36:39], v[44:47], a[124:127], a[36:39]
    ds_read_b64_tr_b16 a[102:103], v8 offset:2528
    v_mfma_f32_16x16x32_bf16 a[40:43], v[40:43], a[128:131], a[40:43]
    ds_read_b64_tr_b16 a[104:105], v8 offset:256
    v_mfma_f32_16x16x32_bf16 a[44:47], v[44:47], a[128:131], a[44:47]
    ds_read_b64_tr_b16 a[106:107], v8 offset:2560
    v_mfma_f32_16x16x32_bf16 a[48:51], v[40:43], a[132:135], a[48:51]
    ds_read_b64_tr_b16 a[144:145], v12 offset:0
    v_mfma_f32_16x16x32_bf16 a[52:55], v[44:47], a[132:135], a[52:55]
    ds_read_b64_tr_b16 a[146:147], v12 offset:2304
    v_mfma_f32_16x16x32_bf16 a[56:59], v[40:43], a[136:139], a[56:59]
    ds_read_b64_tr_b16 a[148:149], v12 offset:128
    v_mfma_f32_16x16x32_bf16 a[60:63], v[44:47], a[136:139], a[60:63]
    ds_read_b64_tr_b16 a[150:151], v12 offset:2432
    v_mfma_f32_16x16x32_bf16 a[64:67], v[40:43], a[140:143], a[64:67]
    ds_read_b64_tr_b16 a[152:153], v8 offset:256
    v_mfma_f32_16x16x32_bf16 a[68:71], v[44:47], a[140:143], a[68:71]
    ds_read_b64_tr_b16 a[154:155], v8 offset:2560
    s_waitcnt lgkmcnt(4)
    v_mfma_f32_16x16x32_bf16 a[156:159], a[144:147], a[168:171], a[156:159]
    s_waitcnt lgkmcnt(2)
    v_mfma_f32_16x16x32_bf16 a[160:163], a[148:151], a[168:171], a[160:163]
    s_waitcnt lgkmcnt(0)
    v_mfma_f32_16x16x32_bf16 a[164:167], a[152:155], a[168:171], a[164:167]
    v_mfma_f32_16x16x32_bf16 v[48:51], a[168:171], v[32:35], v[48:51]
    ds_read_b128 v[40:43], v17 offset:0
    ds_read_b128 v[44:47], v17 offset:2048
    v_mfma_f32_16x16x32_bf16 v[56:59], v[32:35], v[32:35], v[56:59]
    ds_read_b64_tr_b16 a[108:109], v8 offset:9216
    ds_read_b64_tr_b16 a[110:111], v8 offset:11520
    v_mfma_f32_16x16x32_bf16 v[52:55], a[168:171], v[36:39], v[52:55]
    ds_read_b64_tr_b16 a[112:113], v8 offset:9248
    ds_read_b64_tr_b16 a[114:115], v8 offset:11552
    v_mfma_f32_16x16x32_bf16 v[60:63], v[36:39], v[36:39], v[60:63]
    ds_read_b64_tr_b16 a[116:117], v8 offset:9280
    ds_read_b64_tr_b16 a[118:119], v8 offset:11584
    v_mfma_f32_16x16x32_bf16 a[0:3], v[32:35], a[72:75], a[0:3]
    ds_read_b64_tr_b16 a[120:121], v8 offset:9312
    v_mfma_f32_16x16x32_bf16 a[4:7], v[36:39], a[72:75], a[4:7]
    ds_read_b64_tr_b16 a[122:123], v8 offset:11616
    v_mfma_f32_16x16x32_bf16 a[8:11], v[32:35], a[76:79], a[8:11]
    ds_read_b64_tr_b16 a[124:125], v8 offset:9344
    v_mfma_f32_16x16x32_bf16 a[12:15], v[36:39], a[76:79], a[12:15]
    ds_read_b64_tr_b16 a[126:127], v8 offset:11648
    v_mfma_f32_16x16x32_bf16 a[16:19], v[32:35], a[80:83], a[16:19]
    ds_read_b64_tr_b16 a[128:129], v8 offset:9376
    v_mfma_f32_16x16x32_bf16 a[20:23], v[36:39], a[80:83], a[20:23]
    ds_read_b64_tr_b16 a[130:131], v8 offset:11680
    v_mfma_f32_16x16x32_bf16 a[24:27], v[32:35], a[84:87], a[24:27]
    ds_read_b64_tr_b16 a[132:133], v8 offset:9408
    v_mfma_f32_16x16x32_bf16 a[28:31], v[36:39], a[84:87], a[28:31]
    ds_read_b64_tr_b16 a[134:135], v8 offset:11712
    v_mfma_f32_16x16x32_bf16 a[32:35], v[32:35], a[88:91], a[32:35]
    ds_read_b64_tr_b16 a[136:137], v8 offset:9440
    v_mfma_f32_16x16x32_bf16 a[36:39], v[36:39], a[88:91], a[36:39]
    ds_read_b64_tr_b16 a[138:139], v8 offset:11744
    v_mfma_f32_16x16x32_bf16 a[40:43], v[32:35], a[92:95], a[40:43]
    ds_read_b64_tr_b16 a[140:141], v8 offset:9472
    v_mfma_f32_16x16x32_bf16 a[44:47], v[36:39], a[92:95], a[44:47]
    ds_read_b64_tr_b16 a[142:143], v8 offset:11776
    v_mfma_f32_16x16x32_bf16 a[48:51], v[32:35], a[96:99], a[48:51]
    ds_read_b64_tr_b16 a[144:145], v12 offset:9216
    v_mfma_f32_16x16x32_bf16 a[52:55], v[36:39], a[96:99], a[52:55]
    ds_read_b64_tr_b16 a[146:147], v12 offset:11520
    v_mfma_f32_16x16x32_bf16 a[56:59], v[32:35], a[100:103], a[56:59]
    ds_read_b64_tr_b16 a[148:149], v12 offset:9344
    v_mfma_f32_16x16x32_bf16 a[60:63], v[36:39], a[100:103], a[60:63]
    ds_read_b64_tr_b16 a[150:151], v12 offset:11648
    v_mfma_f32_16x16x32_bf16 a[64:67], v[32:35], a[104:107], a[64:67]
    ds_read_b64_tr_b16 a[152:153], v8 offset:9472
    v_mfma_f32_16x16x32_bf16 a[68:71], v[36:39], a[104:107], a[68:71]
    ds_read_b64_tr_b16 a[154:155], v8 offset:11776
    s_barrier
    s_waitcnt lgkmcnt(4)
    v_mfma_f32_16x16x32_bf16 a[156:159], a[144:147], a[168:171], a[156:159]
    s_waitcnt lgkmcnt(2)
    v_mfma_f32_16x16x32_bf16 a[160:163], a[148:151], a[168:171], a[160:163]
    s_waitcnt lgkmcnt(0)
    v_mfma_f32_16x16x32_bf16 a[164:167], a[152:155], a[168:171], a[164:167]
    v_mfma_f32_16x16x32_bf16 v[48:51], a[168:171], v[40:43], v[48:51]
    ds_read_b128 v[32:35], v18 offset:0
    ds_read_b128 v[36:39], v18 offset:2048
    v_mfma_f32_16x16x32_bf16 v[56:59], v[40:43], v[40:43], v[56:59]
    ds_read_b64_tr_b16 a[72:73], v9 offset:0
    ds_read_b64_tr_b16 a[74:75], v9 offset:2304
    v_mfma_f32_16x16x32_bf16 v[52:55], a[168:171], v[44:47], v[52:55]
    ds_read_b64_tr_b16 a[76:77], v9 offset:32
    ds_read_b64_tr_b16 a[78:79], v9 offset:2336
    v_mfma_f32_16x16x32_bf16 v[60:63], v[44:47], v[44:47], v[60:63]
    ds_read_b64_tr_b16 a[80:81], v9 offset:64
    ds_read_b64_tr_b16 a[82:83], v9 offset:2368
    v_mfma_f32_16x16x32_bf16 a[0:3], v[40:43], a[108:111], a[0:3]
    ds_read_b64_tr_b16 a[84:85], v9 offset:96
    v_mfma_f32_16x16x32_bf16 a[4:7], v[44:47], a[108:111], a[4:7]
    ds_read_b64_tr_b16 a[86:87], v9 offset:2400
    v_mfma_f32_16x16x32_bf16 a[8:11], v[40:43], a[112:115], a[8:11]
    ds_read_b64_tr_b16 a[88:89], v9 offset:128
    v_mfma_f32_16x16x32_bf16 a[12:15], v[44:47], a[112:115], a[12:15]
    ds_read_b64_tr_b16 a[90:91], v9 offset:2432
    v_mfma_f32_16x16x32_bf16 a[16:19], v[40:43], a[116:119], a[16:19]
    ds_read_b64_tr_b16 a[92:93], v9 offset:160
    v_mfma_f32_16x16x32_bf16 a[20:23], v[44:47], a[116:119], a[20:23]
    ds_read_b64_tr_b16 a[94:95], v9 offset:2464
    v_mfma_f32_16x16x32_bf16 a[24:27], v[40:43], a[120:123], a[24:27]
    ds_read_b64_tr_b16 a[96:97], v9 offset:192
    v_mfma_f32_16x16x32_bf16 a[28:31], v[44:47], a[120:123], a[28:31]
    ds_read_b64_tr_b16 a[98:99], v9 offset:2496
    v_mfma_f32_16x16x32_bf16 a[32:35], v[40:43], a[124:127], a[32:35]
    ds_read_b64_tr_b16 a[100:101], v9 offset:224
    v_mfma_f32_16x16x32_bf16 a[36:39], v[44:47], a[124:127], a[36:39]
    ds_read_b64_tr_b16 a[102:103], v9 offset:2528
    v_mfma_f32_16x16x32_bf16 a[40:43], v[40:43], a[128:131], a[40:43]
    ds_read_b64_tr_b16 a[104:105], v9 offset:256
    v_mfma_f32_16x16x32_bf16 a[44:47], v[44:47], a[128:131], a[44:47]
    ds_read_b64_tr_b16 a[106:107], v9 offset:2560
    v_mfma_f32_16x16x32_bf16 a[48:51], v[40:43], a[132:135], a[48:51]
    ds_read_b64_tr_b16 a[144:145], v13 offset:0
    v_mfma_f32_16x16x32_bf16 a[52:55], v[44:47], a[132:135], a[52:55]
    ds_read_b64_tr_b16 a[146:147], v13 offset:2304
    v_mfma_f32_16x16x32_bf16 a[56:59], v[40:43], a[136:139], a[56:59]
    ds_read_b64_tr_b16 a[148:149], v13 offset:128
    v_mfma_f32_16x16x32_bf16 a[60:63], v[44:47], a[136:139], a[60:63]
    ds_read_b64_tr_b16 a[150:151], v13 offset:2432
    v_mfma_f32_16x16x32_bf16 a[64:67], v[40:43], a[140:143], a[64:67]
    ds_read_b64_tr_b16 a[152:153], v9 offset:256
    v_mfma_f32_16x16x32_bf16 a[68:71], v[44:47], a[140:143], a[68:71]
    ds_read_b64_tr_b16 a[154:155], v9 offset:2560
    s_waitcnt lgkmcnt(4)
    v_mfma_f32_16x16x32_bf16 a[156:159], a[144:147], a[168:171], a[156:159]
    s_waitcnt lgkmcnt(2)
    v_mfma_f32_16x16x32_bf16 a[160:163], a[148:151], a[168:171], a[160:163]
    s_waitcnt lgkmcnt(0)
    v_mfma_f32_16x16x32_bf16 a[164:167], a[152:155], a[168:171], a[164:167]
    v_mfma_f32_16x16x32_bf16 v[48:51], a[168:171], v[32:35], v[48:51]
    ds_read_b128 v[40:43], v19 offset:0
    ds_read_b128 v[44:47], v19 offset:2048
    v_mfma_f32_16x16x32_bf16 v[56:59], v[32:35], v[32:35], v[56:59]
    ds_read_b64_tr_b16 a[108:109], v9 offset:9216
    ds_read_b64_tr_b16 a[110:111], v9 offset:11520
    v_mfma_f32_16x16x32_bf16 v[52:55], a[168:171], v[36:39], v[52:55]
    ds_read_b64_tr_b16 a[112:113], v9 offset:9248
    ds_read_b64_tr_b16 a[114:115], v9 offset:11552
    v_mfma_f32_16x16x32_bf16 v[60:63], v[36:39], v[36:39], v[60:63]
    ds_read_b64_tr_b16 a[116:117], v9 offset:9280
    ds_read_b64_tr_b16 a[118:119], v9 offset:11584
    v_mfma_f32_16x16x32_bf16 a[0:3], v[32:35], a[72:75], a[0:3]
    ds_read_b64_tr_b16 a[120:121], v9 offset:9312
    v_mfma_f32_16x16x32_bf16 a[4:7], v[36:39], a[72:75], a[4:7]
    ds_read_b64_tr_b16 a[122:123], v9 offset:11616
    v_mfma_f32_16x16x32_bf16 a[8:11], v[32:35], a[76:79], a[8:11]
    ds_read_b64_tr_b16 a[124:125], v9 offset:9344
    v_mfma_f32_16x16x32_bf16 a[12:15], v[36:39], a[76:79], a[12:15]
    ds_read_b64_tr_b16 a[126:127], v9 offset:11648
    v_mfma_f32_16x16x32_bf16 a[16:19], v[32:35], a[80:83], a[16:19]
    ds_read_b64_tr_b16 a[128:129], v9 offset:9376
    v_mfma_f32_16x16x32_bf16 a[20:23], v[36:39], a[80:83], a[20:23]
    ds_read_b64_tr_b16 a[130:131], v9 offset:11680
    v_mfma_f32_16x16x32_bf16 a[24:27], v[32:35], a[84:87], a[24:27]
    ds_read_b64_tr_b16 a[132:133], v9 offset:9408
    v_mfma_f32_16x16x32_bf16 a[28:31], v[36:39], a[84:87], a[28:31]
    ds_read_b64_tr_b16 a[134:135], v9 offset:11712
    v_mfma_f32_16x16x32_bf16 a[32:35], v[32:35], a[88:91], a[32:35]
    ds_read_b64_tr_b16 a[136:137], v9 offset:9440
    v_mfma_f32_16x16x32_bf16 a[36:39], v[36:39], a[88:91], a[36:39]
    ds_read_b64_tr_b16 a[138:139], v9 offset:11744
    v_mfma_f32_16x16x32_bf16 a[40:43], v[32:35], a[92:95], a[40:43]
    ds_read_b64_tr_b16 a[140:141], v9 offset:9472
    v_mfma_f32_16x16x32_bf16 a[44:47], v[36:39], a[92:95], a[44:47]
    ds_read_b64_tr_b16 a[142:143], v9 offset:11776
    v_mfma_f32_16x16x32_bf16 a[48:51], v[32:35], a[96:99], a[48:51]
    ds_read_b64_tr_b16 a[144:145], v13 offset:9216
    v_mfma_f32_16x16x32_bf16 a[52:55], v[36:39], a[96:99], a[52:55]
    ds_read_b64_tr_b16 a[146:147], v13 offset:11520
    v_mfma_f32_16x16x32_bf16 a[56:59], v[32:35], a[100:103], a[56:59]
    ds_read_b64_tr_b16 a[148:149], v13 offset:9344
    v_mfma_f32_16x16x32_bf16 a[60:63], v[36:39], a[100:103], a[60:63]
    ds_read_b64_tr_b16 a[150:151], v13 offset:11648
    v_mfma_f32_16x16x32_bf16 a[64:67], v[32:35], a[104:107], a[64:67]
    ds_read_b64_tr_b16 a[152:153], v9 offset:9472
    v_mfma_f32_16x16x32_bf16 a[68:71], v[36:39], a[104:107], a[68:71]
    ds_read_b64_tr_b16 a[154:155], v9 offset:11776
    s_barrier
    s_waitcnt lgkmcnt(4)
    v_mfma_f32_16x16x32_bf16 a[156:159], a[144:147], a[168:171], a[156:159]
    s_waitcnt lgkmcnt(2)
    v_mfma_f32_16x16x32_bf16 a[160:163], a[148:151], a[168:171], a[160:163]
    s_waitcnt lgkmcnt(0)
    v_mfma_f32_16x16x32_bf16 a[164:167], a[152:155], a[168:171], a[164:167]
    v_mfma_f32_16x16x32_bf16 v[48:51], a[168:171], v[40:43], v[48:51]
    ds_read_b128 v[32:35], v20 offset:0
    ds_read_b128 v[36:39], v20 offset:2048
    v_mfma_f32_16x16x32_bf16 v[56:59], v[40:43], v[40:43], v[56:59]
    ds_read_b64_tr_b16 a[72:73], v10 offset:0
    ds_read_b64_tr_b16 a[74:75], v10 offset:2304
    v_mfma_f32_16x16x32_bf16 v[52:55], a[168:171], v[44:47], v[52:55]
    ds_read_b64_tr_b16 a[76:77], v10 offset:32
    ds_read_b64_tr_b16 a[78:79], v10 offset:2336
    v_mfma_f32_16x16x32_bf16 v[60:63], v[44:47], v[44:47], v[60:63]
    ds_read_b64_tr_b16 a[80:81], v10 offset:64
    ds_read_b64_tr_b16 a[82:83], v10 offset:2368
    v_mfma_f32_16x16x32_bf16 a[0:3], v[40:43], a[108:111], a[0:3]
    ds_read_b64_tr_b16 a[84:85], v10 offset:96
    v_mfma_f32_16x16x32_bf16 a[4:7], v[44:47], a[108:111], a[4:7]
    ds_read_b64_tr_b16 a[86:87], v10 offset:2400
    v_mfma_f32_16x16x32_bf16 a[8:11], v[40:43], a[112:115], a[8:11]
    ds_read_b64_tr_b16 a[88:89], v10 offset:128
    v_mfma_f32_16x16x32_bf16 a[12:15], v[44:47], a[112:115], a[12:15]
    ds_read_b64_tr_b16 a[90:91], v10 offset:2432
    v_mfma_f32_16x16x32_bf16 a[16:19], v[40:43], a[116:119], a[16:19]
    ds_read_b64_tr_b16 a[92:93], v10 offset:160
    v_mfma_f32_16x16x32_bf16 a[20:23], v[44:47], a[116:119], a[20:23]
    ds_read_b64_tr_b16 a[94:95], v10 offset:2464
    v_mfma_f32_16x16x32_bf16 a[24:27], v[40:43], a[120:123], a[24:27]
    ds_read_b64_tr_b16 a[96:97], v10 offset:192
    v_mfma_f32_16x16x32_bf16 a[28:31], v[44:47], a[120:123], a[28:31]
    ds_read_b64_tr_b16 a[98:99], v10 offset:2496
    v_mfma_f32_16x16x32_bf16 a[32:35], v[40:43], a[124:127], a[32:35]
    ds_read_b64_tr_b16 a[100:101], v10 offset:224
    v_mfma_f32_16x16x32_bf16 a[36:39], v[44:47], a[124:127], a[36:39]
    ds_read_b64_tr_b16 a[102:103], v10 offset:2528
    v_mfma_f32_16x16x32_bf16 a[40:43], v[40:43], a[128:131], a[40:43]
    ds_read_b64_tr_b16 a[104:105], v10 offset:256
    v_mfma_f32_16x16x32_bf16 a[44:47], v[44:47], a[128:131], a[44:47]
    ds_read_b64_tr_b16 a[106:107], v10 offset:2560
    v_mfma_f32_16x16x32_bf16 a[48:51], v[40:43], a[132:135], a[48:51]
    ds_read_b64_tr_b16 a[144:145], v14 offset:0
    v_mfma_f32_16x16x32_bf16 a[52:55], v[44:47], a[132:135], a[52:55]
    ds_read_b64_tr_b16 a[146:147], v14 offset:2304
    v_mfma_f32_16x16x32_bf16 a[56:59], v[40:43], a[136:139], a[56:59]
    ds_read_b64_tr_b16 a[148:149], v14 offset:128
    v_mfma_f32_16x16x32_bf16 a[60:63], v[44:47], a[136:139], a[60:63]
    ds_read_b64_tr_b16 a[150:151], v14 offset:2432
    v_mfma_f32_16x16x32_bf16 a[64:67], v[40:43], a[140:143], a[64:67]
    ds_read_b64_tr_b16 a[152:153], v10 offset:256
    v_mfma_f32_16x16x32_bf16 a[68:71], v[44:47], a[140:143], a[68:71]
    ds_read_b64_tr_b16 a[154:155], v10 offset:2560
    s_waitcnt lgkmcnt(4)
    v_mfma_f32_16x16x32_bf16 a[156:159], a[144:147], a[168:171], a[156:159]
    s_waitcnt lgkmcnt(2)
    v_mfma_f32_16x16x32_bf16 a[160:163], a[148:151], a[168:171], a[160:163]
    s_waitcnt lgkmcnt(0)
    v_mfma_f32_16x16x32_bf16 a[164:167], a[152:155], a[168:171], a[164:167]
    v_mfma_f32_16x16x32_bf16 v[48:51], a[168:171], v[32:35], v[48:51]
    ds_read_b128 v[40:43], v21 offset:0
    ds_read_b128 v[44:47], v21 offset:2048
    v_mfma_f32_16x16x32_bf16 v[56:59], v[32:35], v[32:35], v[56:59]
    ds_read_b64_tr_b16 a[108:109], v10 offset:9216
    ds_read_b64_tr_b16 a[110:111], v10 offset:11520
    v_mfma_f32_16x16x32_bf16 v[52:55], a[168:171], v[36:39], v[52:55]
    ds_read_b64_tr_b16 a[112:113], v10 offset:9248
    ds_read_b64_tr_b16 a[114:115], v10 offset:11552
    v_mfma_f32_16x16x32_bf16 v[60:63], v[36:39], v[36:39], v[60:63]
    ds_read_b64_tr_b16 a[116:117], v10 offset:9280
    ds_read_b64_tr_b16 a[118:119], v10 offset:11584
    v_mfma_f32_16x16x32_bf16 a[0:3], v[32:35], a[72:75], a[0:3]
    ds_read_b64_tr_b16 a[120:121], v10 offset:9312
    v_mfma_f32_16x16x32_bf16 a[4:7], v[36:39], a[72:75], a[4:7]
    ds_read_b64_tr_b16 a[122:123], v10 offset:11616
    v_mfma_f32_16x16x32_bf16 a[8:11], v[32:35], a[76:79], a[8:11]
    ds_read_b64_tr_b16 a[124:125], v10 offset:9344
    v_mfma_f32_16x16x32_bf16 a[12:15], v[36:39], a[76:79], a[12:15]
    ds_read_b64_tr_b16 a[126:127], v10 offset:11648
    v_mfma_f32_16x16x32_bf16 a[16:19], v[32:35], a[80:83], a[16:19]
    ds_read_b64_tr_b16 a[128:129], v10 offset:9376
    v_mfma_f32_16x16x32_bf16 a[20:23], v[36:39], a[80:83], a[20:23]
    ds_read_b64_tr_b16 a[130:131], v10 offset:11680
    v_mfma_f32_16x16x32_bf16 a[24:27], v[32:35], a[84:87], a[24:27]
    ds_read_b64_tr_b16 a[132:133], v10 offset:9408
    v_mfma_f32_16x16x32_bf16 a[28:31], v[36:39], a[84:87], a[28:31]
    ds_read_b64_tr_b16 a[134:135], v10 offset:11712
    v_mfma_f32_16x16x32_bf16 a[32:35], v[32:35], a[88:91], a[32:35]
    ds_read_b64_tr_b16 a[136:137], v10 offset:9440
    v_mfma_f32_16x16x32_bf16 a[36:39], v[36:39], a[88:91], a[36:39]
    ds_read_b64_tr_b16 a[138:139], v10 offset:11744
    v_mfma_f32_16x16x32_bf16 a[40:43], v[32:35], a[92:95], a[40:43]
    ds_read_b64_tr_b16 a[140:141], v10 offset:9472
    v_mfma_f32_16x16x32_bf16 a[44:47], v[36:39], a[92:95], a[44:47]
    ds_read_b64_tr_b16 a[142:143], v10 offset:11776
    v_mfma_f32_16x16x32_bf16 a[48:51], v[32:35], a[96:99], a[48:51]
    ds_read_b64_tr_b16 a[144:145], v14 offset:9216
    v_mfma_f32_16x16x32_bf16 a[52:55], v[36:39], a[96:99], a[52:55]
    ds_read_b64_tr_b16 a[146:147], v14 offset:11520
    v_mfma_f32_16x16x32_bf16 a[56:59], v[32:35], a[100:103], a[56:59]
    ds_read_b64_tr_b16 a[148:149], v14 offset:9344
    v_mfma_f32_16x16x32_bf16 a[60:63], v[36:39], a[100:103], a[60:63]
    ds_read_b64_tr_b16 a[150:151], v14 offset:11648
    v_mfma_f32_16x16x32_bf16 a[64:67], v[32:35], a[104:107], a[64:67]
    ds_read_b64_tr_b16 a[152:153], v10 offset:9472
    v_mfma_f32_16x16x32_bf16 a[68:71], v[36:39], a[104:107], a[68:71]
    ds_read_b64_tr_b16 a[154:155], v10 offset:11776
    s_barrier
    s_waitcnt lgkmcnt(4)
    v_mfma_f32_16x16x32_bf16 a[156:159], a[144:147], a[168:171], a[156:159]
    s_waitcnt lgkmcnt(2)
    v_mfma_f32_16x16x32_bf16 a[160:163], a[148:151], a[168:171], a[160:163]
    s_waitcnt lgkmcnt(0)
    v_mfma_f32_16x16x32_bf16 a[164:167], a[152:155], a[168:171], a[164:167]
    v_mfma_f32_16x16x32_bf16 v[48:51], a[168:171], v[40:43], v[48:51]
    ds_read_b128 v[32:35], v22 offset:0
    ds_read_b128 v[36:39], v22 offset:2048
    v_mfma_f32_16x16x32_bf16 v[56:59], v[40:43], v[40:43], v[56:59]
    ds_read_b64_tr_b16 a[72:73], v11 offset:0
    ds_read_b64_tr_b16 a[74:75], v11 offset:2304
    v_mfma_f32_16x16x32_bf16 v[52:55], a[168:171], v[44:47], v[52:55]
    ds_read_b64_tr_b16 a[76:77], v11 offset:32
    ds_read_b64_tr_b16 a[78:79], v11 offset:2336
    v_mfma_f32_16x16x32_bf16 v[60:63], v[44:47], v[44:47], v[60:63]
    ds_read_b64_tr_b16 a[80:81], v11 offset:64
    ds_read_b64_tr_b16 a[82:83], v11 offset:2368
    v_mfma_f32_16x16x32_bf16 a[0:3], v[40:43], a[108:111], a[0:3]
    ds_read_b64_tr_b16 a[84:85], v11 offset:96
    v_mfma_f32_16x16x32_bf16 a[4:7], v[44:47], a[108:111], a[4:7]
    ds_read_b64_tr_b16 a[86:87], v11 offset:2400
    v_mfma_f32_16x16x32_bf16 a[8:11], v[40:43], a[112:115], a[8:11]
    ds_read_b64_tr_b16 a[88:89], v11 offset:128
    v_mfma_f32_16x16x32_bf16 a[12:15], v[44:47], a[112:115], a[12:15]
    ds_read_b64_tr_b16 a[90:91], v11 offset:2432
    v_mfma_f32_16x16x32_bf16 a[16:19], v[40:43], a[116:119], a[16:19]
    ds_read_b64_tr_b16 a[92:93], v11 offset:160
    v_mfma_f32_16x16x32_bf16 a[20:23], v[44:47], a[116:119], a[20:23]
    ds_read_b64_tr_b16 a[94:95], v11 offset:2464
    v_mfma_f32_16x16x32_bf16 a[24:27], v[40:43], a[120:123], a[24:27]
    ds_read_b64_tr_b16 a[96:97], v11 offset:192
    v_mfma_f32_16x16x32_bf16 a[28:31], v[44:47], a[120:123], a[28:31]
    ds_read_b64_tr_b16 a[98:99], v11 offset:2496
    v_mfma_f32_16x16x32_bf16 a[32:35], v[40:43], a[124:127], a[32:35]
    ds_read_b64_tr_b16 a[100:101], v11 offset:224
    v_mfma_f32_16x16x32_bf16 a[36:39], v[44:47], a[124:127], a[36:39]
    ds_read_b64_tr_b16 a[102:103], v11 offset:2528
    v_mfma_f32_16x16x32_bf16 a[40:43], v[40:43], a[128:131], a[40:43]
    ds_read_b64_tr_b16 a[104:105], v11 offset:256
    v_mfma_f32_16x16x32_bf16 a[44:47], v[44:47], a[128:131], a[44:47]
    ds_read_b64_tr_b16 a[106:107], v11 offset:2560
    v_mfma_f32_16x16x32_bf16 a[48:51], v[40:43], a[132:135], a[48:51]
    ds_read_b64_tr_b16 a[144:145], v15 offset:0
    v_mfma_f32_16x16x32_bf16 a[52:55], v[44:47], a[132:135], a[52:55]
    ds_read_b64_tr_b16 a[146:147], v15 offset:2304
    v_mfma_f32_16x16x32_bf16 a[56:59], v[40:43], a[136:139], a[56:59]
    ds_read_b64_tr_b16 a[148:149], v15 offset:128
    v_mfma_f32_16x16x32_bf16 a[60:63], v[44:47], a[136:139], a[60:63]
    ds_read_b64_tr_b16 a[150:151], v15 offset:2432
    v_mfma_f32_16x16x32_bf16 a[64:67], v[40:43], a[140:143], a[64:67]
    ds_read_b64_tr_b16 a[152:153], v11 offset:256
    v_mfma_f32_16x16x32_bf16 a[68:71], v[44:47], a[140:143], a[68:71]
    ds_read_b64_tr_b16 a[154:155], v11 offset:2560
    s_waitcnt lgkmcnt(4)
    v_mfma_f32_16x16x32_bf16 a[156:159], a[144:147], a[168:171], a[156:159]
    s_waitcnt lgkmcnt(2)
    v_mfma_f32_16x16x32_bf16 a[160:163], a[148:151], a[168:171], a[160:163]
    s_waitcnt lgkmcnt(0)
    v_mfma_f32_16x16x32_bf16 a[164:167], a[152:155], a[168:171], a[164:167]
    v_mfma_f32_16x16x32_bf16 v[48:51], a[168:171], v[32:35], v[48:51]
    ds_read_b128 v[40:43], v23 offset:0
    ds_read_b128 v[44:47], v23 offset:2048
    v_mfma_f32_16x16x32_bf16 v[56:59], v[32:35], v[32:35], v[56:59]
    ds_read_b64_tr_b16 a[108:109], v11 offset:9216
    ds_read_b64_tr_b16 a[110:111], v11 offset:11520
    v_mfma_f32_16x16x32_bf16 v[52:55], a[168:171], v[36:39], v[52:55]
    ds_read_b64_tr_b16 a[112:113], v11 offset:9248
    ds_read_b64_tr_b16 a[114:115], v11 offset:11552
    v_mfma_f32_16x16x32_bf16 v[60:63], v[36:39], v[36:39], v[60:63]
    ds_read_b64_tr_b16 a[116:117], v11 offset:9280
    ds_read_b64_tr_b16 a[118:119], v11 offset:11584
    v_mfma_f32_16x16x32_bf16 a[0:3], v[32:35], a[72:75], a[0:3]
    ds_read_b64_tr_b16 a[120:121], v11 offset:9312
    v_mfma_f32_16x16x32_bf16 a[4:7], v[36:39], a[72:75], a[4:7]
    ds_read_b64_tr_b16 a[122:123], v11 offset:11616
    v_mfma_f32_16x16x32_bf16 a[8:11], v[32:35], a[76:79], a[8:11]
    ds_read_b64_tr_b16 a[124:125], v11 offset:9344
    v_mfma_f32_16x16x32_bf16 a[12:15], v[36:39], a[76:79], a[12:15]
    ds_read_b64_tr_b16 a[126:127], v11 offset:11648
    v_mfma_f32_16x16x32_bf16 a[16:19], v[32:35], a[80:83], a[16:19]
    ds_read_b64_tr_b16 a[128:129], v11 offset:9376
    v_mfma_f32_16x16x32_bf16 a[20:23], v[36:39], a[80:83], a[20:23]
    ds_read_b64_tr_b16 a[130:131], v11 offset:11680
    v_mfma_f32_16x16x32_bf16 a[24:27], v[32:35], a[84:87], a[24:27]
    ds_read_b64_tr_b16 a[132:133], v11 offset:9408
    v_mfma_f32_16x16x32_bf16 a[28:31], v[36:39], a[84:87], a[28:31]
    ds_read_b64_tr_b16 a[134:135], v11 offset:11712
    v_mfma_f32_16x16x32_bf16 a[32:35], v[32:35], a[88:91], a[32:35]
    ds_read_b64_tr_b16 a[136:137], v11 offset:9440
    v_mfma_f32_16x16x32_bf16 a[36:39], v[36:39], a[88:91], a[36:39]
    ds_read_b64_tr_b16 a[138:139], v11 offset:11744
    v_mfma_f32_16x16x32_bf16 a[40:43], v[32:35], a[92:95], a[40:43]
    ds_read_b64_tr_b16 a[140:141], v11 offset:9472
    v_mfma_f32_16x16x32_bf16 a[44:47], v[36:39], a[92:95], a[44:47]
    ds_read_b64_tr_b16 a[142:143], v11 offset:11776
    v_mfma_f32_16x16x32_bf16 a[48:51], v[32:35], a[96:99], a[48:51]
    ds_read_b64_tr_b16 a[144:145], v15 offset:9216
    v_mfma_f32_16x16x32_bf16 a[52:55], v[36:39], a[96:99], a[52:55]
    ds_read_b64_tr_b16 a[146:147], v15 offset:11520
    v_mfma_f32_16x16x32_bf16 a[56:59], v[32:35], a[100:103], a[56:59]
    ds_read_b64_tr_b16 a[148:149], v15 offset:9344
    v_mfma_f32_16x16x32_bf16 a[60:63], v[36:39], a[100:103], a[60:63]
    ds_read_b64_tr_b16 a[150:151], v15 offset:11648
    v_mfma_f32_16x16x32_bf16 a[64:67], v[32:35], a[104:107], a[64:67]
    ds_read_b64_tr_b16 a[152:153], v11 offset:9472
    v_mfma_f32_16x16x32_bf16 a[68:71], v[36:39], a[104:107], a[68:71]
    ds_read_b64_tr_b16 a[154:155], v11 offset:11776
    s_barrier
    s_waitcnt lgkmcnt(4)
    v_mfma_f32_16x16x32_bf16 a[156:159], a[144:147], a[168:171], a[156:159]
    s_waitcnt lgkmcnt(2)
    v_mfma_f32_16x16x32_bf16 a[160:163], a[148:151], a[168:171], a[160:163]
    s_waitcnt lgkmcnt(0)
    v_mfma_f32_16x16x32_bf16 a[164:167], a[152:155], a[168:171], a[164:167]
    v_mfma_f32_16x16x32_bf16 v[48:51], a[168:171], v[40:43], v[48:51]
    ds_read_b128 v[32:35], v16 offset:0
    ds_read_b128 v[36:39], v16 offset:2048
    v_mfma_f32_16x16x32_bf16 v[56:59], v[40:43], v[40:43], v[56:59]
    ds_read_b64_tr_b16 a[72:73], v8 offset:0
    ds_read_b64_tr_b16 a[74:75], v8 offset:2304
    v_mfma_f32_16x16x32_bf16 v[52:55], a[168:171], v[44:47], v[52:55]
    ds_read_b64_tr_b16 a[76:77], v8 offset:32
    ds_read_b64_tr_b16 a[78:79], v8 offset:2336
    v_mfma_f32_16x16x32_bf16 v[60:63], v[44:47], v[44:47], v[60:63]
    ds_read_b64_tr_b16 a[80:81], v8 offset:64
    ds_read_b64_tr_b16 a[82:83], v8 offset:2368
    v_mfma_f32_16x16x32_bf16 a[0:3], v[40:43], a[108:111], a[0:3]
    ds_read_b64_tr_b16 a[84:85], v8 offset:96
    v_mfma_f32_16x16x32_bf16 a[4:7], v[44:47], a[108:111], a[4:7]
    ds_read_b64_tr_b16 a[86:87], v8 offset:2400
    v_mfma_f32_16x16x32_bf16 a[8:11], v[40:43], a[112:115], a[8:11]
    ds_read_b64_tr_b16 a[88:89], v8 offset:128
    v_mfma_f32_16x16x32_bf16 a[12:15], v[44:47], a[112:115], a[12:15]
    ds_read_b64_tr_b16 a[90:91], v8 offset:2432
    v_mfma_f32_16x16x32_bf16 a[16:19], v[40:43], a[116:119], a[16:19]
    ds_read_b64_tr_b16 a[92:93], v8 offset:160
    v_mfma_f32_16x16x32_bf16 a[20:23], v[44:47], a[116:119], a[20:23]
    ds_read_b64_tr_b16 a[94:95], v8 offset:2464
    v_mfma_f32_16x16x32_bf16 a[24:27], v[40:43], a[120:123], a[24:27]
    ds_read_b64_tr_b16 a[96:97], v8 offset:192
    v_mfma_f32_16x16x32_bf16 a[28:31], v[44:47], a[120:123], a[28:31]
    ds_read_b64_tr_b16 a[98:99], v8 offset:2496
    v_mfma_f32_16x16x32_bf16 a[32:35], v[40:43], a[124:127], a[32:35]
    ds_read_b64_tr_b16 a[100:101], v8 offset:224
    v_mfma_f32_16x16x32_bf16 a[36:39], v[44:47], a[124:127], a[36:39]
    ds_read_b64_tr_b16 a[102:103], v8 offset:2528
    v_mfma_f32_16x16x32_bf16 a[40:43], v[40:43], a[128:131], a[40:43]
    ds_read_b64_tr_b16 a[104:105], v8 offset:256
    v_mfma_f32_16x16x32_bf16 a[44:47], v[44:47], a[128:131], a[44:47]
    ds_read_b64_tr_b16 a[106:107], v8 offset:2560
    v_mfma_f32_16x16x32_bf16 a[48:51], v[40:43], a[132:135], a[48:51]
    ds_read_b64_tr_b16 a[144:145], v12 offset:0
    v_mfma_f32_16x16x32_bf16 a[52:55], v[44:47], a[132:135], a[52:55]
    ds_read_b64_tr_b16 a[146:147], v12 offset:2304
    v_mfma_f32_16x16x32_bf16 a[56:59], v[40:43], a[136:139], a[56:59]
    ds_read_b64_tr_b16 a[148:149], v12 offset:128
    v_mfma_f32_16x16x32_bf16 a[60:63], v[44:47], a[136:139], a[60:63]
    ds_read_b64_tr_b16 a[150:151], v12 offset:2432
    v_mfma_f32_16x16x32_bf16 a[64:67], v[40:43], a[140:143], a[64:67]
    ds_read_b64_tr_b16 a[152:153], v8 offset:256
    v_mfma_f32_16x16x32_bf16 a[68:71], v[44:47], a[140:143], a[68:71]
    ds_read_b64_tr_b16 a[154:155], v8 offset:2560
    s_waitcnt lgkmcnt(4)
    v_mfma_f32_16x16x32_bf16 a[156:159], a[144:147], a[168:171], a[156:159]
    s_waitcnt lgkmcnt(2)
    v_mfma_f32_16x16x32_bf16 a[160:163], a[148:151], a[168:171], a[160:163]
    s_waitcnt lgkmcnt(0)
    v_mfma_f32_16x16x32_bf16 a[164:167], a[152:155], a[168:171], a[164:167]
    v_mfma_f32_16x16x32_bf16 v[48:51], a[168:171], v[32:35], v[48:51]
    ds_read_b128 v[40:43], v17 offset:0
    ds_read_b128 v[44:47], v17 offset:2048
    v_mfma_f32_16x16x32_bf16 v[56:59], v[32:35], v[32:35], v[56:59]
    ds_read_b64_tr_b16 a[108:109], v8 offset:9216
    ds_read_b64_tr_b16 a[110:111], v8 offset:11520
    v_mfma_f32_16x16x32_bf16 v[52:55], a[168:171], v[36:39], v[52:55]
    ds_read_b64_tr_b16 a[112:113], v8 offset:9248
    ds_read_b64_tr_b16 a[114:115], v8 offset:11552
    v_mfma_f32_16x16x32_bf16 v[60:63], v[36:39], v[36:39], v[60:63]
    ds_read_b64_tr_b16 a[116:117], v8 offset:9280
    ds_read_b64_tr_b16 a[118:119], v8 offset:11584
    v_mfma_f32_16x16x32_bf16 a[0:3], v[32:35], a[72:75], a[0:3]
    ds_read_b64_tr_b16 a[120:121], v8 offset:9312
    v_mfma_f32_16x16x32_bf16 a[4:7], v[36:39], a[72:75], a[4:7]
    ds_read_b64_tr_b16 a[122:123], v8 offset:11616
    v_mfma_f32_16x16x32_bf16 a[8:11], v[32:35], a[76:79], a[8:11]
    ds_read_b64_tr_b16 a[124:125], v8 offset:9344
    v_mfma_f32_16x16x32_bf16 a[12:15], v[36:39], a[76:79], a[12:15]
    ds_read_b64_tr_b16 a[126:127], v8 offset:11648
    v_mfma_f32_16x16x32_bf16 a[16:19], v[32:35], a[80:83], a[16:19]
    ds_read_b64_tr_b16 a[128:129], v8 offset:9376
    v_mfma_f32_16x16x32_bf16 a[20:23], v[36:39], a[80:83], a[20:23]
    ds_read_b64_tr_b16 a[130:131], v8 offset:11680
    v_mfma_f32_16x16x32_bf16 a[24:27], v[32:35], a[84:87], a[24:27]
    ds_read_b64_tr_b16 a[132:133], v8 offset:9408
    v_mfma_f32_16x16x32_bf16 a[28:31], v[36:39], a[84:87], a[28:31]
    ds_read_b64_tr_b16 a[134:135], v8 offset:11712
    v_mfma_f32_16x16x32_bf16 a[32:35], v[32:35], a[88:91], a[32:35]
    ds_read_b64_tr_b16 a[136:137], v8 offset:9440
    v_mfma_f32_16x16x32_bf16 a[36:39], v[36:39], a[88:91], a[36:39]
    ds_read_b64_tr_b16 a[138:139], v8 offset:11744
    v_mfma_f32_16x16x32_bf16 a[40:43], v[32:35], a[92:95], a[40:43]
    ds_read_b64_tr_b16 a[140:141], v8 offset:9472
    v_mfma_f32_16x16x32_bf16 a[44:47], v[36:39], a[92:95], a[44:47]
    ds_read_b64_tr_b16 a[142:143], v8 offset:11776
    v_mfma_f32_16x16x32_bf16 a[48:51], v[32:35], a[96:99], a[48:51]
    ds_read_b64_tr_b16 a[144:145], v12 offset:9216
    v_mfma_f32_16x16x32_bf16 a[52:55], v[36:39], a[96:99], a[52:55]
    ds_read_b64_tr_b16 a[146:147], v12 offset:11520
    v_mfma_f32_16x16x32_bf16 a[56:59], v[32:35], a[100:103], a[56:59]
    ds_read_b64_tr_b16 a[148:149], v12 offset:9344
    v_mfma_f32_16x16x32_bf16 a[60:63], v[36:39], a[100:103], a[60:63]
    ds_read_b64_tr_b16 a[150:151], v12 offset:11648
    v_mfma_f32_16x16x32_bf16 a[64:67], v[32:35], a[104:107], a[64:67]
    ds_read_b64_tr_b16 a[152:153], v8 offset:9472
    v_mfma_f32_16x16x32_bf16 a[68:71], v[36:39], a[104:107], a[68:71]
    ds_read_b64_tr_b16 a[154:155], v8 offset:11776
    s_waitcnt lgkmcnt(4)
    v_mfma_f32_16x16x32_bf16 a[156:159], a[144:147], a[168:171], a[156:159]
    s_waitcnt lgkmcnt(2)
    v_mfma_f32_16x16x32_bf16 a[160:163], a[148:151], a[168:171], a[160:163]
    s_waitcnt lgkmcnt(0)
    v_mfma_f32_16x16x32_bf16 a[164:167], a[152:155], a[168:171], a[164:167]
    v_mfma_f32_16x16x32_bf16 v[48:51], a[168:171], v[40:43], v[48:51]
    v_mfma_f32_16x16x32_bf16 v[56:59], v[40:43], v[40:43], v[56:59]
    v_mfma_f32_16x16x32_bf16 v[52:55], a[168:171], v[44:47], v[52:55]
    v_mfma_f32_16x16x32_bf16 v[60:63], v[44:47], v[44:47], v[60:63]
    v_mfma_f32_16x16x32_bf16 a[0:3], v[40:43], a[108:111], a[0:3]
    v_mfma_f32_16x16x32_bf16 a[4:7], v[44:47], a[108:111], a[4:7]
    v_mfma_f32_16x16x32_bf16 a[8:11], v[40:43], a[112:115], a[8:11]
    v_mfma_f32_16x16x32_bf16 a[12:15], v[44:47], a[112:115], a[12:15]
    v_mfma_f32_16x16x32_bf16 a[16:19], v[40:43], a[116:119], a[16:19]
    v_mfma_f32_16x16x32_bf16 a[20:23], v[44:47], a[116:119], a[20:23]
    v_mfma_f32_16x16x32_bf16 a[24:27], v[40:43], a[120:123], a[24:27]
    v_mfma_f32_16x16x32_bf16 a[28:31], v[44:47], a[120:123], a[28:31]
    v_mfma_f32_16x16x32_bf16 a[32:35], v[40:43], a[124:127], a[32:35]
    v_mfma_f32_16x16x32_bf16 a[36:39], v[44:47], a[124:127], a[36:39]
    v_mfma_f32_16x16x32_bf16 a[40:43], v[40:43], a[128:131], a[40:43]
    v_mfma_f32_16x16x32_bf16 a[44:47], v[44:47], a[128:131], a[44:47]
    v_mfma_f32_16x16x32_bf16 a[48:51], v[40:43], a[132:135], a[48:51]
    v_mfma_f32_16x16x32_bf16 a[52:55], v[44:47], a[132:135], a[52:55]
    v_mfma_f32_16x16x32_bf16 a[56:59], v[40:43], a[136:139], a[56:59]
    v_mfma_f32_16x16x32_bf16 a[60:63], v[44:47], a[136:139], a[60:63]
    v_mfma_f32_16x16x32_bf16 a[64:67], v[40:43], a[140:143], a[64:67]
    v_mfma_f32_16x16x32_bf16 a[68:71], v[44:47], a[140:143], a[68:71]
    v_mov_b32 v24, v48
    v_and_b32 v5, 3, v3
    v_mov_b32 v26, v56
    v_cmp_eq_u32 vcc, 1, v5
    s_nop 1
    v_cndmask_b32 v26, v26, v57, vcc
    v_cmp_eq_u32 vcc, 2, v5
    s_nop 1
    v_cndmask_b32 v26, v26, v58, vcc
    v_cmp_eq_u32 vcc, 3, v5
    s_nop 1
    v_cndmask_b32 v26, v26, v59, vcc
    v_lshrrev_b32 v5, 2, v3
    v_cmp_eq_u32 vcc, v5, v4
    s_nop 1
    v_cndmask_b32 v26, 0, v26, vcc
    v_mov_b32 v27, v26
    s_nop 1
    v_permlane16_swap_b32 v26, v27
    v_add_f32 v26, v26, v27
    v_mov_b32 v27, v26
    s_nop 1
    v_permlane32_swap_b32 v26, v27
    v_add_f32 v26, v26, v27
    v_mul_f32 v25, 0x3ae38e39, v24
    v_mul_f32 v26, 0x3ae38e39, v26
    v_fma_f32 v26, -v25, v25, v26
    v_max_f32 v26, 0, v26
    v_add_f32 v26, 0x3727c5ac, v26
    v_rsq_f32 v24, v26
    s_nop 0
    v_mul_f32 v24, s50, v24
    v_mul_f32 v25, v25, v24
    v_sub_f32 v25, 0, v25
    v_mov_b32 v28, v52
    v_and_b32 v5, 3, v3
    v_mov_b32 v30, v60
    v_cmp_eq_u32 vcc, 1, v5
    s_nop 1
    v_cndmask_b32 v30, v30, v61, vcc
    v_cmp_eq_u32 vcc, 2, v5
    s_nop 1
    v_cndmask_b32 v30, v30, v62, vcc
    v_cmp_eq_u32 vcc, 3, v5
    s_nop 1
    v_cndmask_b32 v30, v30, v63, vcc
    v_lshrrev_b32 v5, 2, v3
    v_cmp_eq_u32 vcc, v5, v4
    s_nop 1
    v_cndmask_b32 v30, 0, v30, vcc
    v_mov_b32 v31, v30
    s_nop 1
    v_permlane16_swap_b32 v30, v31
    v_add_f32 v30, v30, v31
    v_mov_b32 v31, v30
    s_nop 1
    v_permlane32_swap_b32 v30, v31
    v_add_f32 v30, v30, v31
    v_mul_f32 v29, 0x3ae38e39, v28
    v_mul_f32 v30, 0x3ae38e39, v30
    v_fma_f32 v30, -v29, v29, v30
    v_max_f32 v30, 0, v30
    v_add_f32 v30, 0x3727c5ac, v30
    v_rsq_f32 v28, v30
    s_nop 0
    v_mul_f32 v28, s50, v28
    v_mul_f32 v29, v29, v28
    v_sub_f32 v29, 0, v29
    v_lshlrev_b32 v5, 4, v4
    s_lshl_b32 s53, s38, 6
    s_add_u32 s53, s53, 139264
    v_add_u32 v6, s53, v5
    v_add_u32 v7, 139776, v5
    ds_write_b128 v6, a[156:159]
    ds_write_b128 v6, a[160:163] offset:256
    ds_write_b128 v7, a[164:167]
    s_lshl_b32 s53, s38, 8
    s_add_u32 s53, s53, 139904
    v_lshl_add_u32 v6, v3, 3, s53
    ds_write_b64 v6, v[24:25]
    ds_write_b64 v6, v[28:29] offset:128
    s_waitcnt lgkmcnt(0)
    s_barrier
    v_lshlrev_b32 v5, 2, v3
    v_add_u32 v5, 139264, v5
    ds_read_b32 v32, v5 offset:0
    ds_read_b32 v33, v5 offset:64
    ds_read_b32 v34, v5 offset:128
    ds_read_b32 v35, v5 offset:192
    ds_read_b32 v36, v5 offset:256
    ds_read_b32 v37, v5 offset:320
    ds_read_b32 v38, v5 offset:384
    ds_read_b32 v39, v5 offset:448
    ds_read_b32 v40, v5 offset:512
    s_lshl_b32 s53, s38, 8
    s_add_u32 s53, s53, 139904
    v_lshl_add_u32 v6, v4, 5, s53
    ds_read_b128 v[48:51], v6 offset:0
    ds_read_b128 v[52:55], v6 offset:16
    ds_read_b128 v[56:59], v6 offset:128
    ds_read_b128 v[60:63], v6 offset:144
    v_and_b32 v5, 1, v4
    v_mul_u32_u24 v5, 304, v5
    v_lshrrev_b32 v6, 1, v4
    v_lshl_add_u32 v5, v6, 3, v5
    v_add_u32 v5, s52, v5
    v_add_u32 v12, 0, v3
    v_mul_u32_u24 v13, 3641, v12
    v_lshrrev_b32 v13, 16, v13
    v_mul_u32_u24 v14, 18, v13
    v_sub_u32 v12, v12, v14
    v_mul_u32_u24 v13, 1216, v13
    v_lshl_add_u32 v13, v12, 4, v13
    v_add_u32 v8, v13, v5
    v_accvgpr_read_b32 v68, a0
    v_accvgpr_read_b32 v69, a1
    v_accvgpr_read_b32 v70, a2
    v_accvgpr_read_b32 v71, a3
    s_waitcnt lgkmcnt(3)
    v_mul_f32 v72, v49, v32
    v_mul_f32 v73, v51, v32
    s_waitcnt lgkmcnt(2)
    v_mul_f32 v74, v53, v32
    v_mul_f32 v75, v55, v32
    v_fma_f32 v68, v68, v48, v72
    v_fma_f32 v69, v69, v50, v73
    v_fma_f32 v70, v70, v52, v74
    v_fma_f32 v71, v71, v54, v75
    v_cvt_pk_bf16_f32 v72, v68, v69
    v_cvt_pk_bf16_f32 v73, v70, v71
    ds_write_b64 v8, v[72:73] offset:0
    v_accvgpr_read_b32 v76, a4
    v_accvgpr_read_b32 v77, a5
    v_accvgpr_read_b32 v78, a6
    v_accvgpr_read_b32 v79, a7
    s_waitcnt lgkmcnt(2)
    v_mul_f32 v80, v57, v32
    v_mul_f32 v81, v59, v32
    s_waitcnt lgkmcnt(1)
    v_mul_f32 v82, v61, v32
    v_mul_f32 v83, v63, v32
    v_fma_f32 v76, v76, v56, v80
    v_fma_f32 v77, v77, v58, v81
    v_fma_f32 v78, v78, v60, v82
    v_fma_f32 v79, v79, v62, v83
    v_cvt_pk_bf16_f32 v80, v76, v77
    v_cvt_pk_bf16_f32 v81, v78, v79
    ds_write_b64 v8, v[80:81] offset:608
    v_add_u32 v12, 16, v3
    v_mul_u32_u24 v13, 3641, v12
    v_lshrrev_b32 v13, 16, v13
    v_mul_u32_u24 v14, 18, v13
    v_sub_u32 v12, v12, v14
    v_mul_u32_u24 v13, 1216, v13
    v_lshl_add_u32 v13, v12, 4, v13
    v_add_u32 v9, v13, v5
    v_accvgpr_read_b32 v68, a8
    v_accvgpr_read_b32 v69, a9
    v_accvgpr_read_b32 v70, a10
    v_accvgpr_read_b32 v71, a11
    v_mul_f32 v72, v49, v33
    v_mul_f32 v73, v51, v33
    v_mul_f32 v74, v53, v33
    v_mul_f32 v75, v55, v33
    v_fma_f32 v68, v68, v48, v72
    v_fma_f32 v69, v69, v50, v73
    v_fma_f32 v70, v70, v52, v74
    v_fma_f32 v71, v71, v54, v75
    v_cvt_pk_bf16_f32 v72, v68, v69
    v_cvt_pk_bf16_f32 v73, v70, v71
    ds_write_b64 v9, v[72:73] offset:0
    v_accvgpr_read_b32 v76, a12
    v_accvgpr_read_b32 v77, a13
    v_accvgpr_read_b32 v78, a14
    v_accvgpr_read_b32 v79, a15
    v_mul_f32 v80, v57, v33
    v_mul_f32 v81, v59, v33
    v_mul_f32 v82, v61, v33
    v_mul_f32 v83, v63, v33
    v_fma_f32 v76, v76, v56, v80
    v_fma_f32 v77, v77, v58, v81
    v_fma_f32 v78, v78, v60, v82
    v_fma_f32 v79, v79, v62, v83
    v_cvt_pk_bf16_f32 v80, v76, v77
    v_cvt_pk_bf16_f32 v81, v78, v79
    ds_write_b64 v9, v[80:81] offset:608
    v_add_u32 v12, 32, v3
    v_mul_u32_u24 v13, 3641, v12
    v_lshrrev_b32 v13, 16, v13
    v_mul_u32_u24 v14, 18, v13
    v_sub_u32 v12, v12, v14
    v_mul_u32_u24 v13, 1216, v13
    v_lshl_add_u32 v13, v12, 4, v13
    v_add_u32 v8, v13, v5
    v_accvgpr_read_b32 v68, a16
    v_accvgpr_read_b32 v69, a17
    v_accvgpr_read_b32 v70, a18
    v_accvgpr_read_b32 v71, a19
    v_mul_f32 v72, v49, v34
    v_mul_f32 v73, v51, v34
    v_mul_f32 v74, v53, v34
    v_mul_f32 v75, v55, v34
    v_fma_f32 v68, v68, v48, v72
    v_fma_f32 v69, v69, v50, v73
    v_fma_f32 v70, v70, v52, v74
    v_fma_f32 v71, v71, v54, v75
    v_cvt_pk_bf16_f32 v72, v68, v69
    v_cvt_pk_bf16_f32 v73, v70, v71
    ds_write_b64 v8, v[72:73] offset:0
    v_accvgpr_read_b32 v76, a20
    v_accvgpr_read_b32 v77, a21
    v_accvgpr_read_b32 v78, a22
    v_accvgpr_read_b32 v79, a23
    v_mul_f32 v80, v57, v34
    v_mul_f32 v81, v59, v34
    v_mul_f32 v82, v61, v34
    v_mul_f32 v83, v63, v34
    v_fma_f32 v76, v76, v56, v80
    v_fma_f32 v77, v77, v58, v81
    v_fma_f32 v78, v78, v60, v82
    v_fma_f32 v79, v79, v62, v83
    v_cvt_pk_bf16_f32 v80, v76, v77
    v_cvt_pk_bf16_f32 v81, v78, v79
    ds_write_b64 v8, v[80:81] offset:608
    v_add_u32 v12, 48, v3
    v_mul_u32_u24 v13, 3641, v12
    v_lshrrev_b32 v13, 16, v13
    v_mul_u32_u24 v14, 18, v13
    v_sub_u32 v12, v12, v14
    v_mul_u32_u24 v13, 1216, v13
    v_lshl_add_u32 v13, v12, 4, v13
    v_add_u32 v9, v13, v5
    v_accvgpr_read_b32 v68, a24
    v_accvgpr_read_b32 v69, a25
    v_accvgpr_read_b32 v70, a26
    v_accvgpr_read_b32 v71, a27
    v_mul_f32 v72, v49, v35
    v_mul_f32 v73, v51, v35
    v_mul_f32 v74, v53, v35
    v_mul_f32 v75, v55, v35
    v_fma_f32 v68, v68, v48, v72
    v_fma_f32 v69, v69, v50, v73
    v_fma_f32 v70, v70, v52, v74
    v_fma_f32 v71, v71, v54, v75
    v_cvt_pk_bf16_f32 v72, v68, v69
    v_cvt_pk_bf16_f32 v73, v70, v71
    ds_write_b64 v9, v[72:73] offset:0
    v_accvgpr_read_b32 v76, a28
    v_accvgpr_read_b32 v77, a29
    v_accvgpr_read_b32 v78, a30
    v_accvgpr_read_b32 v79, a31
    v_mul_f32 v80, v57, v35
    v_mul_f32 v81, v59, v35
    v_mul_f32 v82, v61, v35
    v_mul_f32 v83, v63, v35
    v_fma_f32 v76, v76, v56, v80
    v_fma_f32 v77, v77, v58, v81
    v_fma_f32 v78, v78, v60, v82
    v_fma_f32 v79, v79, v62, v83
    v_cvt_pk_bf16_f32 v80, v76, v77
    v_cvt_pk_bf16_f32 v81, v78, v79
    ds_write_b64 v9, v[80:81] offset:608
    v_add_u32 v12, 64, v3
    v_mul_u32_u24 v13, 3641, v12
    v_lshrrev_b32 v13, 16, v13
    v_mul_u32_u24 v14, 18, v13
    v_sub_u32 v12, v12, v14
    v_mul_u32_u24 v13, 1216, v13
    v_lshl_add_u32 v13, v12, 4, v13
    v_add_u32 v8, v13, v5
    v_accvgpr_read_b32 v68, a32
    v_accvgpr_read_b32 v69, a33
    v_accvgpr_read_b32 v70, a34
    v_accvgpr_read_b32 v71, a35
    v_mul_f32 v72, v49, v36
    v_mul_f32 v73, v51, v36
    v_mul_f32 v74, v53, v36
    v_mul_f32 v75, v55, v36
    v_fma_f32 v68, v68, v48, v72
    v_fma_f32 v69, v69, v50, v73
    v_fma_f32 v70, v70, v52, v74
    v_fma_f32 v71, v71, v54, v75
    v_cvt_pk_bf16_f32 v72, v68, v69
    v_cvt_pk_bf16_f32 v73, v70, v71
    ds_write_b64 v8, v[72:73] offset:0
    v_accvgpr_read_b32 v76, a36
    v_accvgpr_read_b32 v77, a37
    v_accvgpr_read_b32 v78, a38
    v_accvgpr_read_b32 v79, a39
    v_mul_f32 v80, v57, v36
    v_mul_f32 v81, v59, v36
    v_mul_f32 v82, v61, v36
    v_mul_f32 v83, v63, v36
    v_fma_f32 v76, v76, v56, v80
    v_fma_f32 v77, v77, v58, v81
    v_fma_f32 v78, v78, v60, v82
    v_fma_f32 v79, v79, v62, v83
    v_cvt_pk_bf16_f32 v80, v76, v77
    v_cvt_pk_bf16_f32 v81, v78, v79
    ds_write_b64 v8, v[80:81] offset:608
    v_add_u32 v12, 80, v3
    v_mul_u32_u24 v13, 3641, v12
    v_lshrrev_b32 v13, 16, v13
    v_mul_u32_u24 v14, 18, v13
    v_sub_u32 v12, v12, v14
    v_mul_u32_u24 v13, 1216, v13
    v_lshl_add_u32 v13, v12, 4, v13
    v_add_u32 v9, v13, v5
    v_accvgpr_read_b32 v68, a40
    v_accvgpr_read_b32 v69, a41
    v_accvgpr_read_b32 v70, a42
    v_accvgpr_read_b32 v71, a43
    v_mul_f32 v72, v49, v37
    v_mul_f32 v73, v51, v37
    v_mul_f32 v74, v53, v37
    v_mul_f32 v75, v55, v37
    v_fma_f32 v68, v68, v48, v72
    v_fma_f32 v69, v69, v50, v73
    v_fma_f32 v70, v70, v52, v74
    v_fma_f32 v71, v71, v54, v75
    v_cvt_pk_bf16_f32 v72, v68, v69
    v_cvt_pk_bf16_f32 v73, v70, v71
    ds_write_b64 v9, v[72:73] offset:0
    v_accvgpr_read_b32 v76, a44
    v_accvgpr_read_b32 v77, a45
    v_accvgpr_read_b32 v78, a46
    v_accvgpr_read_b32 v79, a47
    v_mul_f32 v80, v57, v37
    v_mul_f32 v81, v59, v37
    v_mul_f32 v82, v61, v37
    v_mul_f32 v83, v63, v37
    v_fma_f32 v76, v76, v56, v80
    v_fma_f32 v77, v77, v58, v81
    v_fma_f32 v78, v78, v60, v82
    v_fma_f32 v79, v79, v62, v83
    v_cvt_pk_bf16_f32 v80, v76, v77
    v_cvt_pk_bf16_f32 v81, v78, v79
    ds_write_b64 v9, v[80:81] offset:608
    v_add_u32 v12, 96, v3
    v_mul_u32_u24 v13, 3641, v12
    v_lshrrev_b32 v13, 16, v13
    v_mul_u32_u24 v14, 18, v13
    v_sub_u32 v12, v12, v14
    v_mul_u32_u24 v13, 1216, v13
    v_lshl_add_u32 v13, v12, 4, v13
    v_add_u32 v8, v13, v5
    v_accvgpr_read_b32 v68, a48
    v_accvgpr_read_b32 v69, a49
    v_accvgpr_read_b32 v70, a50
    v_accvgpr_read_b32 v71, a51
    v_mul_f32 v72, v49, v38
    v_mul_f32 v73, v51, v38
    v_mul_f32 v74, v53, v38
    v_mul_f32 v75, v55, v38
    v_fma_f32 v68, v68, v48, v72
    v_fma_f32 v69, v69, v50, v73
    v_fma_f32 v70, v70, v52, v74
    v_fma_f32 v71, v71, v54, v75
    v_cvt_pk_bf16_f32 v72, v68, v69
    v_cvt_pk_bf16_f32 v73, v70, v71
    ds_write_b64 v8, v[72:73] offset:0
    v_accvgpr_read_b32 v76, a52
    v_accvgpr_read_b32 v77, a53
    v_accvgpr_read_b32 v78, a54
    v_accvgpr_read_b32 v79, a55
    v_mul_f32 v80, v57, v38
    v_mul_f32 v81, v59, v38
    v_mul_f32 v82, v61, v38
    v_mul_f32 v83, v63, v38
    v_fma_f32 v76, v76, v56, v80
    v_fma_f32 v77, v77, v58, v81
    v_fma_f32 v78, v78, v60, v82
    v_fma_f32 v79, v79, v62, v83
    v_cvt_pk_bf16_f32 v80, v76, v77
    v_cvt_pk_bf16_f32 v81, v78, v79
    ds_write_b64 v8, v[80:81] offset:608
    v_add_u32 v12, 112, v3
    v_mul_u32_u24 v13, 3641, v12
    v_lshrrev_b32 v13, 16, v13
    v_mul_u32_u24 v14, 18, v13
    v_sub_u32 v12, v12, v14
    v_mul_u32_u24 v13, 1216, v13
    v_lshl_add_u32 v13, v12, 4, v13
    v_add_u32 v9, v13, v5
    v_accvgpr_read_b32 v68, a56
    v_accvgpr_read_b32 v69, a57
    v_accvgpr_read_b32 v70, a58
    v_accvgpr_read_b32 v71, a59
    v_mul_f32 v72, v49, v39
    v_mul_f32 v73, v51, v39
    v_mul_f32 v74, v53, v39
    v_mul_f32 v75, v55, v39
    v_fma_f32 v68, v68, v48, v72
    v_fma_f32 v69, v69, v50, v73
    v_fma_f32 v70, v70, v52, v74
    v_fma_f32 v71, v71, v54, v75
    v_cvt_pk_bf16_f32 v72, v68, v69
    v_cvt_pk_bf16_f32 v73, v70, v71
    ds_write_b64 v9, v[72:73] offset:0
    v_accvgpr_read_b32 v76, a60
    v_accvgpr_read_b32 v77, a61
    v_accvgpr_read_b32 v78, a62
    v_accvgpr_read_b32 v79, a63
    v_mul_f32 v80, v57, v39
    v_mul_f32 v81, v59, v39
    v_mul_f32 v82, v61, v39
    v_mul_f32 v83, v63, v39
    v_fma_f32 v76, v76, v56, v80
    v_fma_f32 v77, v77, v58, v81
    v_fma_f32 v78, v78, v60, v82
    v_fma_f32 v79, v79, v62, v83
    v_cvt_pk_bf16_f32 v80, v76, v77
    v_cvt_pk_bf16_f32 v81, v78, v79
    ds_write_b64 v9, v[80:81] offset:608
    v_add_u32 v12, 128, v3
    v_mul_u32_u24 v13, 3641, v12
    v_lshrrev_b32 v13, 16, v13
    v_mul_u32_u24 v14, 18, v13
    v_sub_u32 v12, v12, v14
    v_mul_u32_u24 v13, 1216, v13
    v_lshl_add_u32 v13, v12, 4, v13
    v_add_u32 v8, v13, v5
    v_accvgpr_read_b32 v68, a64
    v_accvgpr_read_b32 v69, a65
    v_accvgpr_read_b32 v70, a66
    v_accvgpr_read_b32 v71, a67
    v_mul_f32 v72, v49, v40
    v_mul_f32 v73, v51, v40
    v_mul_f32 v74, v53, v40
    v_mul_f32 v75, v55, v40
    v_fma_f32 v68, v68, v48, v72
    v_fma_f32 v69, v69, v50, v73
    v_fma_f32 v70, v70, v52, v74
    v_fma_f32 v71, v71, v54, v75
    v_cvt_pk_bf16_f32 v72, v68, v69
    v_cvt_pk_bf16_f32 v73, v70, v71
    ds_write_b64 v8, v[72:73] offset:0
    v_accvgpr_read_b32 v76, a68
    v_accvgpr_read_b32 v77, a69
    v_accvgpr_read_b32 v78, a70
    v_accvgpr_read_b32 v79, a71
    v_mul_f32 v80, v57, v40
    v_mul_f32 v81, v59, v40
    v_mul_f32 v82, v61, v40
    v_mul_f32 v83, v63, v40
    v_fma_f32 v76, v76, v56, v80
    v_fma_f32 v77, v77, v58, v81
    v_fma_f32 v78, v78, v60, v82
    v_fma_f32 v79, v79, v62, v83
    v_cvt_pk_bf16_f32 v80, v76, v77
    v_cvt_pk_bf16_f32 v81, v78, v79
    ds_write_b64 v8, v[80:81] offset:608
    v_and_b32 v9, 31, v2
    v_mul_u32_u24 v9, 304, v9
    v_add_u32 v9, s52, v9
    v_mov_b32 v12, s41
    v_mov_b32 v13, s41
    v_mov_b32 v14, s41
    v_mov_b32 v15, s41
    ds_write_b128 v9, v[12:15] offset:288
    v_lshlrev_b32 v8, 4, v2
    v_add_u32 v9, s52, v8
    s_waitcnt lgkmcnt(0)
    ds_read_b128 v[32:35], v9 offset:0
    ds_read_b128 v[36:39], v9 offset:1024
    ds_read_b128 v[40:43], v9 offset:2048
    ds_read_b128 v[44:47], v9 offset:3072
    ds_read_b128 v[48:51], v9 offset:4096
    ds_read_b128 v[52:55], v9 offset:5120
    ds_read_b128 v[56:59], v9 offset:6144
    ds_read_b128 v[60:63], v9 offset:7168
    ds_read_b128 v[64:67], v9 offset:8192
    ds_read_b128 v[68:71], v9 offset:9216
    v_add_u32 v12, 0, v2
    v_mul_u32_u24 v13, 863, v12
    v_lshrrev_b32 v13, 16, v13
    v_mul_u32_u24 v14, 76, v13
    v_sub_u32 v14, v12, v14
    v_mul_lo_u32 v13, v13, s47
    v_lshl_add_u32 v16, v14, 4, v13
    s_waitcnt lgkmcnt(9)
    buffer_store_dwordx4 v[32:35], v16, s[16:19], s46 offen
    v_add_u32 v12, 64, v2
    v_mul_u32_u24 v13, 863, v12
    v_lshrrev_b32 v13, 16, v13
    v_mul_u32_u24 v14, 76, v13
    v_sub_u32 v14, v12, v14
    v_mul_lo_u32 v13, v13, s47
    v_lshl_add_u32 v17, v14, 4, v13
    s_waitcnt lgkmcnt(8)
    buffer_store_dwordx4 v[36:39], v17, s[16:19], s46 offen
    v_add_u32 v12, 128, v2
    v_mul_u32_u24 v13, 863, v12
    v_lshrrev_b32 v13, 16, v13
    v_mul_u32_u24 v14, 76, v13
    v_sub_u32 v14, v12, v14
    v_mul_lo_u32 v13, v13, s47
    v_lshl_add_u32 v16, v14, 4, v13
    s_waitcnt lgkmcnt(7)
    buffer_store_dwordx4 v[40:43], v16, s[16:19], s46 offen
    v_add_u32 v12, 192, v2
    v_mul_u32_u24 v13, 863, v12
    v_lshrrev_b32 v13, 16, v13
    v_mul_u32_u24 v14, 76, v13
    v_sub_u32 v14, v12, v14
    v_mul_lo_u32 v13, v13, s47
    v_lshl_add_u32 v17, v14, 4, v13
    s_waitcnt lgkmcnt(6)
    buffer_store_dwordx4 v[44:47], v17, s[16:19], s46 offen
    v_add_u32 v12, 256, v2
    v_mul_u32_u24 v13, 863, v12
    v_lshrrev_b32 v13, 16, v13
    v_mul_u32_u24 v14, 76, v13
    v_sub_u32 v14, v12, v14
    v_mul_lo_u32 v13, v13, s47
    v_lshl_add_u32 v16, v14, 4, v13
    s_waitcnt lgkmcnt(5)
    buffer_store_dwordx4 v[48:51], v16, s[16:19], s46 offen
    v_add_u32 v12, 320, v2
    v_mul_u32_u24 v13, 863, v12
    v_lshrrev_b32 v13, 16, v13
    v_mul_u32_u24 v14, 76, v13
    v_sub_u32 v14, v12, v14
    v_mul_lo_u32 v13, v13, s47
    v_lshl_add_u32 v17, v14, 4, v13
    s_waitcnt lgkmcnt(4)
    buffer_store_dwordx4 v[52:55], v17, s[16:19], s46 offen
    v_add_u32 v12, 384, v2
    v_mul_u32_u24 v13, 863, v12
    v_lshrrev_b32 v13, 16, v13
    v_mul_u32_u24 v14, 76, v13
    v_sub_u32 v14, v12, v14
    v_mul_lo_u32 v13, v13, s47
    v_lshl_add_u32 v16, v14, 4, v13
    s_waitcnt lgkmcnt(3)
    buffer_store_dwordx4 v[56:59], v16, s[16:19], s46 offen
    v_add_u32 v12, 448, v2
    v_mul_u32_u24 v13, 863, v12
    v_lshrrev_b32 v13, 16, v13
    v_mul_u32_u24 v14, 76, v13
    v_sub_u32 v14, v12, v14
    v_mul_lo_u32 v13, v13, s47
    v_lshl_add_u32 v17, v14, 4, v13
    s_waitcnt lgkmcnt(2)
    buffer_store_dwordx4 v[60:63], v17, s[16:19], s46 offen
    v_add_u32 v12, 512, v2
    v_mul_u32_u24 v13, 863, v12
    v_lshrrev_b32 v13, 16, v13
    v_mul_u32_u24 v14, 76, v13
    v_sub_u32 v14, v12, v14
    v_mul_lo_u32 v13, v13, s47
    v_lshl_add_u32 v16, v14, 4, v13
    s_waitcnt lgkmcnt(1)
    buffer_store_dwordx4 v[64:67], v16, s[16:19], s46 offen
    v_add_u32 v12, 576, v2
    v_mul_u32_u24 v13, 863, v12
    v_lshrrev_b32 v13, 16, v13
    v_mul_u32_u24 v14, 76, v13
    v_sub_u32 v14, v12, v14
    v_mul_lo_u32 v13, v13, s47
    v_lshl_add_u32 v17, v14, 4, v13
    s_mov_b64 exec, 0xffffffff
    s_waitcnt lgkmcnt(0)
    buffer_store_dwordx4 v[68:71], v17, s[16:19], s46 offen
L_qkv_kernel_end:
    s_endpgm
.globl attn_kernel
.p2align 8
.type attn_kernel,@function
attn_kernel:
    s_cmp_ge_u32 s2, 256
    s_cbranch_scc1 L_attn_kernel_end
    s_load_dwordx16 s[64:79], s[0:1], 0
    s_load_dwordx4 s[80:83], s[0:1], 64
    s_load_dwordx2 s[84:85], s[0:1], 80
    s_waitcnt lgkmcnt(0)
    s_add_u32 s8, s84, 0
    s_addc_u32 s9, s85, 0
    s_and_b32 s9, s9, 0xffff
    s_mov_b32 s10, 7208960
    s_mov_b32 s11, 0x20000
    s_add_u32 s12, s84, 7208960
    s_addc_u32 s13, s85, 0
    s_and_b32 s13, s13, 0xffff
    s_mov_b32 s14, 2359296
    s_mov_b32 s15, 0x20000
    s_and_b32 s31, s2, 7
    s_lshr_b32 s32, s2, 3
    s_lshr_b32 s33, s32, 3
    s_lshl_b32 s31, s31, 2
    s_add_u32 s33, s33, s31
    s_and_b32 s34, s32, 7
    v_lshrrev_b32 v1, 6, v0
    v_and_b32 v2, 63, v0
    v_readfirstlane_b32 s38, v1
    s_lshl_b32 s35, s34, 3
    s_add_u32 s35, s35, s38
    v_lshlrev_b32 v3, 4, v2
    v_and_b32 v4, 31, v2
    v_lshrrev_b32 v5, 5, v2
    s_lshl_b32 s36, s33, 16
    s_lshl_b32 s37, s35, 10
    s_add_u32 s36, s36, s37
    buffer_load_dwordx4 v[152:155], v3, s[8:11], s36 offen
    s_lshl_b32 s36, s33, 13
    s_lshl_b32 s37, s35, 7
    s_add_u32 s36, s36, s37
    s_add_u32 s36, s36, 2097152
    v_lshlrev_b32 v6, 2, v4
    buffer_load_dword v156, v6, s[8:11], s36 offen
    s_add_u32 s24, s84, 19595264
    s_addc_u32 s25, s85, 0
    s_and_b32 s25, s25, 0xffff
    s_mov_b32 s26, 8192
    s_mov_b32 s27, 0x20000
    s_lshl_b32 s36, s33, 8
    v_lshlrev_b32 v7, 2, v2
    buffer_load_dword v14, v7, s[24:27], s36 offen
    v_mov_b32 v16, 0x17800000
    s_mul_i32 s36, s33, 151552
    s_add_u32 s36, s36, 2359296
    s_lshl_b32 s44, s38, 10
    s_add_u32 s44, s44, 0
    s_lshl_b32 s45, s38, 10
    s_add_u32 s45, s45, 8192
    s_lshl_b32 s46, s38, 10
    s_add_u32 s46, s46, 16384
    s_lshl_b32 s47, s38, 10
    s_add_u32 s47, s47, 24576
    s_add_u32 s48, s38, 32
    s_min_u32 s48, s48, 36
    s_lshl_b32 s48, s48, 10
    s_mov_b32 m0, s44
    s_add_u32 s39, s36, s44
    buffer_load_dwordx4 v3, s[8:11], s39 offen lds
    s_add_u32 s44, s44, 37888
    s_mov_b32 m0, s45
    s_add_u32 s39, s36, s45
    buffer_load_dwordx4 v3, s[8:11], s39 offen lds
    s_add_u32 s45, s45, 37888
    s_mov_b32 m0, s46
    s_add_u32 s39, s36, s46
    buffer_load_dwordx4 v3, s[8:11], s39 offen lds
    s_add_u32 s46, s46, 37888
    s_mov_b32 m0, s47
    s_add_u32 s39, s36, s47
    buffer_load_dwordx4 v3, s[8:11], s39 offen lds
    s_add_u32 s47, s47, 37888
    s_mov_b32 m0, s48
    s_add_u32 s39, s36, s48
    buffer_load_dwordx4 v3, s[8:11], s39 offen lds
    s_add_u32 s48, s48, 37888
    s_mov_b32 m0, s44
    s_add_u32 s39, s36, s44
    buffer_load_dwordx4 v3, s[8:11], s39 offen lds
    s_add_u32 s44, s44, 37888
    s_mov_b32 m0, s45
    s_add_u32 s39, s36, s45
    buffer_load_dwordx4 v3, s[8:11], s39 offen lds
    s_add_u32 s45, s45, 37888
    s_mov_b32 m0, s46
    s_add_u32 s39, s36, s46
    buffer_load_dwordx4 v3, s[8:11], s39 offen lds
    s_add_u32 s46, s46, 37888
    s_mov_b32 m0, s47
    s_add_u32 s39, s36, s47
    buffer_load_dwordx4 v3, s[8:11], s39 offen lds
    s_add_u32 s47, s47, 37888
    s_mov_b32 m0, s48
    s_add_u32 s39, s36, s48
    buffer_load_dwordx4 v3, s[8:11], s39 offen lds
    s_add_u32 s48, s48, 37888
    v_mov_b32 v8, v3
    v_add_u32 v9, 16384, v6
    v_min_u32 v7, 18, v4
    v_lshlrev_b32 v7, 4, v7
    v_mul_u32_u24 v11, 304, v5
    v_add3_u32 v10, v7, v11, 0
    v_add_u32 v10, 18432, v10
    v_mov_b32 v125, 0
    v_mov_b32 v126, 0
    v_mov_b32 v127, 0
    v_mov_b32 v133, 0
    v_mov_b32 v134, 0
    v_mov_b32 v135, 0
    v_mov_b32 v157, 0
    v_mov_b32 v158, 0
    v_mov_b32 v159, 0
    v_mov_b32 v88, 0
    v_mov_b32 v89, 0
    v_mov_b32 v90, 0
    v_mov_b32 v91, 0
    v_mov_b32 v92, 0
    v_mov_b32 v93, 0
    v_mov_b32 v94, 0
    v_mov_b32 v95, 0
    v_mov_b32 v96, 0
    v_mov_b32 v97, 0
    v_mov_b32 v98, 0
    v_mov_b32 v99, 0
    v_mov_b32 v100, 0
    v_mov_b32 v101, 0
    v_mov_b32 v102, 0
    v_mov_b32 v103, 0
    v_cmp_eq_u32 vcc, 0, v5
    s_waitcnt vmcnt(11)
    s_nop 0
    v_cndmask_b32 v156, 0, v156, vcc
    s_waitcnt vmcnt(5)
    s_barrier
    s_mov_b32 s16, s72
    s_and_b32 s17, s73, 0xffff
    s_mov_b32 s18, 18874368
    s_mov_b32 s19, 0x20000
    s_mov_b32 s20, s76
    s_and_b32 s21, s77, 0xffff
    s_mov_b32 s22, 18874368
    s_mov_b32 s23, 0x20000
    s_lshl_b32 s41, s2, 3
    s_add_u32 s41, s41, s38
    s_mul_i32 s41, s41, 9216
    v_dot2_f32_bf16 v12, v152, v152, 0
    v_dot2_f32_bf16 v12, v153, v153, v12
    v_dot2_f32_bf16 v12, v154, v154, v12
    v_dot2_f32_bf16 v12, v155, v155, v12
    v_dot2_f32_bf16 v12, v156, v156, v12
    s_nop 2
    v_mov_b32 v13, v12
    s_nop 1
    v_permlane32_swap_b32 v12, v13
    v_add_f32 v12, v12, v13
    v_max_f32_dpp v14, v14, v14 quad_perm:[1,0,3,2] row_mask:0xf bank_mask:0xf
    s_nop 1
    v_max_f32_dpp v14, v14, v14 quad_perm:[2,3,0,1] row_mask:0xf bank_mask:0xf
    s_nop 1
    v_max_f32_dpp v14, v14, v14 row_half_mirror row_mask:0xf bank_mask:0xf
    s_nop 1
    v_max_f32_dpp v14, v14, v14 row_mirror row_mask:0xf bank_mask:0xf
    v_mov_b32 v15, v14
    s_nop 1
    v_permlane16_swap_b32 v14, v15
    v_max_f32 v14, v14, v15
    v_mov_b32 v15, v14
    s_nop 1
    v_permlane32_swap_b32 v14, v15
    v_max_f32 v14, v14, v15
    v_mul_f32 v12, v12, v14
    v_sqrt_f32 v12, v12
    s_nop 0
    v_mul_f32 v12, 0xbf8147ae, v12
    v_mov_b32 v104, v12
    v_mov_b32 v105, v12
    v_mov_b32 v106, v12
    v_mov_b32 v107, v12
    v_mov_b32 v108, v12
    v_mov_b32 v109, v12
    v_mov_b32 v110, v12
    v_mov_b32 v111, v12
    v_mov_b32 v112, v12
    v_mov_b32 v113, v12
    v_mov_b32 v114, v12
    v_mov_b32 v115, v12
    v_mov_b32 v116, v12
    v_mov_b32 v117, v12
    v_mov_b32 v118, v12
    v_mov_b32 v119, v12
    ds_read_b128 v[120:123], v8 offset:0
    ds_read_b32 v124, v9 offset:0
    ds_read_b128 v[148:151], v10 offset:608
    ds_read_b128 v[128:131], v8 offset:1024
    ds_read_b32 v132, v9 offset:128
    s_waitcnt lgkmcnt(4)
    v_mfma_f32_32x32x16_bf16 v[32:47], v[120:123], v[152:155], v[104:119]
    s_waitcnt lgkmcnt(3)
    v_mfma_f32_32x32x16_bf16 v[32:47], v[124:127], v[156:159], v[32:47]
    v_mov_b32 v84, 0
    v_mov_b32 v85, 0
    v_mov_b32 v86, 0
    v_mov_b32 v87, 0
    ds_read_b128 v[136:139], v10 offset:0
    ds_read_b128 v[140:143], v10 offset:608
    s_mov_b32 s30, 0
    s_mov_b32 s40, 0x40004000
L_attn_kernel_loopf:
    s_cmp_ge_u32 s30, 2
    s_cbranch_scc1 L_attn_kernel_nodma0
    s_mov_b32 m0, s44
    s_add_u32 s39, s36, s44
    buffer_load_dwordx4 v3, s[8:11], s39 offen lds
    s_add_u32 s44, s44, 37888
L_attn_kernel_nodma0:
    s_nop 1
    v_exp_f32 v64, v32
    v_exp_f32 v65, v33
    v_exp_f32 v66, v34
    v_exp_f32 v67, v35
    s_waitcnt lgkmcnt(4)
    v_mfma_f32_32x32x16_bf16 v[88:103], v[148:151], v[84:87], v[88:103]
    v_exp_f32 v68, v36
    v_exp_f32 v69, v37
    v_exp_f32 v70, v38
    v_exp_f32 v71, v39
    s_waitcnt lgkmcnt(3)
    v_mfma_f32_32x32x16_bf16 v[48:63], v[128:131], v[152:155], v[104:119]
    v_exp_f32 v72, v40
    v_exp_f32 v73, v41
    v_exp_f32 v74, v42
    v_exp_f32 v75, v43
    s_waitcnt lgkmcnt(2)
    v_mfma_f32_32x32x16_bf16 v[48:63], v[132:135], v[156:159], v[48:63]
    ds_read_b128 v[120:123], v8 offset:2048
    ds_read_b32 v124, v9 offset:256
    ds_read_b128 v[144:147], v10 offset:1216
    ds_read_b128 v[148:151], v10 offset:1824
    v_exp_f32 v76, v44
    v_exp_f32 v77, v45
    v_exp_f32 v78, v46
    v_exp_f32 v79, v47
    v_cvt_pk_bf16_f32 v80, v64, v65
    v_cvt_pk_bf16_f32 v81, v66, v67
    v_cvt_pk_bf16_f32 v82, v68, v69
    v_cvt_pk_bf16_f32 v83, v70, v71
    v_cvt_pk_bf16_f32 v84, v72, v73
    v_cvt_pk_bf16_f32 v85, v74, v75
    v_cvt_pk_bf16_f32 v86, v76, v77
    v_cvt_pk_bf16_f32 v87, v78, v79
    s_waitcnt lgkmcnt(5)
    v_mfma_f32_32x32x16_bf16 v[88:103], v[136:139], v[80:83], v[88:103]
    s_cmp_ge_u32 s30, 2
    s_cbranch_scc1 L_attn_kernel_nodma1
    s_mov_b32 m0, s45
    s_add_u32 s39, s36, s45
    buffer_load_dwordx4 v3, s[8:11], s39 offen lds
    s_add_u32 s45, s45, 37888
L_attn_kernel_nodma1:
    v_exp_f32 v64, v48
    v_exp_f32 v65, v49
    v_exp_f32 v66, v50
    v_exp_f32 v67, v51
    s_waitcnt lgkmcnt(4)
    v_mfma_f32_32x32x16_bf16 v[88:103], v[140:143], v[84:87], v[88:103]
    v_exp_f32 v68, v52
    v_exp_f32 v69, v53
    v_exp_f32 v70, v54
    v_exp_f32 v71, v55
    s_waitcnt lgkmcnt(3)
    v_mfma_f32_32x32x16_bf16 v[32:47], v[120:123], v[152:155], v[104:119]
    v_exp_f32 v72, v56
    v_exp_f32 v73, v57
    v_exp_f32 v74, v58
    v_exp_f32 v75, v59
    s_waitcnt lgkmcnt(2)
    v_mfma_f32_32x32x16_bf16 v[32:47], v[124:127], v[156:159], v[32:47]
    ds_read_b128 v[128:131], v8 offset:3072
    ds_read_b32 v132, v9 offset:384
    ds_read_b128 v[136:139], v10 offset:2432
    ds_read_b128 v[140:143], v10 offset:3040
    v_exp_f32 v76, v60
    v_exp_f32 v77, v61
    v_exp_f32 v78, v62
    v_exp_f32 v79, v63
    v_cvt_pk_bf16_f32 v80, v64, v65
    v_cvt_pk_bf16_f32 v81, v66, v67
    v_cvt_pk_bf16_f32 v82, v68, v69
    v_cvt_pk_bf16_f32 v83, v70, v71
    v_cvt_pk_bf16_f32 v84, v72, v73
    v_cvt_pk_bf16_f32 v85, v74, v75
    v_cvt_pk_bf16_f32 v86, v76, v77
    v_cvt_pk_bf16_f32 v87, v78, v79
    s_waitcnt lgkmcnt(5)
    v_mfma_f32_32x32x16_bf16 v[88:103], v[144:147], v[80:83], v[88:103]
    s_cmp_ge_u32 s30, 2
    s_cbranch_scc1 L_attn_kernel_nodma2
    s_mov_b32 m0, s46
    s_add_u32 s39, s36, s46
    buffer_load_dwordx4 v3, s[8:11], s39 offen lds
    s_add_u32 s46, s46, 37888
L_attn_kernel_nodma2:
    v_exp_f32 v64, v32
    v_exp_f32 v65, v33
    v_exp_f32 v66, v34
    v_exp_f32 v67, v35
    s_waitcnt lgkmcnt(4)
    v_mfma_f32_32x32x16_bf16 v[88:103], v[148:151], v[84:87], v[88:103]
    v_exp_f32 v68, v36
    v_exp_f32 v69, v37
    v_exp_f32 v70, v38
    v_exp_f32 v71, v39
    s_waitcnt lgkmcnt(3)
    v_mfma_f32_32x32x16_bf16 v[48:63], v[128:131], v[152:155], v[104:119]
    v_exp_f32 v72, v40
    v_exp_f32 v73, v41
    v_exp_f32 v74, v42
    v_exp_f32 v75, v43
    s_waitcnt lgkmcnt(2)
    v_mfma_f32_32x32x16_bf16 v[48:63], v[132:135], v[156:159], v[48:63]
    ds_read_b128 v[120:123], v8 offset:4096
    ds_read_b32 v124, v9 offset:512
    ds_read_b128 v[144:147], v10 offset:3648
    ds_read_b128 v[148:151], v10 offset:4256
    v_exp_f32 v76, v44
    v_exp_f32 v77, v45
    v_exp_f32 v78, v46
    v_exp_f32 v79, v47
    v_cvt_pk_bf16_f32 v80, v64, v65
    v_cvt_pk_bf16_f32 v81, v66, v67
    v_cvt_pk_bf16_f32 v82, v68, v69
    v_cvt_pk_bf16_f32 v83, v70, v71
    v_cvt_pk_bf16_f32 v84, v72, v73
    v_cvt_pk_bf16_f32 v85, v74, v75
    v_cvt_pk_bf16_f32 v86, v76, v77
    v_cvt_pk_bf16_f32 v87, v78, v79
    s_waitcnt lgkmcnt(5)
    v_mfma_f32_32x32x16_bf16 v[88:103], v[136:139], v[80:83], v[88:103]
    s_cmp_ge_u32 s30, 2
    s_cbranch_scc1 L_attn_kernel_nodma3
    s_mov_b32 m0, s47
    s_add_u32 s39, s36, s47
    buffer_load_dwordx4 v3, s[8:11], s39 offen lds
    s_add_u32 s47, s47, 37888
L_attn_kernel_nodma3:
    v_exp_f32 v64, v48
    v_exp_f32 v65, v49
    v_exp_f32 v66, v50
    v_exp_f32 v67, v51
    s_waitcnt lgkmcnt(4)
    v_mfma_f32_32x32x16_bf16 v[88:103], v[140:143], v[84:87], v[88:103]
    v_exp_f32 v68, v52
    v_exp_f32 v69, v53
    v_exp_f32 v70, v54
    v_exp_f32 v71, v55
    s_waitcnt lgkmcnt(3)
    v_mfma_f32_32x32x16_bf16 v[32:47], v[120:123], v[152:155], v[104:119]
    v_exp_f32 v72, v56
    v_exp_f32 v73, v57
    v_exp_f32 v74, v58
    v_exp_f32 v75, v59
    s_waitcnt lgkmcnt(2)
    v_mfma_f32_32x32x16_bf16 v[32:47], v[124:127], v[156:159], v[32:47]
    ds_read_b128 v[128:131], v8 offset:5120
    ds_read_b32 v132, v9 offset:640
    ds_read_b128 v[136:139], v10 offset:4864
    ds_read_b128 v[140:143], v10 offset:5472
    v_exp_f32 v76, v60
    v_exp_f32 v77, v61
    v_exp_f32 v78, v62
    v_exp_f32 v79, v63
    v_cvt_pk_bf16_f32 v80, v64, v65
    v_cvt_pk_bf16_f32 v81, v66, v67
    v_cvt_pk_bf16_f32 v82, v68, v69
    v_cvt_pk_bf16_f32 v83, v70, v71
    v_cvt_pk_bf16_f32 v84, v72, v73
    v_cvt_pk_bf16_f32 v85, v74, v75
    v_cvt_pk_bf16_f32 v86, v76, v77
    v_cvt_pk_bf16_f32 v87, v78, v79
    s_waitcnt lgkmcnt(5)
    v_mfma_f32_32x32x16_bf16 v[88:103], v[144:147], v[80:83], v[88:103]
    s_cmp_ge_u32 s30, 2
    s_cbranch_scc1 L_attn_kernel_nodma4
    s_mov_b32 m0, s48
    s_add_u32 s39, s36, s48
    buffer_load_dwordx4 v3, s[8:11], s39 offen lds
    s_add_u32 s48, s48, 37888
L_attn_kernel_nodma4:
    v_exp_f32 v64, v32
    v_exp_f32 v65, v33
    v_exp_f32 v66, v34
    v_exp_f32 v67, v35
    s_waitcnt lgkmcnt(4)
    v_mfma_f32_32x32x16_bf16 v[88:103], v[148:151], v[84:87], v[88:103]
    v_exp_f32 v68, v36
    v_exp_f32 v69, v37
    v_exp_f32 v70, v38
    v_exp_f32 v71, v39
    s_waitcnt lgkmcnt(3)
    v_mfma_f32_32x32x16_bf16 v[48:63], v[128:131], v[152:155], v[104:119]
    v_exp_f32 v72, v40
    v_exp_f32 v73, v41
    v_exp_f32 v74, v42
    v_exp_f32 v75, v43
    s_waitcnt lgkmcnt(2)
    v_mfma_f32_32x32x16_bf16 v[48:63], v[132:135], v[156:159], v[48:63]
    ds_read_b128 v[120:123], v8 offset:6144
    ds_read_b32 v124, v9 offset:768
    ds_read_b128 v[144:147], v10 offset:6080
    ds_read_b128 v[148:151], v10 offset:6688
    v_exp_f32 v76, v44
    v_exp_f32 v77, v45
    v_exp_f32 v78, v46
    v_exp_f32 v79, v47
    v_cvt_pk_bf16_f32 v80, v64, v65
    v_cvt_pk_bf16_f32 v81, v66, v67
    v_cvt_pk_bf16_f32 v82, v68, v69
    v_cvt_pk_bf16_f32 v83, v70, v71
    v_cvt_pk_bf16_f32 v84, v72, v73
    v_cvt_pk_bf16_f32 v85, v74, v75
    v_cvt_pk_bf16_f32 v86, v76, v77
    v_cvt_pk_bf16_f32 v87, v78, v79
    s_waitcnt lgkmcnt(5)
    v_mfma_f32_32x32x16_bf16 v[88:103], v[136:139], v[80:83], v[88:103]
    buffer_load_dwordx4 v[160:163], v3, s[16:19], s41 offen offset:0
    v_exp_f32 v64, v48
    v_exp_f32 v65, v49
    v_exp_f32 v66, v50
    v_exp_f32 v67, v51
    s_waitcnt lgkmcnt(4)
    v_mfma_f32_32x32x16_bf16 v[88:103], v[140:143], v[84:87], v[88:103]
    v_exp_f32 v68, v52
    v_exp_f32 v69, v53
    v_exp_f32 v70, v54
    v_exp_f32 v71, v55
    s_waitcnt lgkmcnt(3)
    v_mfma_f32_32x32x16_bf16 v[32:47], v[120:123], v[152:155], v[104:119]
    v_exp_f32 v72, v56
    v_exp_f32 v73, v57
    v_exp_f32 v74, v58
    v_exp_f32 v75, v59
    s_waitcnt lgkmcnt(2)
    v_mfma_f32_32x32x16_bf16 v[32:47], v[124:127], v[156:159], v[32:47]
    ds_read_b128 v[128:131], v8 offset:7168
    ds_read_b32 v132, v9 offset:896
    ds_read_b128 v[136:139], v10 offset:7296
    ds_read_b128 v[140:143], v10 offset:7904
    v_exp_f32 v76, v60
    v_exp_f32 v77, v61
    v_exp_f32 v78, v62
    v_exp_f32 v79, v63
    v_cvt_pk_bf16_f32 v80, v64, v65
    v_cvt_pk_bf16_f32 v81, v66, v67
    v_cvt_pk_bf16_f32 v82, v68, v69
    v_cvt_pk_bf16_f32 v83, v70, v71
    v_cvt_pk_bf16_f32 v84, v72, v73
    v_cvt_pk_bf16_f32 v85, v74, v75
    v_cvt_pk_bf16_f32 v86, v76, v77
    v_cvt_pk_bf16_f32 v87, v78, v79
    s_waitcnt lgkmcnt(5)
    v_mfma_f32_32x32x16_bf16 v[88:103], v[144:147], v[80:83], v[88:103]
    buffer_load_dwordx4 v[160:163], v3, s[16:19], s41 offen offset:1024
    v_exp_f32 v64, v32
    v_exp_f32 v65, v33
    v_exp_f32 v66, v34
    v_exp_f32 v67, v35
    s_waitcnt lgkmcnt(4)
    v_mfma_f32_32x32x16_bf16 v[88:103], v[148:151], v[84:87], v[88:103]
    v_exp_f32 v68, v36
    v_exp_f32 v69, v37
    v_exp_f32 v70, v38
    v_exp_f32 v71, v39
    s_waitcnt lgkmcnt(3)
    v_mfma_f32_32x32x16_bf16 v[48:63], v[128:131], v[152:155], v[104:119]
    v_exp_f32 v72, v40
    v_exp_f32 v73, v41
    v_exp_f32 v74, v42
    v_exp_f32 v75, v43
    s_waitcnt lgkmcnt(2)
    v_mfma_f32_32x32x16_bf16 v[48:63], v[132:135], v[156:159], v[48:63]
    ds_read_b128 v[120:123], v8 offset:8192
    ds_read_b32 v124, v9 offset:1024
    ds_read_b128 v[144:147], v10 offset:8512
    ds_read_b128 v[148:151], v10 offset:9120
    v_exp_f32 v76, v44
    v_exp_f32 v77, v45
    v_exp_f32 v78, v46
    v_exp_f32 v79, v47
    v_cvt_pk_bf16_f32 v80, v64, v65
    v_cvt_pk_bf16_f32 v81, v66, v67
    v_cvt_pk_bf16_f32 v82, v68, v69
    v_cvt_pk_bf16_f32 v83, v70, v71
    v_cvt_pk_bf16_f32 v84, v72, v73
    v_cvt_pk_bf16_f32 v85, v74, v75
    v_cvt_pk_bf16_f32 v86, v76, v77
    v_cvt_pk_bf16_f32 v87, v78, v79
    s_waitcnt lgkmcnt(5)
    v_mfma_f32_32x32x16_bf16 v[88:103], v[136:139], v[80:83], v[88:103]
    buffer_load_dwordx4 v[160:163], v3, s[16:19], s41 offen offset:2048
    v_exp_f32 v64, v48
    v_exp_f32 v65, v49
    v_exp_f32 v66, v50
    v_exp_f32 v67, v51
    s_waitcnt lgkmcnt(4)
    v_mfma_f32_32x32x16_bf16 v[88:103], v[140:143], v[84:87], v[88:103]
    v_exp_f32 v68, v52
    v_exp_f32 v69, v53
    v_exp_f32 v70, v54
    v_exp_f32 v71, v55
    s_waitcnt lgkmcnt(3)
    v_mfma_f32_32x32x16_bf16 v[32:47], v[120:123], v[152:155], v[104:119]
    v_exp_f32 v72, v56
    v_exp_f32 v73, v57
    v_exp_f32 v74, v58
    v_exp_f32 v75, v59
    s_waitcnt lgkmcnt(2)
    v_mfma_f32_32x32x16_bf16 v[32:47], v[124:127], v[156:159], v[32:47]
    ds_read_b128 v[128:131], v8 offset:9216
    ds_read_b32 v132, v9 offset:1152
    ds_read_b128 v[136:139], v10 offset:9728
    ds_read_b128 v[140:143], v10 offset:10336
    v_exp_f32 v76, v60
    v_exp_f32 v77, v61
    v_exp_f32 v78, v62
    v_exp_f32 v79, v63
    v_cvt_pk_bf16_f32 v80, v64, v65
    v_cvt_pk_bf16_f32 v81, v66, v67
    v_cvt_pk_bf16_f32 v82, v68, v69
    v_cvt_pk_bf16_f32 v83, v70, v71
    v_cvt_pk_bf16_f32 v84, v72, v73
    v_cvt_pk_bf16_f32 v85, v74, v75
    v_cvt_pk_bf16_f32 v86, v76, v77
    v_cvt_pk_bf16_f32 v87, v78, v79
    s_waitcnt lgkmcnt(5)
    v_mfma_f32_32x32x16_bf16 v[88:103], v[144:147], v[80:83], v[88:103]
    v_exp_f32 v64, v32
    v_exp_f32 v65, v33
    v_exp_f32 v66, v34
    v_exp_f32 v67, v35
    s_waitcnt lgkmcnt(4)
    v_mfma_f32_32x32x16_bf16 v[88:103], v[148:151], v[84:87], v[88:103]
    v_exp_f32 v68, v36
    v_exp_f32 v69, v37
    v_exp_f32 v70, v38
    v_exp_f32 v71, v39
    s_waitcnt lgkmcnt(3)
    v_mfma_f32_32x32x16_bf16 v[48:63], v[128:131], v[152:155], v[104:119]
    v_exp_f32 v72, v40
    v_exp_f32 v73, v41
    v_exp_f32 v74, v42
    v_exp_f32 v75, v43
    s_waitcnt lgkmcnt(2)
    v_mfma_f32_32x32x16_bf16 v[48:63], v[132:135], v[156:159], v[48:63]
    ds_read_b128 v[120:123], v8 offset:10240
    ds_read_b32 v124, v9 offset:1280
    ds_read_b128 v[144:147], v10 offset:10944
    ds_read_b128 v[148:151], v10 offset:11552
    v_exp_f32 v76, v44
    v_exp_f32 v77, v45
    v_exp_f32 v78, v46
    v_exp_f32 v79, v47
    v_cvt_pk_bf16_f32 v80, v64, v65
    v_cvt_pk_bf16_f32 v81, v66, v67
    v_cvt_pk_bf16_f32 v82, v68, v69
    v_cvt_pk_bf16_f32 v83, v70, v71
    v_cvt_pk_bf16_f32 v84, v72, v73
    v_cvt_pk_bf16_f32 v85, v74, v75
    v_cvt_pk_bf16_f32 v86, v76, v77
    v_cvt_pk_bf16_f32 v87, v78, v79
    s_waitcnt lgkmcnt(5)
    v_mfma_f32_32x32x16_bf16 v[88:103], v[136:139], v[80:83], v[88:103]
    buffer_load_dwordx4 v[160:163], v3, s[20:23], s41 offen offset:0
    v_exp_f32 v64, v48
    v_exp_f32 v65, v49
    v_exp_f32 v66, v50
    v_exp_f32 v67, v51
    s_waitcnt lgkmcnt(4)
    v_mfma_f32_32x32x16_bf16 v[88:103], v[140:143], v[84:87], v[88:103]
    v_exp_f32 v68, v52
    v_exp_f32 v69, v53
    v_exp_f32 v70, v54
    v_exp_f32 v71, v55
    s_waitcnt lgkmcnt(3)
    v_mfma_f32_32x32x16_bf16 v[32:47], v[120:123], v[152:155], v[104:119]
    v_exp_f32 v72, v56
    v_exp_f32 v73, v57
    v_exp_f32 v74, v58
    v_exp_f32 v75, v59
    s_waitcnt lgkmcnt(2)
    v_mfma_f32_32x32x16_bf16 v[32:47], v[124:127], v[156:159], v[32:47]
    ds_read_b128 v[128:131], v8 offset:11264
    ds_read_b32 v132, v9 offset:1408
    ds_read_b128 v[136:139], v10 offset:12160
    ds_read_b128 v[140:143], v10 offset:12768
    v_exp_f32 v76, v60
    v_exp_f32 v77, v61
    v_exp_f32 v78, v62
    v_exp_f32 v79, v63
    v_cvt_pk_bf16_f32 v80, v64, v65
    v_cvt_pk_bf16_f32 v81, v66, v67
    v_cvt_pk_bf16_f32 v82, v68, v69
    v_cvt_pk_bf16_f32 v83, v70, v71
    v_cvt_pk_bf16_f32 v84, v72, v73
    v_cvt_pk_bf16_f32 v85, v74, v75
    v_cvt_pk_bf16_f32 v86, v76, v77
    v_cvt_pk_bf16_f32 v87, v78, v79
    s_waitcnt lgkmcnt(5)
    v_mfma_f32_32x32x16_bf16 v[88:103], v[144:147], v[80:83], v[88:103]
    v_exp_f32 v64, v32
    v_exp_f32 v65, v33
    v_exp_f32 v66, v34
    v_exp_f32 v67, v35
    s_waitcnt lgkmcnt(4)
    v_mfma_f32_32x32x16_bf16 v[88:103], v[148:151], v[84:87], v[88:103]
    v_exp_f32 v68, v36
    v_exp_f32 v69, v37
    v_exp_f32 v70, v38
    v_exp_f32 v71, v39
    s_waitcnt lgkmcnt(3)
    v_mfma_f32_32x32x16_bf16 v[48:63], v[128:131], v[152:155], v[104:119]
    v_exp_f32 v72, v40
    v_exp_f32 v73, v41
    v_exp_f32 v74, v42
    v_exp_f32 v75, v43
    s_waitcnt lgkmcnt(2)
    v_mfma_f32_32x32x16_bf16 v[48:63], v[132:135], v[156:159], v[48:63]
    ds_read_b128 v[120:123], v8 offset:12288
    ds_read_b32 v124, v9 offset:1536
    ds_read_b128 v[144:147], v10 offset:13376
    ds_read_b128 v[148:151], v10 offset:13984
    v_exp_f32 v76, v44
    v_exp_f32 v77, v45
    v_exp_f32 v78, v46
    v_exp_f32 v79, v47
    v_cvt_pk_bf16_f32 v80, v64, v65
    v_cvt_pk_bf16_f32 v81, v66, v67
    v_cvt_pk_bf16_f32 v82, v68, v69
    v_cvt_pk_bf16_f32 v83, v70, v71
    v_cvt_pk_bf16_f32 v84, v72, v73
    v_cvt_pk_bf16_f32 v85, v74, v75
    v_cvt_pk_bf16_f32 v86, v76, v77
    v_cvt_pk_bf16_f32 v87, v78, v79
    s_waitcnt lgkmcnt(5)
    v_mfma_f32_32x32x16_bf16 v[88:103], v[136:139], v[80:83], v[88:103]
    buffer_load_dwordx4 v[160:163], v3, s[20:23], s41 offen offset:1024
    v_exp_f32 v64, v48
    v_exp_f32 v65, v49
    v_exp_f32 v66, v50
    v_exp_f32 v67, v51
    s_waitcnt lgkmcnt(4)
    v_mfma_f32_32x32x16_bf16 v[88:103], v[140:143], v[84:87], v[88:103]
    v_exp_f32 v68, v52
    v_exp_f32 v69, v53
    v_exp_f32 v70, v54
    v_exp_f32 v71, v55
    s_waitcnt lgkmcnt(3)
    v_mfma_f32_32x32x16_bf16 v[32:47], v[120:123], v[152:155], v[104:119]
    v_exp_f32 v72, v56
    v_exp_f32 v73, v57
    v_exp_f32 v74, v58
    v_exp_f32 v75, v59
    s_waitcnt lgkmcnt(2)
    v_mfma_f32_32x32x16_bf16 v[32:47], v[124:127], v[156:159], v[32:47]
    ds_read_b128 v[128:131], v8 offset:13312
    ds_read_b32 v132, v9 offset:1664
    ds_read_b128 v[136:139], v10 offset:14592
    ds_read_b128 v[140:143], v10 offset:15200
    v_exp_f32 v76, v60
    v_exp_f32 v77, v61
    v_exp_f32 v78, v62
    v_exp_f32 v79, v63
    v_cvt_pk_bf16_f32 v80, v64, v65
    v_cvt_pk_bf16_f32 v81, v66, v67
    v_cvt_pk_bf16_f32 v82, v68, v69
    v_cvt_pk_bf16_f32 v83, v70, v71
    v_cvt_pk_bf16_f32 v84, v72, v73
    v_cvt_pk_bf16_f32 v85, v74, v75
    v_cvt_pk_bf16_f32 v86, v76, v77
    v_cvt_pk_bf16_f32 v87, v78, v79
    s_waitcnt lgkmcnt(5)
    v_mfma_f32_32x32x16_bf16 v[88:103], v[144:147], v[80:83], v[88:103]
    v_exp_f32 v64, v32
    v_exp_f32 v65, v33
    v_exp_f32 v66, v34
    v_exp_f32 v67, v35
    s_waitcnt lgkmcnt(4)
    v_mfma_f32_32x32x16_bf16 v[88:103], v[148:151], v[84:87], v[88:103]
    v_exp_f32 v68, v36
    v_exp_f32 v69, v37
    v_exp_f32 v70, v38
    v_exp_f32 v71, v39
    s_waitcnt lgkmcnt(3)
    v_mfma_f32_32x32x16_bf16 v[48:63], v[128:131], v[152:155], v[104:119]
    v_exp_f32 v72, v40
    v_exp_f32 v73, v41
    v_exp_f32 v74, v42
    v_exp_f32 v75, v43
    s_waitcnt lgkmcnt(2)
    v_mfma_f32_32x32x16_bf16 v[48:63], v[132:135], v[156:159], v[48:63]
    ds_read_b128 v[120:123], v8 offset:14336
    ds_read_b32 v124, v9 offset:1792
    ds_read_b128 v[144:147], v10 offset:15808
    ds_read_b128 v[148:151], v10 offset:16416
    v_exp_f32 v76, v44
    v_exp_f32 v77, v45
    v_exp_f32 v78, v46
    v_exp_f32 v79, v47
    v_cvt_pk_bf16_f32 v80, v64, v65
    v_cvt_pk_bf16_f32 v81, v66, v67
    v_cvt_pk_bf16_f32 v82, v68, v69
    v_cvt_pk_bf16_f32 v83, v70, v71
    v_cvt_pk_bf16_f32 v84, v72, v73
    v_cvt_pk_bf16_f32 v85, v74, v75
    v_cvt_pk_bf16_f32 v86, v76, v77
    v_cvt_pk_bf16_f32 v87, v78, v79
    s_waitcnt lgkmcnt(5)
    v_mfma_f32_32x32x16_bf16 v[88:103], v[136:139], v[80:83], v[88:103]
    buffer_load_dwordx4 v[160:163], v3, s[20:23], s41 offen offset:2048
    v_exp_f32 v64, v48
    v_exp_f32 v65, v49
    v_exp_f32 v66, v50
    v_exp_f32 v67, v51
    s_waitcnt lgkmcnt(4)
    v_mfma_f32_32x32x16_bf16 v[88:103], v[140:143], v[84:87], v[88:103]
    v_exp_f32 v68, v52
    v_exp_f32 v69, v53
    v_exp_f32 v70, v54
    v_exp_f32 v71, v55
    s_waitcnt lgkmcnt(3)
    v_mfma_f32_32x32x16_bf16 v[32:47], v[120:123], v[152:155], v[104:119]
    v_exp_f32 v72, v56
    v_exp_f32 v73, v57
    v_exp_f32 v74, v58
    v_exp_f32 v75, v59
    s_waitcnt lgkmcnt(2)
    v_mfma_f32_32x32x16_bf16 v[32:47], v[124:127], v[156:159], v[32:47]
    ds_read_b128 v[128:131], v8 offset:15360
    ds_read_b32 v132, v9 offset:1920
    ds_read_b128 v[136:139], v10 offset:17024
    ds_read_b128 v[140:143], v10 offset:17632
    v_exp_f32 v76, v60
    v_exp_f32 v77, v61
    v_exp_f32 v78, v62
    v_exp_f32 v79, v63
    v_cvt_pk_bf16_f32 v80, v64, v65
    v_cvt_pk_bf16_f32 v81, v66, v67
    v_cvt_pk_bf16_f32 v82, v68, v69
    v_cvt_pk_bf16_f32 v83, v70, v71
    v_cvt_pk_bf16_f32 v84, v72, v73
    v_cvt_pk_bf16_f32 v85, v74, v75
    v_cvt_pk_bf16_f32 v86, v76, v77
    v_cvt_pk_bf16_f32 v87, v78, v79
    s_waitcnt lgkmcnt(5)
    v_mfma_f32_32x32x16_bf16 v[88:103], v[144:147], v[80:83], v[88:103]
    s_waitcnt vmcnt(11)
    s_barrier
    v_exp_f32 v64, v32
    v_exp_f32 v65, v33
    v_exp_f32 v66, v34
    v_exp_f32 v67, v35
    s_waitcnt lgkmcnt(4)
    v_mfma_f32_32x32x16_bf16 v[88:103], v[148:151], v[84:87], v[88:103]
    v_exp_f32 v68, v36
    v_exp_f32 v69, v37
    v_exp_f32 v70, v38
    v_exp_f32 v71, v39
    s_waitcnt lgkmcnt(3)
    v_mfma_f32_32x32x16_bf16 v[48:63], v[128:131], v[152:155], v[104:119]
    v_exp_f32 v72, v40
    v_exp_f32 v73, v41
    v_exp_f32 v74, v42
    v_exp_f32 v75, v43
    s_waitcnt lgkmcnt(2)
    v_mfma_f32_32x32x16_bf16 v[48:63], v[132:135], v[156:159], v[48:63]
    ds_read_b128 v[120:123], v8 offset:37888
    ds_read_b32 v124, v9 offset:37888
    ds_read_b128 v[144:147], v10 offset:18240
    ds_read_b128 v[148:151], v10 offset:18848
    v_exp_f32 v76, v44
    v_exp_f32 v77, v45
    v_exp_f32 v78, v46
    v_exp_f32 v79, v47
    v_cvt_pk_bf16_f32 v80, v64, v65
    v_cvt_pk_bf16_f32 v81, v66, v67
    v_cvt_pk_bf16_f32 v82, v68, v69
    v_cvt_pk_bf16_f32 v83, v70, v71
    v_cvt_pk_bf16_f32 v84, v72, v73
    v_cvt_pk_bf16_f32 v85, v74, v75
    v_cvt_pk_bf16_f32 v86, v76, v77
    v_cvt_pk_bf16_f32 v87, v78, v79
    s_waitcnt lgkmcnt(5)
    v_mfma_f32_32x32x16_bf16 v[88:103], v[136:139], v[80:83], v[88:103]
    v_exp_f32 v64, v48
    v_exp_f32 v65, v49
    v_exp_f32 v66, v50
    v_exp_f32 v67, v51
    s_waitcnt lgkmcnt(4)
    v_mfma_f32_32x32x16_bf16 v[88:103], v[140:143], v[84:87], v[88:103]
    v_exp_f32 v68, v52
    v_exp_f32 v69, v53
    v_exp_f32 v70, v54
    v_exp_f32 v71, v55
    s_waitcnt lgkmcnt(3)
    v_mfma_f32_32x32x16_bf16 v[32:47], v[120:123], v[152:155], v[104:119]
    v_exp_f32 v72, v56
    v_exp_f32 v73, v57
    v_exp_f32 v74, v58
    v_exp_f32 v75, v59
    s_waitcnt lgkmcnt(2)
    v_mfma_f32_32x32x16_bf16 v[32:47], v[124:127], v[156:159], v[32:47]
    ds_read_b128 v[128:131], v8 offset:38912
    ds_read_b32 v132, v9 offset:38016
    ds_read_b128 v[136:139], v10 offset:37888
    ds_read_b128 v[140:143], v10 offset:38496
    v_exp_f32 v76, v60
    v_exp_f32 v77, v61
    v_exp_f32 v78, v62
    v_exp_f32 v79, v63
    v_cvt_pk_bf16_f32 v80, v64, v65
    v_cvt_pk_bf16_f32 v81, v66, v67
    v_cvt_pk_bf16_f32 v82, v68, v69
    v_cvt_pk_bf16_f32 v83, v70, v71
    v_cvt_pk_bf16_f32 v84, v72, v73
    v_cvt_pk_bf16_f32 v85, v74, v75
    v_cvt_pk_bf16_f32 v86, v76, v77
    v_cvt_pk_bf16_f32 v87, v78, v79
    s_waitcnt lgkmcnt(5)
    v_mfma_f32_32x32x16_bf16 v[88:103], v[144:147], v[80:83], v[88:103]
    v_add_u32 v8, 37888, v8
    v_add_u32 v9, 37888, v9
    v_add_u32 v10, 37888, v10
    s_add_u32 s41, s41, 3072
    s_cmp_eq_u32 s30, 2
    s_cselect_b32 s41, 0x7f000000, s41
    s_add_u32 s30, s30, 1
    s_cmp_lt_u32 s30, 4
    s_cbranch_scc1 L_attn_kernel_loopf
    s_waitcnt lgkmcnt(4)
    v_mfma_f32_32x32x16_bf16 v[88:103], v[148:151], v[84:87], v[88:103]
    s_mov_b32 s42, 0x17800000
    s_nop 10
    v_cmp_ngt_f32 vcc, v100, v16
    s_cbranch_vccnz L_attn_kernel_slow
L_attn_kernel_fin:
    s_nop 10
    v_rcp_f32 v12, v100
    s_mul_i32 s36, s33, 18
    v_lshl_add_u32 v6, v5, 2, s36
    v_lshlrev_b32 v6, 12, v6
    s_lshl_b32 s37, s35, 5
    v_add_u32 v7, s37, v4
    v_lshl_add_u32 v6, v7, 1, v6
    v_mul_f32 v88, v88, v12
    v_mul_f32 v89, v89, v12
    v_mul_f32 v90, v90, v12
    v_mul_f32 v91, v91, v12
    v_mul_f32 v92, v92, v12
    v_mul_f32 v93, v93, v12
    v_mul_f32 v94, v94, v12
    v_mul_f32 v95, v95, v12
    v_mul_f32 v96, v96, v12
    v_mul_f32 v97, v97, v12
    v_cvt_pk_bf16_f32 v64, v88, v89
    v_cvt_pk_bf16_f32 v65, v90, v91
    v_cvt_pk_bf16_f32 v66, v92, v93
    v_cvt_pk_bf16_f32 v67, v94, v95
    v_cvt_pk_bf16_f32 v68, v96, v97
    s_mov_b32 s37, 0
    buffer_store_short v64, v6, s[12:15], s37 offen
    s_mov_b32 s37, 4096
    buffer_store_short_d16_hi v64, v6, s[12:15], s37 offen
    s_mov_b32 s37, 8192
    buffer_store_short v65, v6, s[12:15], s37 offen
    s_mov_b32 s37, 12288
    buffer_store_short_d16_hi v65, v6, s[12:15], s37 offen
    s_mov_b32 s37, 32768
    buffer_store_short v66, v6, s[12:15], s37 offen
    s_mov_b32 s37, 36864
    buffer_store_short_d16_hi v66, v6, s[12:15], s37 offen
    s_mov_b32 s37, 40960
    buffer_store_short v67, v6, s[12:15], s37 offen
    s_mov_b32 s37, 45056
    buffer_store_short_d16_hi v67, v6, s[12:15], s37 offen
    s_mov_b64 exec, 0xffffffff
    s_mov_b32 s37, 65536
    buffer_store_short v68, v6, s[12:15], s37 offen
    s_mov_b32 s37, 69632
    buffer_store_short_d16_hi v68, v6, s[12:15], s37 offen
L_attn_kernel_end:
    s_endpgm
L_attn_kernel_slow:
    v_subrev_u32 v8, 151552, v8
    v_subrev_u32 v9, 151552, v9
    v_subrev_u32 v10, 151552, v10
    v_mov_b32 v88, 0
    v_mov_b32 v89, 0
    v_mov_b32 v90, 0
    v_mov_b32 v91, 0
    v_mov_b32 v92, 0
    v_mov_b32 v93, 0
    v_mov_b32 v94, 0
    v_mov_b32 v95, 0
    v_mov_b32 v96, 0
    v_mov_b32 v97, 0
    v_mov_b32 v98, 0
    v_mov_b32 v99, 0
    v_mov_b32 v100, 0
    v_mov_b32 v101, 0
    v_mov_b32 v102, 0
    v_mov_b32 v103, 0
    s_waitcnt lgkmcnt(0)
    ds_read_b128 v[120:123], v8 offset:0
    ds_read_b32 v124, v9 offset:0
    ds_read_b128 v[148:151], v10 offset:608
    ds_read_b128 v[128:131], v8 offset:1024
    ds_read_b32 v132, v9 offset:128
    s_waitcnt lgkmcnt(4)
    v_mfma_f32_32x32x16_bf16 v[32:47], v[120:123], v[152:155], 0
    s_waitcnt lgkmcnt(3)
    v_mfma_f32_32x32x16_bf16 v[32:47], v[124:127], v[156:159], v[32:47]
    s_nop 11
    v_max3_f32 v12, v32, v33, v34
    v_max3_f32 v12, v12, v35, v36
    v_max3_f32 v12, v12, v37, v38
    v_max3_f32 v12, v12, v39, v40
    v_max3_f32 v12, v12, v41, v42
    v_max3_f32 v12, v12, v43, v44
    v_max3_f32 v12, v12, v45, v46
    v_max_f32 v12, v12, v47
    v_mov_b32 v13, v12
    s_nop 1
    v_permlane32_swap_b32 v12, v13
    v_max_f32 v12, v12, v13
    v_add_f32 v12, 0x41800000, v12
    v_sub_f32 v104, 0, v12
    v_sub_f32 v105, 0, v12
    v_sub_f32 v106, 0, v12
    v_sub_f32 v107, 0, v12
    v_sub_f32 v108, 0, v12
    v_sub_f32 v109, 0, v12
    v_sub_f32 v110, 0, v12
    v_sub_f32 v111, 0, v12
    v_sub_f32 v112, 0, v12
    v_sub_f32 v113, 0, v12
    v_sub_f32 v114, 0, v12
    v_sub_f32 v115, 0, v12
    v_sub_f32 v116, 0, v12
    v_sub_f32 v117, 0, v12
    v_sub_f32 v118, 0, v12
    v_sub_f32 v119, 0, v12
    v_sub_f32 v32, v32, v12
    v_sub_f32 v33, v33, v12
    v_sub_f32 v34, v34, v12
    v_sub_f32 v35, v35, v12
    v_sub_f32 v36, v36, v12
    v_sub_f32 v37, v37, v12
    v_sub_f32 v38, v38, v12
    v_sub_f32 v39, v39, v12
    v_sub_f32 v40, v40, v12
    v_sub_f32 v41, v41, v12
    v_sub_f32 v42, v42, v12
    v_sub_f32 v43, v43, v12
    v_sub_f32 v44, v44, v12
    v_sub_f32 v45, v45, v12
    v_sub_f32 v46, v46, v12
    v_sub_f32 v47, v47, v12
    v_mov_b32 v84, 0
    v_mov_b32 v85, 0
    v_mov_b32 v86, 0
    v_mov_b32 v87, 0
    ds_read_b128 v[136:139], v10 offset:0
    ds_read_b128 v[140:143], v10 offset:608
    s_mov_b32 s30, 0
    s_mov_b32 s40, 0x40004000
L_attn_kernel_loops:
    v_exp_f32 v64, v32
    v_exp_f32 v65, v33
    v_exp_f32 v66, v34
    v_exp_f32 v67, v35
    s_waitcnt lgkmcnt(4)
    v_mfma_f32_32x32x16_bf16 v[88:103], v[148:151], v[84:87], v[88:103]
    v_exp_f32 v68, v36
    v_exp_f32 v69, v37
    v_exp_f32 v70, v38
    v_exp_f32 v71, v39
    s_waitcnt lgkmcnt(3)
    v_mfma_f32_32x32x16_bf16 v[48:63], v[128:131], v[152:155], v[104:119]
    v_exp_f32 v72, v40
    v_exp_f32 v73, v41
    v_exp_f32 v74, v42
    v_exp_f32 v75, v43
    s_waitcnt lgkmcnt(2)
    v_mfma_f32_32x32x16_bf16 v[48:63], v[132:135], v[156:159], v[48:63]
    ds_read_b128 v[120:123], v8 offset:2048
    ds_read_b32 v124, v9 offset:256
    ds_read_b128 v[144:147], v10 offset:1216
    ds_read_b128 v[148:151], v10 offset:1824
    v_exp_f32 v76, v44
    v_exp_f32 v77, v45
    v_exp_f32 v78, v46
    v_exp_f32 v79, v47
    v_cvt_pk_bf16_f32 v80, v64, v65
    v_cvt_pk_bf16_f32 v81, v66, v67
    v_cvt_pk_bf16_f32 v82, v68, v69
    v_cvt_pk_bf16_f32 v83, v70, v71
    v_cvt_pk_bf16_f32 v84, v72, v73
    v_cvt_pk_bf16_f32 v85, v74, v75
    v_cvt_pk_bf16_f32 v86, v76, v77
    v_cvt_pk_bf16_f32 v87, v78, v79
    v_or_b32 v12, v80, v81
    v_or_b32 v13, v82, v83
    v_or_b32 v14, v84, v85
    v_or_b32 v15, v86, v87
    v_or_b32 v12, v12, v13
    v_or_b32 v14, v14, v15
    v_or_b32 v12, v12, v14
    v_and_b32 v12, s40, v12
    v_cmp_ne_u32 vcc, 0, v12
    s_cbranch_vccnz L_attn_kernel_rare0
L_attn_kernel_back0:
    s_waitcnt lgkmcnt(5)
    v_mfma_f32_32x32x16_bf16 v[88:103], v[136:139], v[80:83], v[88:103]
    v_exp_f32 v64, v48
    v_exp_f32 v65, v49
    v_exp_f32 v66, v50
    v_exp_f32 v67, v51
    s_waitcnt lgkmcnt(4)
    v_mfma_f32_32x32x16_bf16 v[88:103], v[140:143], v[84:87], v[88:103]
    v_exp_f32 v68, v52
    v_exp_f32 v69, v53
    v_exp_f32 v70, v54
    v_exp_f32 v71, v55
    s_waitcnt lgkmcnt(3)
    v_mfma_f32_32x32x16_bf16 v[32:47], v[120:123], v[152:155], v[104:119]
    v_exp_f32 v72, v56
    v_exp_f32 v73, v57
    v_exp_f32 v74, v58
    v_exp_f32 v75, v59
    s_waitcnt lgkmcnt(2)
    v_mfma_f32_32x32x16_bf16 v[32:47], v[124:127], v[156:159], v[32:47]
    ds_read_b128 v[128:131], v8 offset:3072
    ds_read_b32 v132, v9 offset:384
    ds_read_b128 v[136:139], v10 offset:2432
    ds_read_b128 v[140:143], v10 offset:3040
    v_exp_f32 v76, v60
    v_exp_f32 v77, v61
    v_exp_f32 v78, v62
    v_exp_f32 v79, v63
    v_cvt_pk_bf16_f32 v80, v64, v65
    v_cvt_pk_bf16_f32 v81, v66, v67
    v_cvt_pk_bf16_f32 v82, v68, v69
    v_cvt_pk_bf16_f32 v83, v70, v71
    v_cvt_pk_bf16_f32 v84, v72, v73
    v_cvt_pk_bf16_f32 v85, v74, v75
    v_cvt_pk_bf16_f32 v86, v76, v77
    v_cvt_pk_bf16_f32 v87, v78, v79
    v_or_b32 v12, v80, v81
    v_or_b32 v13, v82, v83
    v_or_b32 v14, v84, v85
    v_or_b32 v15, v86, v87
    v_or_b32 v12, v12, v13
    v_or_b32 v14, v14, v15
    v_or_b32 v12, v12, v14
    v_and_b32 v12, s40, v12
    v_cmp_ne_u32 vcc, 0, v12
    s_cbranch_vccnz L_attn_kernel_rare1
L_attn_kernel_back1:
    s_waitcnt lgkmcnt(5)
    v_mfma_f32_32x32x16_bf16 v[88:103], v[144:147], v[80:83], v[88:103]
    v_exp_f32 v64, v32
    v_exp_f32 v65, v33
    v_exp_f32 v66, v34
    v_exp_f32 v67, v35
    s_waitcnt lgkmcnt(4)
    v_mfma_f32_32x32x16_bf16 v[88:103], v[148:151], v[84:87], v[88:103]
    v_exp_f32 v68, v36
    v_exp_f32 v69, v37
    v_exp_f32 v70, v38
    v_exp_f32 v71, v39
    s_waitcnt lgkmcnt(3)
    v_mfma_f32_32x32x16_bf16 v[48:63], v[128:131], v[152:155], v[104:119]
    v_exp_f32 v72, v40
    v_exp_f32 v73, v41
    v_exp_f32 v74, v42
    v_exp_f32 v75, v43
    s_waitcnt lgkmcnt(2)
    v_mfma_f32_32x32x16_bf16 v[48:63], v[132:135], v[156:159], v[48:63]
    ds_read_b128 v[120:123], v8 offset:4096
    ds_read_b32 v124, v9 offset:512
    ds_read_b128 v[144:147], v10 offset:3648
    ds_read_b128 v[148:151], v10 offset:4256
    v_exp_f32 v76, v44
    v_exp_f32 v77, v45
    v_exp_f32 v78, v46
    v_exp_f32 v79, v47
    v_cvt_pk_bf16_f32 v80, v64, v65
    v_cvt_pk_bf16_f32 v81, v66, v67
    v_cvt_pk_bf16_f32 v82, v68, v69
    v_cvt_pk_bf16_f32 v83, v70, v71
    v_cvt_pk_bf16_f32 v84, v72, v73
    v_cvt_pk_bf16_f32 v85, v74, v75
    v_cvt_pk_bf16_f32 v86, v76, v77
    v_cvt_pk_bf16_f32 v87, v78, v79
    v_or_b32 v12, v80, v81
    v_or_b32 v13, v82, v83
    v_or_b32 v14, v84, v85
    v_or_b32 v15, v86, v87
    v_or_b32 v12, v12, v13
    v_or_b32 v14, v14, v15
    v_or_b32 v12, v12, v14
    v_and_b32 v12, s40, v12
    v_cmp_ne_u32 vcc, 0, v12
    s_cbranch_vccnz L_attn_kernel_rare2
L_attn_kernel_back2:
    s_waitcnt lgkmcnt(5)
    v_mfma_f32_32x32x16_bf16 v[88:103], v[136:139], v[80:83], v[88:103]
    v_exp_f32 v64, v48
    v_exp_f32 v65, v49
    v_exp_f32 v66, v50
    v_exp_f32 v67, v51
    s_waitcnt lgkmcnt(4)
    v_mfma_f32_32x32x16_bf16 v[88:103], v[140:143], v[84:87], v[88:103]
    v_exp_f32 v68, v52
    v_exp_f32 v69, v53
    v_exp_f32 v70, v54
    v_exp_f32 v71, v55
    s_waitcnt lgkmcnt(3)
    v_mfma_f32_32x32x16_bf16 v[32:47], v[120:123], v[152:155], v[104:119]
    v_exp_f32 v72, v56
    v_exp_f32 v73, v57
    v_exp_f32 v74, v58
    v_exp_f32 v75, v59
    s_waitcnt lgkmcnt(2)
    v_mfma_f32_32x32x16_bf16 v[32:47], v[124:127], v[156:159], v[32:47]
    ds_read_b128 v[128:131], v8 offset:5120
    ds_read_b32 v132, v9 offset:640
    ds_read_b128 v[136:139], v10 offset:4864
    ds_read_b128 v[140:143], v10 offset:5472
    v_exp_f32 v76, v60
    v_exp_f32 v77, v61
    v_exp_f32 v78, v62
    v_exp_f32 v79, v63
    v_cvt_pk_bf16_f32 v80, v64, v65
    v_cvt_pk_bf16_f32 v81, v66, v67
    v_cvt_pk_bf16_f32 v82, v68, v69
    v_cvt_pk_bf16_f32 v83, v70, v71
    v_cvt_pk_bf16_f32 v84, v72, v73
    v_cvt_pk_bf16_f32 v85, v74, v75
    v_cvt_pk_bf16_f32 v86, v76, v77
    v_cvt_pk_bf16_f32 v87, v78, v79
    v_or_b32 v12, v80, v81
    v_or_b32 v13, v82, v83
    v_or_b32 v14, v84, v85
    v_or_b32 v15, v86, v87
    v_or_b32 v12, v12, v13
    v_or_b32 v14, v14, v15
    v_or_b32 v12, v12, v14
    v_and_b32 v12, s40, v12
    v_cmp_ne_u32 vcc, 0, v12
    s_cbranch_vccnz L_attn_kernel_rare3
L_attn_kernel_back3:
    s_waitcnt lgkmcnt(5)
    v_mfma_f32_32x32x16_bf16 v[88:103], v[144:147], v[80:83], v[88:103]
    v_exp_f32 v64, v32
    v_exp_f32 v65, v33
    v_exp_f32 v66, v34
    v_exp_f32 v67, v35
    s_waitcnt lgkmcnt(4)
    v_mfma_f32_32x32x16_bf16 v[88:103], v[148:151], v[84:87], v[88:103]
    v_exp_f32 v68, v36
    v_exp_f32 v69, v37
    v_exp_f32 v70, v38
    v_exp_f32 v71, v39
    s_waitcnt lgkmcnt(3)
    v_mfma_f32_32x32x16_bf16 v[48:63], v[128:131], v[152:155], v[104:119]
    v_exp_f32 v72, v40
    v_exp_f32 v73, v41
    v_exp_f32 v74, v42
    v_exp_f32 v75, v43
    s_waitcnt lgkmcnt(2)
    v_mfma_f32_32x32x16_bf16 v[48:63], v[132:135], v[156:159], v[48:63]
    ds_read_b128 v[120:123], v8 offset:6144
    ds_read_b32 v124, v9 offset:768
    ds_read_b128 v[144:147], v10 offset:6080
    ds_read_b128 v[148:151], v10 offset:6688
    v_exp_f32 v76, v44
    v_exp_f32 v77, v45
    v_exp_f32 v78, v46
    v_exp_f32 v79, v47
    v_cvt_pk_bf16_f32 v80, v64, v65
    v_cvt_pk_bf16_f32 v81, v66, v67
    v_cvt_pk_bf16_f32 v82, v68, v69
    v_cvt_pk_bf16_f32 v83, v70, v71
    v_cvt_pk_bf16_f32 v84, v72, v73
    v_cvt_pk_bf16_f32 v85, v74, v75
    v_cvt_pk_bf16_f32 v86, v76, v77
    v_cvt_pk_bf16_f32 v87, v78, v79
    v_or_b32 v12, v80, v81
    v_or_b32 v13, v82, v83
    v_or_b32 v14, v84, v85
    v_or_b32 v15, v86, v87
    v_or_b32 v12, v12, v13
    v_or_b32 v14, v14, v15
    v_or_b32 v12, v12, v14
    v_and_b32 v12, s40, v12
    v_cmp_ne_u32 vcc, 0, v12
    s_cbranch_vccnz L_attn_kernel_rare4
L_attn_kernel_back4:
    s_waitcnt lgkmcnt(5)
    v_mfma_f32_32x32x16_bf16 v[88:103], v[136:139], v[80:83], v[88:103]
    v_exp_f32 v64, v48
    v_exp_f32 v65, v49
    v_exp_f32 v66, v50
    v_exp_f32 v67, v51
    s_waitcnt lgkmcnt(4)
    v_mfma_f32_32x32x16_bf16 v[88:103], v[140:143], v[84:87], v[88:103]
    v_exp_f32 v68, v52
    v_exp_f32 v69, v53
    v_exp_f32 v70, v54
    v_exp_f32 v71, v55
    s_waitcnt lgkmcnt(3)
    v_mfma_f32_32x32x16_bf16 v[32:47], v[120:123], v[152:155], v[104:119]
    v_exp_f32 v72, v56
    v_exp_f32 v73, v57
    v_exp_f32 v74, v58
    v_exp_f32 v75, v59
    s_waitcnt lgkmcnt(2)
    v_mfma_f32_32x32x16_bf16 v[32:47], v[124:127], v[156:159], v[32:47]
    ds_read_b128 v[128:131], v8 offset:7168
    ds_read_b32 v132, v9 offset:896
    ds_read_b128 v[136:139], v10 offset:7296
    ds_read_b128 v[140:143], v10 offset:7904
    v_exp_f32 v76, v60
    v_exp_f32 v77, v61
    v_exp_f32 v78, v62
    v_exp_f32 v79, v63
    v_cvt_pk_bf16_f32 v80, v64, v65
    v_cvt_pk_bf16_f32 v81, v66, v67
    v_cvt_pk_bf16_f32 v82, v68, v69
    v_cvt_pk_bf16_f32 v83, v70, v71
    v_cvt_pk_bf16_f32 v84, v72, v73
    v_cvt_pk_bf16_f32 v85, v74, v75
    v_cvt_pk_bf16_f32 v86, v76, v77
    v_cvt_pk_bf16_f32 v87, v78, v79
    v_or_b32 v12, v80, v81
    v_or_b32 v13, v82, v83
    v_or_b32 v14, v84, v85
    v_or_b32 v15, v86, v87
    v_or_b32 v12, v12, v13
    v_or_b32 v14, v14, v15
    v_or_b32 v12, v12, v14
    v_and_b32 v12, s40, v12
    v_cmp_ne_u32 vcc, 0, v12
    s_cbranch_vccnz L_attn_kernel_rare5
L_attn_kernel_back5:
    s_waitcnt lgkmcnt(5)
    v_mfma_f32_32x32x16_bf16 v[88:103], v[144:147], v[80:83], v[88:103]
    v_exp_f32 v64, v32
    v_exp_f32 v65, v33
    v_exp_f32 v66, v34
    v_exp_f32 v67, v35
    s_waitcnt lgkmcnt(4)
    v_mfma_f32_32x32x16_bf16 v[88:103], v[148:151], v[84:87], v[88:103]
    v_exp_f32 v68, v36
    v_exp_f32 v69, v37
    v_exp_f32 v70, v38
    v_exp_f32 v71, v39
    s_waitcnt lgkmcnt(3)
    v_mfma_f32_32x32x16_bf16 v[48:63], v[128:131], v[152:155], v[104:119]
    v_exp_f32 v72, v40
    v_exp_f32 v73, v41
    v_exp_f32 v74, v42
    v_exp_f32 v75, v43
    s_waitcnt lgkmcnt(2)
    v_mfma_f32_32x32x16_bf16 v[48:63], v[132:135], v[156:159], v[48:63]
    ds_read_b128 v[120:123], v8 offset:8192
    ds_read_b32 v124, v9 offset:1024
    ds_read_b128 v[144:147], v10 offset:8512
    ds_read_b128 v[148:151], v10 offset:9120
    v_exp_f32 v76, v44
    v_exp_f32 v77, v45
    v_exp_f32 v78, v46
    v_exp_f32 v79, v47
    v_cvt_pk_bf16_f32 v80, v64, v65
    v_cvt_pk_bf16_f32 v81, v66, v67
    v_cvt_pk_bf16_f32 v82, v68, v69
    v_cvt_pk_bf16_f32 v83, v70, v71
    v_cvt_pk_bf16_f32 v84, v72, v73
    v_cvt_pk_bf16_f32 v85, v74, v75
    v_cvt_pk_bf16_f32 v86, v76, v77
    v_cvt_pk_bf16_f32 v87, v78, v79
    v_or_b32 v12, v80, v81
    v_or_b32 v13, v82, v83
    v_or_b32 v14, v84, v85
    v_or_b32 v15, v86, v87
    v_or_b32 v12, v12, v13
    v_or_b32 v14, v14, v15
    v_or_b32 v12, v12, v14
    v_and_b32 v12, s40, v12
    v_cmp_ne_u32 vcc, 0, v12
    s_cbranch_vccnz L_attn_kernel_rare6
L_attn_kernel_back6:
    s_waitcnt lgkmcnt(5)
    v_mfma_f32_32x32x16_bf16 v[88:103], v[136:139], v[80:83], v[88:103]
    v_exp_f32 v64, v48
    v_exp_f32 v65, v49
    v_exp_f32 v66, v50
    v_exp_f32 v67, v51
    s_waitcnt lgkmcnt(4)
    v_mfma_f32_32x32x16_bf16 v[88:103], v[140:143], v[84:87], v[88:103]
    v_exp_f32 v68, v52
    v_exp_f32 v69, v53
    v_exp_f32 v70, v54
    v_exp_f32 v71, v55
    s_waitcnt lgkmcnt(3)
    v_mfma_f32_32x32x16_bf16 v[32:47], v[120:123], v[152:155], v[104:119]
    v_exp_f32 v72, v56
    v_exp_f32 v73, v57
    v_exp_f32 v74, v58
    v_exp_f32 v75, v59
    s_waitcnt lgkmcnt(2)
    v_mfma_f32_32x32x16_bf16 v[32:47], v[124:127], v[156:159], v[32:47]
    ds_read_b128 v[128:131], v8 offset:9216
    ds_read_b32 v132, v9 offset:1152
    ds_read_b128 v[136:139], v10 offset:9728
    ds_read_b128 v[140:143], v10 offset:10336
    v_exp_f32 v76, v60
    v_exp_f32 v77, v61
    v_exp_f32 v78, v62
    v_exp_f32 v79, v63
    v_cvt_pk_bf16_f32 v80, v64, v65
    v_cvt_pk_bf16_f32 v81, v66, v67
    v_cvt_pk_bf16_f32 v82, v68, v69
    v_cvt_pk_bf16_f32 v83, v70, v71
    v_cvt_pk_bf16_f32 v84, v72, v73
    v_cvt_pk_bf16_f32 v85, v74, v75
    v_cvt_pk_bf16_f32 v86, v76, v77
    v_cvt_pk_bf16_f32 v87, v78, v79
    v_or_b32 v12, v80, v81
    v_or_b32 v13, v82, v83
    v_or_b32 v14, v84, v85
    v_or_b32 v15, v86, v87
    v_or_b32 v12, v12, v13
    v_or_b32 v14, v14, v15
    v_or_b32 v12, v12, v14
    v_and_b32 v12, s40, v12
    v_cmp_ne_u32 vcc, 0, v12
    s_cbranch_vccnz L_attn_kernel_rare7
L_attn_kernel_back7:
    s_waitcnt lgkmcnt(5)
    v_mfma_f32_32x32x16_bf16 v[88:103], v[144:147], v[80:83], v[88:103]
    v_exp_f32 v64, v32
    v_exp_f32 v65, v33
    v_exp_f32 v66, v34
    v_exp_f32 v67, v35
    s_waitcnt lgkmcnt(4)
    v_mfma_f32_32x32x16_bf16 v[88:103], v[148:151], v[84:87], v[88:103]
    v_exp_f32 v68, v36
    v_exp_f32 v69, v37
    v_exp_f32 v70, v38
    v_exp_f32 v71, v39
    s_waitcnt lgkmcnt(3)
    v_mfma_f32_32x32x16_bf16 v[48:63], v[128:131], v[152:155], v[104:119]
    v_exp_f32 v72, v40
    v_exp_f32 v73, v41
    v_exp_f32 v74, v42
    v_exp_f32 v75, v43
    s_waitcnt lgkmcnt(2)
    v_mfma_f32_32x32x16_bf16 v[48:63], v[132:135], v[156:159], v[48:63]
    ds_read_b128 v[120:123], v8 offset:10240
    ds_read_b32 v124, v9 offset:1280
    ds_read_b128 v[144:147], v10 offset:10944
    ds_read_b128 v[148:151], v10 offset:11552
    v_exp_f32 v76, v44
    v_exp_f32 v77, v45
    v_exp_f32 v78, v46
    v_exp_f32 v79, v47
    v_cvt_pk_bf16_f32 v80, v64, v65
    v_cvt_pk_bf16_f32 v81, v66, v67
    v_cvt_pk_bf16_f32 v82, v68, v69
    v_cvt_pk_bf16_f32 v83, v70, v71
    v_cvt_pk_bf16_f32 v84, v72, v73
    v_cvt_pk_bf16_f32 v85, v74, v75
    v_cvt_pk_bf16_f32 v86, v76, v77
    v_cvt_pk_bf16_f32 v87, v78, v79
    v_or_b32 v12, v80, v81
    v_or_b32 v13, v82, v83
    v_or_b32 v14, v84, v85
    v_or_b32 v15, v86, v87
    v_or_b32 v12, v12, v13
    v_or_b32 v14, v14, v15
    v_or_b32 v12, v12, v14
    v_and_b32 v12, s40, v12
    v_cmp_ne_u32 vcc, 0, v12
    s_cbranch_vccnz L_attn_kernel_rare8
L_attn_kernel_back8:
    s_waitcnt lgkmcnt(5)
    v_mfma_f32_32x32x16_bf16 v[88:103], v[136:139], v[80:83], v[88:103]
    v_exp_f32 v64, v48
    v_exp_f32 v65, v49
    v_exp_f32 v66, v50
    v_exp_f32 v67, v51
    s_waitcnt lgkmcnt(4)
    v_mfma_f32_32x32x16_bf16 v[88:103], v[140:143], v[84:87], v[88:103]
    v_exp_f32 v68, v52
    v_exp_f32 v69, v53
    v_exp_f32 v70, v54
    v_exp_f32 v71, v55
    s_waitcnt lgkmcnt(3)
    v_mfma_f32_32x32x16_bf16 v[32:47], v[120:123], v[152:155], v[104:119]
    v_exp_f32 v72, v56
    v_exp_f32 v73, v57
    v_exp_f32 v74, v58
    v_exp_f32 v75, v59
    s_waitcnt lgkmcnt(2)
    v_mfma_f32_32x32x16_bf16 v[32:47], v[124:127], v[156:159], v[32:47]
    ds_read_b128 v[128:131], v8 offset:11264
    ds_read_b32 v132, v9 offset:1408
    ds_read_b128 v[136:139], v10 offset:12160
    ds_read_b128 v[140:143], v10 offset:12768
    v_exp_f32 v76, v60
    v_exp_f32 v77, v61
    v_exp_f32 v78, v62
    v_exp_f32 v79, v63
    v_cvt_pk_bf16_f32 v80, v64, v65
    v_cvt_pk_bf16_f32 v81, v66, v67
    v_cvt_pk_bf16_f32 v82, v68, v69
    v_cvt_pk_bf16_f32 v83, v70, v71
    v_cvt_pk_bf16_f32 v84, v72, v73
    v_cvt_pk_bf16_f32 v85, v74, v75
    v_cvt_pk_bf16_f32 v86, v76, v77
    v_cvt_pk_bf16_f32 v87, v78, v79
    v_or_b32 v12, v80, v81
    v_or_b32 v13, v82, v83
    v_or_b32 v14, v84, v85
    v_or_b32 v15, v86, v87
    v_or_b32 v12, v12, v13
    v_or_b32 v14, v14, v15
    v_or_b32 v12, v12, v14
    v_and_b32 v12, s40, v12
    v_cmp_ne_u32 vcc, 0, v12
    s_cbranch_vccnz L_attn_kernel_rare9
L_attn_kernel_back9:
    s_waitcnt lgkmcnt(5)
    v_mfma_f32_32x32x16_bf16 v[88:103], v[144:147], v[80:83], v[88:103]
    v_exp_f32 v64, v32
    v_exp_f32 v65, v33
    v_exp_f32 v66, v34
    v_exp_f32 v67, v35
    s_waitcnt lgkmcnt(4)
    v_mfma_f32_32x32x16_bf16 v[88:103], v[148:151], v[84:87], v[88:103]
    v_exp_f32 v68, v36
    v_exp_f32 v69, v37
    v_exp_f32 v70, v38
    v_exp_f32 v71, v39
    s_waitcnt lgkmcnt(3)
    v_mfma_f32_32x32x16_bf16 v[48:63], v[128:131], v[152:155], v[104:119]
    v_exp_f32 v72, v40
    v_exp_f32 v73, v41
    v_exp_f32 v74, v42
    v_exp_f32 v75, v43
    s_waitcnt lgkmcnt(2)
    v_mfma_f32_32x32x16_bf16 v[48:63], v[132:135], v[156:159], v[48:63]
    ds_read_b128 v[120:123], v8 offset:12288
    ds_read_b32 v124, v9 offset:1536
    ds_read_b128 v[144:147], v10 offset:13376
    ds_read_b128 v[148:151], v10 offset:13984
    v_exp_f32 v76, v44
    v_exp_f32 v77, v45
    v_exp_f32 v78, v46
    v_exp_f32 v79, v47
    v_cvt_pk_bf16_f32 v80, v64, v65
    v_cvt_pk_bf16_f32 v81, v66, v67
    v_cvt_pk_bf16_f32 v82, v68, v69
    v_cvt_pk_bf16_f32 v83, v70, v71
    v_cvt_pk_bf16_f32 v84, v72, v73
    v_cvt_pk_bf16_f32 v85, v74, v75
    v_cvt_pk_bf16_f32 v86, v76, v77
    v_cvt_pk_bf16_f32 v87, v78, v79
    v_or_b32 v12, v80, v81
    v_or_b32 v13, v82, v83
    v_or_b32 v14, v84, v85
    v_or_b32 v15, v86, v87
    v_or_b32 v12, v12, v13
    v_or_b32 v14, v14, v15
    v_or_b32 v12, v12, v14
    v_and_b32 v12, s40, v12
    v_cmp_ne_u32 vcc, 0, v12
    s_cbranch_vccnz L_attn_kernel_rare10
L_attn_kernel_back10:
    s_waitcnt lgkmcnt(5)
    v_mfma_f32_32x32x16_bf16 v[88:103], v[136:139], v[80:83], v[88:103]
    v_exp_f32 v64, v48
    v_exp_f32 v65, v49
    v_exp_f32 v66, v50
    v_exp_f32 v67, v51
    s_waitcnt lgkmcnt(4)
    v_mfma_f32_32x32x16_bf16 v[88:103], v[140:143], v[84:87], v[88:103]
    v_exp_f32 v68, v52
    v_exp_f32 v69, v53
    v_exp_f32 v70, v54
    v_exp_f32 v71, v55
    s_waitcnt lgkmcnt(3)
    v_mfma_f32_32x32x16_bf16 v[32:47], v[120:123], v[152:155], v[104:119]
    v_exp_f32 v72, v56
    v_exp_f32 v73, v57
    v_exp_f32 v74, v58
    v_exp_f32 v75, v59
    s_waitcnt lgkmcnt(2)
    v_mfma_f32_32x32x16_bf16 v[32:47], v[124:127], v[156:159], v[32:47]
    ds_read_b128 v[128:131], v8 offset:13312
    ds_read_b32 v132, v9 offset:1664
    ds_read_b128 v[136:139], v10 offset:14592
    ds_read_b128 v[140:143], v10 offset:15200
    v_exp_f32 v76, v60
    v_exp_f32 v77, v61
    v_exp_f32 v78, v62
    v_exp_f32 v79, v63
    v_cvt_pk_bf16_f32 v80, v64, v65
    v_cvt_pk_bf16_f32 v81, v66, v67
    v_cvt_pk_bf16_f32 v82, v68, v69
    v_cvt_pk_bf16_f32 v83, v70, v71
    v_cvt_pk_bf16_f32 v84, v72, v73
    v_cvt_pk_bf16_f32 v85, v74, v75
    v_cvt_pk_bf16_f32 v86, v76, v77
    v_cvt_pk_bf16_f32 v87, v78, v79
    v_or_b32 v12, v80, v81
    v_or_b32 v13, v82, v83
    v_or_b32 v14, v84, v85
    v_or_b32 v15, v86, v87
    v_or_b32 v12, v12, v13
    v_or_b32 v14, v14, v15
    v_or_b32 v12, v12, v14
    v_and_b32 v12, s40, v12
    v_cmp_ne_u32 vcc, 0, v12
    s_cbranch_vccnz L_attn_kernel_rare11
L_attn_kernel_back11:
    s_waitcnt lgkmcnt(5)
    v_mfma_f32_32x32x16_bf16 v[88:103], v[144:147], v[80:83], v[88:103]
    v_exp_f32 v64, v32
    v_exp_f32 v65, v33
    v_exp_f32 v66, v34
    v_exp_f32 v67, v35
    s_waitcnt lgkmcnt(4)
    v_mfma_f32_32x32x16_bf16 v[88:103], v[148:151], v[84:87], v[88:103]
    v_exp_f32 v68, v36
    v_exp_f32 v69, v37
    v_exp_f32 v70, v38
    v_exp_f32 v71, v39
    s_waitcnt lgkmcnt(3)
    v_mfma_f32_32x32x16_bf16 v[48:63], v[128:131], v[152:155], v[104:119]
    v_exp_f32 v72, v40
    v_exp_f32 v73, v41
    v_exp_f32 v74, v42
    v_exp_f32 v75, v43
    s_waitcnt lgkmcnt(2)
    v_mfma_f32_32x32x16_bf16 v[48:63], v[132:135], v[156:159], v[48:63]
    ds_read_b128 v[120:123], v8 offset:14336
    ds_read_b32 v124, v9 offset:1792
    ds_read_b128 v[144:147], v10 offset:15808
    ds_read_b128 v[148:151], v10 offset:16416
    v_exp_f32 v76, v44
    v_exp_f32 v77, v45
    v_exp_f32 v78, v46
    v_exp_f32 v79, v47
    v_cvt_pk_bf16_f32 v80, v64, v65
    v_cvt_pk_bf16_f32 v81, v66, v67
    v_cvt_pk_bf16_f32 v82, v68, v69
    v_cvt_pk_bf16_f32 v83, v70, v71
    v_cvt_pk_bf16_f32 v84, v72, v73
    v_cvt_pk_bf16_f32 v85, v74, v75
    v_cvt_pk_bf16_f32 v86, v76, v77
    v_cvt_pk_bf16_f32 v87, v78, v79
    v_or_b32 v12, v80, v81
    v_or_b32 v13, v82, v83
    v_or_b32 v14, v84, v85
    v_or_b32 v15, v86, v87
    v_or_b32 v12, v12, v13
    v_or_b32 v14, v14, v15
    v_or_b32 v12, v12, v14
    v_and_b32 v12, s40, v12
    v_cmp_ne_u32 vcc, 0, v12
    s_cbranch_vccnz L_attn_kernel_rare12
L_attn_kernel_back12:
    s_waitcnt lgkmcnt(5)
    v_mfma_f32_32x32x16_bf16 v[88:103], v[136:139], v[80:83], v[88:103]
    v_exp_f32 v64, v48
    v_exp_f32 v65, v49
    v_exp_f32 v66, v50
    v_exp_f32 v67, v51
    s_waitcnt lgkmcnt(4)
    v_mfma_f32_32x32x16_bf16 v[88:103], v[140:143], v[84:87], v[88:103]
    v_exp_f32 v68, v52
    v_exp_f32 v69, v53
    v_exp_f32 v70, v54
    v_exp_f32 v71, v55
    s_waitcnt lgkmcnt(3)
    v_mfma_f32_32x32x16_bf16 v[32:47], v[120:123], v[152:155], v[104:119]
    v_exp_f32 v72, v56
    v_exp_f32 v73, v57
    v_exp_f32 v74, v58
    v_exp_f32 v75, v59
    s_waitcnt lgkmcnt(2)
    v_mfma_f32_32x32x16_bf16 v[32:47], v[124:127], v[156:159], v[32:47]
    ds_read_b128 v[128:131], v8 offset:15360
    ds_read_b32 v132, v9 offset:1920
    ds_read_b128 v[136:139], v10 offset:17024
    ds_read_b128 v[140:143], v10 offset:17632
    v_exp_f32 v76, v60
    v_exp_f32 v77, v61
    v_exp_f32 v78, v62
    v_exp_f32 v79, v63
    v_cvt_pk_bf16_f32 v80, v64, v65
    v_cvt_pk_bf16_f32 v81, v66, v67
    v_cvt_pk_bf16_f32 v82, v68, v69
    v_cvt_pk_bf16_f32 v83, v70, v71
    v_cvt_pk_bf16_f32 v84, v72, v73
    v_cvt_pk_bf16_f32 v85, v74, v75
    v_cvt_pk_bf16_f32 v86, v76, v77
    v_cvt_pk_bf16_f32 v87, v78, v79
    v_or_b32 v12, v80, v81
    v_or_b32 v13, v82, v83
    v_or_b32 v14, v84, v85
    v_or_b32 v15, v86, v87
    v_or_b32 v12, v12, v13
    v_or_b32 v14, v14, v15
    v_or_b32 v12, v12, v14
    v_and_b32 v12, s40, v12
    v_cmp_ne_u32 vcc, 0, v12
    s_cbranch_vccnz L_attn_kernel_rare13
L_attn_kernel_back13:
    s_waitcnt lgkmcnt(5)
    v_mfma_f32_32x32x16_bf16 v[88:103], v[144:147], v[80:83], v[88:103]
    v_exp_f32 v64, v32
    v_exp_f32 v65, v33
    v_exp_f32 v66, v34
    v_exp_f32 v67, v35
    s_waitcnt lgkmcnt(4)
    v_mfma_f32_32x32x16_bf16 v[88:103], v[148:151], v[84:87], v[88:103]
    v_exp_f32 v68, v36
    v_exp_f32 v69, v37
    v_exp_f32 v70, v38
    v_exp_f32 v71, v39
    s_waitcnt lgkmcnt(3)
    v_mfma_f32_32x32x16_bf16 v[48:63], v[128:131], v[152:155], v[104:119]
    v_exp_f32 v72, v40
    v_exp_f32 v73, v41
    v_exp_f32 v74, v42
    v_exp_f32 v75, v43
    s_waitcnt lgkmcnt(2)
    v_mfma_f32_32x32x16_bf16 v[48:63], v[132:135], v[156:159], v[48:63]
    ds_read_b128 v[120:123], v8 offset:37888
    ds_read_b32 v124, v9 offset:37888
    ds_read_b128 v[144:147], v10 offset:18240
    ds_read_b128 v[148:151], v10 offset:18848
    v_exp_f32 v76, v44
    v_exp_f32 v77, v45
    v_exp_f32 v78, v46
    v_exp_f32 v79, v47
    v_cvt_pk_bf16_f32 v80, v64, v65
    v_cvt_pk_bf16_f32 v81, v66, v67
    v_cvt_pk_bf16_f32 v82, v68, v69
    v_cvt_pk_bf16_f32 v83, v70, v71
    v_cvt_pk_bf16_f32 v84, v72, v73
    v_cvt_pk_bf16_f32 v85, v74, v75
    v_cvt_pk_bf16_f32 v86, v76, v77
    v_cvt_pk_bf16_f32 v87, v78, v79
    v_or_b32 v12, v80, v81
    v_or_b32 v13, v82, v83
    v_or_b32 v14, v84, v85
    v_or_b32 v15, v86, v87
    v_or_b32 v12, v12, v13
    v_or_b32 v14, v14, v15
    v_or_b32 v12, v12, v14
    v_and_b32 v12, s40, v12
    v_cmp_ne_u32 vcc, 0, v12
    s_cbranch_vccnz L_attn_kernel_rare14
L_attn_kernel_back14:
    s_waitcnt lgkmcnt(5)
    v_mfma_f32_32x32x16_bf16 v[88:103], v[136:139], v[80:83], v[88:103]
    v_exp_f32 v64, v48
    v_exp_f32 v65, v49
    v_exp_f32 v66, v50
    v_exp_f32 v67, v51
    s_waitcnt lgkmcnt(4)
    v_mfma_f32_32x32x16_bf16 v[88:103], v[140:143], v[84:87], v[88:103]
    v_exp_f32 v68, v52
    v_exp_f32 v69, v53
    v_exp_f32 v70, v54
    v_exp_f32 v71, v55
    s_waitcnt lgkmcnt(3)
    v_mfma_f32_32x32x16_bf16 v[32:47], v[120:123], v[152:155], v[104:119]
    v_exp_f32 v72, v56
    v_exp_f32 v73, v57
    v_exp_f32 v74, v58
    v_exp_f32 v75, v59
    s_waitcnt lgkmcnt(2)
    v_mfma_f32_32x32x16_bf16 v[32:47], v[124:127], v[156:159], v[32:47]
    ds_read_b128 v[128:131], v8 offset:38912
    ds_read_b32 v132, v9 offset:38016
    ds_read_b128 v[136:139], v10 offset:37888
    ds_read_b128 v[140:143], v10 offset:38496
    v_exp_f32 v76, v60
    v_exp_f32 v77, v61
    v_exp_f32 v78, v62
    v_exp_f32 v79, v63
    v_cvt_pk_bf16_f32 v80, v64, v65
    v_cvt_pk_bf16_f32 v81, v66, v67
    v_cvt_pk_bf16_f32 v82, v68, v69
    v_cvt_pk_bf16_f32 v83, v70, v71
    v_cvt_pk_bf16_f32 v84, v72, v73
    v_cvt_pk_bf16_f32 v85, v74, v75
    v_cvt_pk_bf16_f32 v86, v76, v77
    v_cvt_pk_bf16_f32 v87, v78, v79
    v_or_b32 v12, v80, v81
    v_or_b32 v13, v82, v83
    v_or_b32 v14, v84, v85
    v_or_b32 v15, v86, v87
    v_or_b32 v12, v12, v13
    v_or_b32 v14, v14, v15
    v_or_b32 v12, v12, v14
    v_and_b32 v12, s40, v12
    v_cmp_ne_u32 vcc, 0, v12
    s_cbranch_vccnz L_attn_kernel_rare15
L_attn_kernel_back15:
    s_waitcnt lgkmcnt(5)
    v_mfma_f32_32x32x16_bf16 v[88:103], v[144:147], v[80:83], v[88:103]
    v_add_u32 v8, 37888, v8
    v_add_u32 v9, 37888, v9
    v_add_u32 v10, 37888, v10
    s_add_u32 s30, s30, 1
    s_cmp_lt_u32 s30, 4
    s_cbranch_scc1 L_attn_kernel_loops
    s_waitcnt lgkmcnt(4)
    v_mfma_f32_32x32x16_bf16 v[88:103], v[148:151], v[84:87], v[88:103]
    s_branch L_attn_kernel_fin
L_attn_kernel_rare0:
    v_max3_f32 v12, v32, v33, v34
    v_max3_f32 v12, v12, v35, v36
    v_max3_f32 v12, v12, v37, v38
    v_max3_f32 v12, v12, v39, v40
    v_max3_f32 v12, v12, v41, v42
    v_max3_f32 v12, v12, v43, v44
    v_max3_f32 v12, v12, v45, v46
    v_max_f32 v12, v12, v47
    v_mov_b32 v13, v12
    s_nop 1
    v_permlane32_swap_b32 v12, v13
    v_max_f32 v12, v12, v13
    v_add_f32 v12, 0x41800000, v12
    v_max_f32 v12, 0, v12
    v_sub_f32 v13, 0, v12
    v_exp_f32 v13, v13
    v_sub_f32 v32, v32, v12
    v_sub_f32 v33, v33, v12
    v_sub_f32 v34, v34, v12
    v_sub_f32 v35, v35, v12
    v_sub_f32 v36, v36, v12
    v_sub_f32 v37, v37, v12
    v_sub_f32 v38, v38, v12
    v_sub_f32 v39, v39, v12
    v_sub_f32 v40, v40, v12
    v_sub_f32 v41, v41, v12
    v_sub_f32 v42, v42, v12
    v_sub_f32 v43, v43, v12
    v_sub_f32 v44, v44, v12
    v_sub_f32 v45, v45, v12
    v_sub_f32 v46, v46, v12
    v_sub_f32 v47, v47, v12
    v_sub_f32 v104, v104, v12
    v_sub_f32 v105, v105, v12
    v_sub_f32 v106, v106, v12
    v_sub_f32 v107, v107, v12
    v_sub_f32 v108, v108, v12
    v_sub_f32 v109, v109, v12
    v_sub_f32 v110, v110, v12
    v_sub_f32 v111, v111, v12
    v_sub_f32 v112, v112, v12
    v_sub_f32 v113, v113, v12
    v_sub_f32 v114, v114, v12
    v_sub_f32 v115, v115, v12
    v_sub_f32 v116, v116, v12
    v_sub_f32 v117, v117, v12
    v_sub_f32 v118, v118, v12
    v_sub_f32 v119, v119, v12
    v_mul_f32 v88, v88, v13
    v_mul_f32 v89, v89, v13
    v_mul_f32 v90, v90, v13
    v_mul_f32 v91, v91, v13
    v_mul_f32 v92, v92, v13
    v_mul_f32 v93, v93, v13
    v_mul_f32 v94, v94, v13
    v_mul_f32 v95, v95, v13
    v_mul_f32 v96, v96, v13
    v_mul_f32 v97, v97, v13
    v_mul_f32 v98, v98, v13
    v_mul_f32 v99, v99, v13
    v_mul_f32 v100, v100, v13
    v_mul_f32 v101, v101, v13
    v_mul_f32 v102, v102, v13
    v_mul_f32 v103, v103, v13
    v_sub_f32 v48, v48, v12
    v_sub_f32 v49, v49, v12
    v_sub_f32 v50, v50, v12
    v_sub_f32 v51, v51, v12
    v_sub_f32 v52, v52, v12
    v_sub_f32 v53, v53, v12
    v_sub_f32 v54, v54, v12
    v_sub_f32 v55, v55, v12
    v_sub_f32 v56, v56, v12
    v_sub_f32 v57, v57, v12
    v_sub_f32 v58, v58, v12
    v_sub_f32 v59, v59, v12
    v_sub_f32 v60, v60, v12
    v_sub_f32 v61, v61, v12
    v_sub_f32 v62, v62, v12
    v_sub_f32 v63, v63, v12
    v_exp_f32 v64, v32
    v_exp_f32 v65, v33
    v_exp_f32 v66, v34
    v_exp_f32 v67, v35
    v_exp_f32 v68, v36
    v_exp_f32 v69, v37
    v_exp_f32 v70, v38
    v_exp_f32 v71, v39
    v_exp_f32 v72, v40
    v_exp_f32 v73, v41
    v_exp_f32 v74, v42
    v_exp_f32 v75, v43
    v_exp_f32 v76, v44
    v_exp_f32 v77, v45
    v_exp_f32 v78, v46
    v_exp_f32 v79, v47
    v_cvt_pk_bf16_f32 v80, v64, v65
    v_cvt_pk_bf16_f32 v81, v66, v67
    v_cvt_pk_bf16_f32 v82, v68, v69
    v_cvt_pk_bf16_f32 v83, v70, v71
    v_cvt_pk_bf16_f32 v84, v72, v73
    v_cvt_pk_bf16_f32 v85, v74, v75
    v_cvt_pk_bf16_f32 v86, v76, v77
    v_cvt_pk_bf16_f32 v87, v78, v79
    s_branch L_attn_kernel_back0
L_attn_kernel_rare1:
    v_max3_f32 v12, v48, v49, v50
    v_max3_f32 v12, v12, v51, v52
    v_max3_f32 v12, v12, v53, v54
    v_max3_f32 v12, v12, v55, v56
    v_max3_f32 v12, v12, v57, v58
    v_max3_f32 v12, v12, v59, v60
    v_max3_f32 v12, v12, v61, v62
    v_max_f32 v12, v12, v63
    v_mov_b32 v13, v12
    s_nop 1
    v_permlane32_swap_b32 v12, v13
    v_max_f32 v12, v12, v13
    v_add_f32 v12, 0x41800000, v12
    v_max_f32 v12, 0, v12
    v_sub_f32 v13, 0, v12
    v_exp_f32 v13, v13
    v_sub_f32 v48, v48, v12
    v_sub_f32 v49, v49, v12
    v_sub_f32 v50, v50, v12
    v_sub_f32 v51, v51, v12
    v_sub_f32 v52, v52, v12
    v_sub_f32 v53, v53, v12
    v_sub_f32 v54, v54, v12
    v_sub_f32 v55, v55, v12
    v_sub_f32 v56, v56, v12
    v_sub_f32 v57, v57, v12
    v_sub_f32 v58, v58, v12
    v_sub_f32 v59, v59, v12
    v_sub_f32 v60, v60, v12
    v_sub_f32 v61, v61, v12
    v_sub_f32 v62, v62, v12
    v_sub_f32 v63, v63, v12
    v_sub_f32 v104, v104, v12
    v_sub_f32 v105, v105, v12
    v_sub_f32 v106, v106, v12
    v_sub_f32 v107, v107, v12
    v_sub_f32 v108, v108, v12
    v_sub_f32 v109, v109, v12
    v_sub_f32 v110, v110, v12
    v_sub_f32 v111, v111, v12
    v_sub_f32 v112, v112, v12
    v_sub_f32 v113, v113, v12
    v_sub_f32 v114, v114, v12
    v_sub_f32 v115, v115, v12
    v_sub_f32 v116, v116, v12
    v_sub_f32 v117, v117, v12
    v_sub_f32 v118, v118, v12
    v_sub_f32 v119, v119, v12
    v_mul_f32 v88, v88, v13
    v_mul_f32 v89, v89, v13
    v_mul_f32 v90, v90, v13
    v_mul_f32 v91, v91, v13
    v_mul_f32 v92, v92, v13
    v_mul_f32 v93, v93, v13
    v_mul_f32 v94, v94, v13
    v_mul_f32 v95, v95, v13
    v_mul_f32 v96, v96, v13
    v_mul_f32 v97, v97, v13
    v_mul_f32 v98, v98, v13
    v_mul_f32 v99, v99, v13
    v_mul_f32 v100, v100, v13
    v_mul_f32 v101, v101, v13
    v_mul_f32 v102, v102, v13
    v_mul_f32 v103, v103, v13
    v_sub_f32 v32, v32, v12
    v_sub_f32 v33, v33, v12
    v_sub_f32 v34, v34, v12
    v_sub_f32 v35, v35, v12
    v_sub_f32 v36, v36, v12
    v_sub_f32 v37, v37, v12
    v_sub_f32 v38, v38, v12
    v_sub_f32 v39, v39, v12
    v_sub_f32 v40, v40, v12
    v_sub_f32 v41, v41, v12
    v_sub_f32 v42, v42, v12
    v_sub_f32 v43, v43, v12
    v_sub_f32 v44, v44, v12
    v_sub_f32 v45, v45, v12
    v_sub_f32 v46, v46, v12
    v_sub_f32 v47, v47, v12
    v_exp_f32 v64, v48
    v_exp_f32 v65, v49
    v_exp_f32 v66, v50
    v_exp_f32 v67, v51
    v_exp_f32 v68, v52
    v_exp_f32 v69, v53
    v_exp_f32 v70, v54
    v_exp_f32 v71, v55
    v_exp_f32 v72, v56
    v_exp_f32 v73, v57
    v_exp_f32 v74, v58
    v_exp_f32 v75, v59
    v_exp_f32 v76, v60
    v_exp_f32 v77, v61
    v_exp_f32 v78, v62
    v_exp_f32 v79, v63
    v_cvt_pk_bf16_f32 v80, v64, v65
    v_cvt_pk_bf16_f32 v81, v66, v67
    v_cvt_pk_bf16_f32 v82, v68, v69
    v_cvt_pk_bf16_f32 v83, v70, v71
    v_cvt_pk_bf16_f32 v84, v72, v73
    v_cvt_pk_bf16_f32 v85, v74, v75
    v_cvt_pk_bf16_f32 v86, v76, v77
    v_cvt_pk_bf16_f32 v87, v78, v79
    s_branch L_attn_kernel_back1
L_attn_kernel_rare2:
    v_max3_f32 v12, v32, v33, v34
    v_max3_f32 v12, v12, v35, v36
    v_max3_f32 v12, v12, v37, v38
    v_max3_f32 v12, v12, v39, v40
    v_max3_f32 v12, v12, v41, v42
    v_max3_f32 v12, v12, v43, v44
    v_max3_f32 v12, v12, v45, v46
    v_max_f32 v12, v12, v47
    v_mov_b32 v13, v12
    s_nop 1
    v_permlane32_swap_b32 v12, v13
    v_max_f32 v12, v12, v13
    v_add_f32 v12, 0x41800000, v12
    v_max_f32 v12, 0, v12
    v_sub_f32 v13, 0, v12
    v_exp_f32 v13, v13
    v_sub_f32 v32, v32, v12
    v_sub_f32 v33, v33, v12
    v_sub_f32 v34, v34, v12
    v_sub_f32 v35, v35, v12
    v_sub_f32 v36, v36, v12
    v_sub_f32 v37, v37, v12
    v_sub_f32 v38, v38, v12
    v_sub_f32 v39, v39, v12
    v_sub_f32 v40, v40, v12
    v_sub_f32 v41, v41, v12
    v_sub_f32 v42, v42, v12
    v_sub_f32 v43, v43, v12
    v_sub_f32 v44, v44, v12
    v_sub_f32 v45, v45, v12
    v_sub_f32 v46, v46, v12
    v_sub_f32 v47, v47, v12
    v_sub_f32 v104, v104, v12
    v_sub_f32 v105, v105, v12
    v_sub_f32 v106, v106, v12
    v_sub_f32 v107, v107, v12
    v_sub_f32 v108, v108, v12
    v_sub_f32 v109, v109, v12
    v_sub_f32 v110, v110, v12
    v_sub_f32 v111, v111, v12
    v_sub_f32 v112, v112, v12
    v_sub_f32 v113, v113, v12
    v_sub_f32 v114, v114, v12
    v_sub_f32 v115, v115, v12
    v_sub_f32 v116, v116, v12
    v_sub_f32 v117, v117, v12
    v_sub_f32 v118, v118, v12
    v_sub_f32 v119, v119, v12
    v_mul_f32 v88, v88, v13
    v_mul_f32 v89, v89, v13
    v_mul_f32 v90, v90, v13
    v_mul_f32 v91, v91, v13
    v_mul_f32 v92, v92, v13
    v_mul_f32 v93, v93, v13
    v_mul_f32 v94, v94, v13
    v_mul_f32 v95, v95, v13
    v_mul_f32 v96, v96, v13
    v_mul_f32 v97, v97, v13
    v_mul_f32 v98, v98, v13
    v_mul_f32 v99, v99, v13
    v_mul_f32 v100, v100, v13
    v_mul_f32 v101, v101, v13
    v_mul_f32 v102, v102, v13
    v_mul_f32 v103, v103, v13
    v_sub_f32 v48, v48, v12
    v_sub_f32 v49, v49, v12
    v_sub_f32 v50, v50, v12
    v_sub_f32 v51, v51, v12
    v_sub_f32 v52, v52, v12
    v_sub_f32 v53, v53, v12
    v_sub_f32 v54, v54, v12
    v_sub_f32 v55, v55, v12
    v_sub_f32 v56, v56, v12
    v_sub_f32 v57, v57, v12
    v_sub_f32 v58, v58, v12
    v_sub_f32 v59, v59, v12
    v_sub_f32 v60, v60, v12
    v_sub_f32 v61, v61, v12
    v_sub_f32 v62, v62, v12
    v_sub_f32 v63, v63, v12
    v_exp_f32 v64, v32
    v_exp_f32 v65, v33
    v_exp_f32 v66, v34
    v_exp_f32 v67, v35
    v_exp_f32 v68, v36
    v_exp_f32 v69, v37
    v_exp_f32 v70, v38
    v_exp_f32 v71, v39
    v_exp_f32 v72, v40
    v_exp_f32 v73, v41
    v_exp_f32 v74, v42
    v_exp_f32 v75, v43
    v_exp_f32 v76, v44
    v_exp_f32 v77, v45
    v_exp_f32 v78, v46
    v_exp_f32 v79, v47
    v_cvt_pk_bf16_f32 v80, v64, v65
    v_cvt_pk_bf16_f32 v81, v66, v67
    v_cvt_pk_bf16_f32 v82, v68, v69
    v_cvt_pk_bf16_f32 v83, v70, v71
    v_cvt_pk_bf16_f32 v84, v72, v73
    v_cvt_pk_bf16_f32 v85, v74, v75
    v_cvt_pk_bf16_f32 v86, v76, v77
    v_cvt_pk_bf16_f32 v87, v78, v79
    s_branch L_attn_kernel_back2
L_attn_kernel_rare3:
    v_max3_f32 v12, v48, v49, v50
    v_max3_f32 v12, v12, v51, v52
    v_max3_f32 v12, v12, v53, v54
    v_max3_f32 v12, v12, v55, v56
    v_max3_f32 v12, v12, v57, v58
    v_max3_f32 v12, v12, v59, v60
    v_max3_f32 v12, v12, v61, v62
    v_max_f32 v12, v12, v63
    v_mov_b32 v13, v12
    s_nop 1
    v_permlane32_swap_b32 v12, v13
    v_max_f32 v12, v12, v13
    v_add_f32 v12, 0x41800000, v12
    v_max_f32 v12, 0, v12
    v_sub_f32 v13, 0, v12
    v_exp_f32 v13, v13
    v_sub_f32 v48, v48, v12
    v_sub_f32 v49, v49, v12
    v_sub_f32 v50, v50, v12
    v_sub_f32 v51, v51, v12
    v_sub_f32 v52, v52, v12
    v_sub_f32 v53, v53, v12
    v_sub_f32 v54, v54, v12
    v_sub_f32 v55, v55, v12
    v_sub_f32 v56, v56, v12
    v_sub_f32 v57, v57, v12
    v_sub_f32 v58, v58, v12
    v_sub_f32 v59, v59, v12
    v_sub_f32 v60, v60, v12
    v_sub_f32 v61, v61, v12
    v_sub_f32 v62, v62, v12
    v_sub_f32 v63, v63, v12
    v_sub_f32 v104, v104, v12
    v_sub_f32 v105, v105, v12
    v_sub_f32 v106, v106, v12
    v_sub_f32 v107, v107, v12
    v_sub_f32 v108, v108, v12
    v_sub_f32 v109, v109, v12
    v_sub_f32 v110, v110, v12
    v_sub_f32 v111, v111, v12
    v_sub_f32 v112, v112, v12
    v_sub_f32 v113, v113, v12
    v_sub_f32 v114, v114, v12
    v_sub_f32 v115, v115, v12
    v_sub_f32 v116, v116, v12
    v_sub_f32 v117, v117, v12
    v_sub_f32 v118, v118, v12
    v_sub_f32 v119, v119, v12
    v_mul_f32 v88, v88, v13
    v_mul_f32 v89, v89, v13
    v_mul_f32 v90, v90, v13
    v_mul_f32 v91, v91, v13
    v_mul_f32 v92, v92, v13
    v_mul_f32 v93, v93, v13
    v_mul_f32 v94, v94, v13
    v_mul_f32 v95, v95, v13
    v_mul_f32 v96, v96, v13
    v_mul_f32 v97, v97, v13
    v_mul_f32 v98, v98, v13
    v_mul_f32 v99, v99, v13
    v_mul_f32 v100, v100, v13
    v_mul_f32 v101, v101, v13
    v_mul_f32 v102, v102, v13
    v_mul_f32 v103, v103, v13
    v_sub_f32 v32, v32, v12
    v_sub_f32 v33, v33, v12
    v_sub_f32 v34, v34, v12
    v_sub_f32 v35, v35, v12
    v_sub_f32 v36, v36, v12
    v_sub_f32 v37, v37, v12
    v_sub_f32 v38, v38, v12
    v_sub_f32 v39, v39, v12
    v_sub_f32 v40, v40, v12
    v_sub_f32 v41, v41, v12
    v_sub_f32 v42, v42, v12
    v_sub_f32 v43, v43, v12
    v_sub_f32 v44, v44, v12
    v_sub_f32 v45, v45, v12
    v_sub_f32 v46, v46, v12
    v_sub_f32 v47, v47, v12
    v_exp_f32 v64, v48
    v_exp_f32 v65, v49
    v_exp_f32 v66, v50
    v_exp_f32 v67, v51
    v_exp_f32 v68, v52
    v_exp_f32 v69, v53
    v_exp_f32 v70, v54
    v_exp_f32 v71, v55
    v_exp_f32 v72, v56
    v_exp_f32 v73, v57
    v_exp_f32 v74, v58
    v_exp_f32 v75, v59
    v_exp_f32 v76, v60
    v_exp_f32 v77, v61
    v_exp_f32 v78, v62
    v_exp_f32 v79, v63
    v_cvt_pk_bf16_f32 v80, v64, v65
    v_cvt_pk_bf16_f32 v81, v66, v67
    v_cvt_pk_bf16_f32 v82, v68, v69
    v_cvt_pk_bf16_f32 v83, v70, v71
    v_cvt_pk_bf16_f32 v84, v72, v73
    v_cvt_pk_bf16_f32 v85, v74, v75
    v_cvt_pk_bf16_f32 v86, v76, v77
    v_cvt_pk_bf16_f32 v87, v78, v79
    s_branch L_attn_kernel_back3
L_attn_kernel_rare4:
    v_max3_f32 v12, v32, v33, v34
    v_max3_f32 v12, v12, v35, v36
    v_max3_f32 v12, v12, v37, v38
    v_max3_f32 v12, v12, v39, v40
    v_max3_f32 v12, v12, v41, v42
    v_max3_f32 v12, v12, v43, v44
    v_max3_f32 v12, v12, v45, v46
    v_max_f32 v12, v12, v47
    v_mov_b32 v13, v12
    s_nop 1
    v_permlane32_swap_b32 v12, v13
    v_max_f32 v12, v12, v13
    v_add_f32 v12, 0x41800000, v12
    v_max_f32 v12, 0, v12
    v_sub_f32 v13, 0, v12
    v_exp_f32 v13, v13
    v_sub_f32 v32, v32, v12
    v_sub_f32 v33, v33, v12
    v_sub_f32 v34, v34, v12
    v_sub_f32 v35, v35, v12
    v_sub_f32 v36, v36, v12
    v_sub_f32 v37, v37, v12
    v_sub_f32 v38, v38, v12
    v_sub_f32 v39, v39, v12
    v_sub_f32 v40, v40, v12
    v_sub_f32 v41, v41, v12
    v_sub_f32 v42, v42, v12
    v_sub_f32 v43, v43, v12
    v_sub_f32 v44, v44, v12
    v_sub_f32 v45, v45, v12
    v_sub_f32 v46, v46, v12
    v_sub_f32 v47, v47, v12
    v_sub_f32 v104, v104, v12
    v_sub_f32 v105, v105, v12
    v_sub_f32 v106, v106, v12
    v_sub_f32 v107, v107, v12
    v_sub_f32 v108, v108, v12
    v_sub_f32 v109, v109, v12
    v_sub_f32 v110, v110, v12
    v_sub_f32 v111, v111, v12
    v_sub_f32 v112, v112, v12
    v_sub_f32 v113, v113, v12
    v_sub_f32 v114, v114, v12
    v_sub_f32 v115, v115, v12
    v_sub_f32 v116, v116, v12
    v_sub_f32 v117, v117, v12
    v_sub_f32 v118, v118, v12
    v_sub_f32 v119, v119, v12
    v_mul_f32 v88, v88, v13
    v_mul_f32 v89, v89, v13
    v_mul_f32 v90, v90, v13
    v_mul_f32 v91, v91, v13
    v_mul_f32 v92, v92, v13
    v_mul_f32 v93, v93, v13
    v_mul_f32 v94, v94, v13
    v_mul_f32 v95, v95, v13
    v_mul_f32 v96, v96, v13
    v_mul_f32 v97, v97, v13
    v_mul_f32 v98, v98, v13
    v_mul_f32 v99, v99, v13
    v_mul_f32 v100, v100, v13
    v_mul_f32 v101, v101, v13
    v_mul_f32 v102, v102, v13
    v_mul_f32 v103, v103, v13
    v_sub_f32 v48, v48, v12
    v_sub_f32 v49, v49, v12
    v_sub_f32 v50, v50, v12
    v_sub_f32 v51, v51, v12
    v_sub_f32 v52, v52, v12
    v_sub_f32 v53, v53, v12
    v_sub_f32 v54, v54, v12
    v_sub_f32 v55, v55, v12
    v_sub_f32 v56, v56, v12
    v_sub_f32 v57, v57, v12
    v_sub_f32 v58, v58, v12
    v_sub_f32 v59, v59, v12
    v_sub_f32 v60, v60, v12
    v_sub_f32 v61, v61, v12
    v_sub_f32 v62, v62, v12
    v_sub_f32 v63, v63, v12
    v_exp_f32 v64, v32
    v_exp_f32 v65, v33
    v_exp_f32 v66, v34
    v_exp_f32 v67, v35
    v_exp_f32 v68, v36
    v_exp_f32 v69, v37
    v_exp_f32 v70, v38
    v_exp_f32 v71, v39
    v_exp_f32 v72, v40
    v_exp_f32 v73, v41
    v_exp_f32 v74, v42
    v_exp_f32 v75, v43
    v_exp_f32 v76, v44
    v_exp_f32 v77, v45
    v_exp_f32 v78, v46
    v_exp_f32 v79, v47
    v_cvt_pk_bf16_f32 v80, v64, v65
    v_cvt_pk_bf16_f32 v81, v66, v67
    v_cvt_pk_bf16_f32 v82, v68, v69
    v_cvt_pk_bf16_f32 v83, v70, v71
    v_cvt_pk_bf16_f32 v84, v72, v73
    v_cvt_pk_bf16_f32 v85, v74, v75
    v_cvt_pk_bf16_f32 v86, v76, v77
    v_cvt_pk_bf16_f32 v87, v78, v79
    s_branch L_attn_kernel_back4
L_attn_kernel_rare5:
    v_max3_f32 v12, v48, v49, v50
    v_max3_f32 v12, v12, v51, v52
    v_max3_f32 v12, v12, v53, v54
    v_max3_f32 v12, v12, v55, v56
    v_max3_f32 v12, v12, v57, v58
    v_max3_f32 v12, v12, v59, v60
    v_max3_f32 v12, v12, v61, v62
    v_max_f32 v12, v12, v63
    v_mov_b32 v13, v12
    s_nop 1
    v_permlane32_swap_b32 v12, v13
    v_max_f32 v12, v12, v13
    v_add_f32 v12, 0x41800000, v12
    v_max_f32 v12, 0, v12
    v_sub_f32 v13, 0, v12
    v_exp_f32 v13, v13
    v_sub_f32 v48, v48, v12
    v_sub_f32 v49, v49, v12
    v_sub_f32 v50, v50, v12
    v_sub_f32 v51, v51, v12
    v_sub_f32 v52, v52, v12
    v_sub_f32 v53, v53, v12
    v_sub_f32 v54, v54, v12
    v_sub_f32 v55, v55, v12
    v_sub_f32 v56, v56, v12
    v_sub_f32 v57, v57, v12
    v_sub_f32 v58, v58, v12
    v_sub_f32 v59, v59, v12
    v_sub_f32 v60, v60, v12
    v_sub_f32 v61, v61, v12
    v_sub_f32 v62, v62, v12
    v_sub_f32 v63, v63, v12
    v_sub_f32 v104, v104, v12
    v_sub_f32 v105, v105, v12
    v_sub_f32 v106, v106, v12
    v_sub_f32 v107, v107, v12
    v_sub_f32 v108, v108, v12
    v_sub_f32 v109, v109, v12
    v_sub_f32 v110, v110, v12
    v_sub_f32 v111, v111, v12
    v_sub_f32 v112, v112, v12
    v_sub_f32 v113, v113, v12
    v_sub_f32 v114, v114, v12
    v_sub_f32 v115, v115, v12
    v_sub_f32 v116, v116, v12
    v_sub_f32 v117, v117, v12
    v_sub_f32 v118, v118, v12
    v_sub_f32 v119, v119, v12
    v_mul_f32 v88, v88, v13
    v_mul_f32 v89, v89, v13
    v_mul_f32 v90, v90, v13
    v_mul_f32 v91, v91, v13
    v_mul_f32 v92, v92, v13
    v_mul_f32 v93, v93, v13
    v_mul_f32 v94, v94, v13
    v_mul_f32 v95, v95, v13
    v_mul_f32 v96, v96, v13
    v_mul_f32 v97, v97, v13
    v_mul_f32 v98, v98, v13
    v_mul_f32 v99, v99, v13
    v_mul_f32 v100, v100, v13
    v_mul_f32 v101, v101, v13
    v_mul_f32 v102, v102, v13
    v_mul_f32 v103, v103, v13
    v_sub_f32 v32, v32, v12
    v_sub_f32 v33, v33, v12
    v_sub_f32 v34, v34, v12
    v_sub_f32 v35, v35, v12
    v_sub_f32 v36, v36, v12
    v_sub_f32 v37, v37, v12
    v_sub_f32 v38, v38, v12
    v_sub_f32 v39, v39, v12
    v_sub_f32 v40, v40, v12
    v_sub_f32 v41, v41, v12
    v_sub_f32 v42, v42, v12
    v_sub_f32 v43, v43, v12
    v_sub_f32 v44, v44, v12
    v_sub_f32 v45, v45, v12
    v_sub_f32 v46, v46, v12
    v_sub_f32 v47, v47, v12
    v_exp_f32 v64, v48
    v_exp_f32 v65, v49
    v_exp_f32 v66, v50
    v_exp_f32 v67, v51
    v_exp_f32 v68, v52
    v_exp_f32 v69, v53
    v_exp_f32 v70, v54
    v_exp_f32 v71, v55
    v_exp_f32 v72, v56
    v_exp_f32 v73, v57
    v_exp_f32 v74, v58
    v_exp_f32 v75, v59
    v_exp_f32 v76, v60
    v_exp_f32 v77, v61
    v_exp_f32 v78, v62
    v_exp_f32 v79, v63
    v_cvt_pk_bf16_f32 v80, v64, v65
    v_cvt_pk_bf16_f32 v81, v66, v67
    v_cvt_pk_bf16_f32 v82, v68, v69
    v_cvt_pk_bf16_f32 v83, v70, v71
    v_cvt_pk_bf16_f32 v84, v72, v73
    v_cvt_pk_bf16_f32 v85, v74, v75
    v_cvt_pk_bf16_f32 v86, v76, v77
    v_cvt_pk_bf16_f32 v87, v78, v79
    s_branch L_attn_kernel_back5
L_attn_kernel_rare6:
    v_max3_f32 v12, v32, v33, v34
    v_max3_f32 v12, v12, v35, v36
    v_max3_f32 v12, v12, v37, v38
    v_max3_f32 v12, v12, v39, v40
    v_max3_f32 v12, v12, v41, v42
    v_max3_f32 v12, v12, v43, v44
    v_max3_f32 v12, v12, v45, v46
    v_max_f32 v12, v12, v47
    v_mov_b32 v13, v12
    s_nop 1
    v_permlane32_swap_b32 v12, v13
    v_max_f32 v12, v12, v13
    v_add_f32 v12, 0x41800000, v12
    v_max_f32 v12, 0, v12
    v_sub_f32 v13, 0, v12
    v_exp_f32 v13, v13
    v_sub_f32 v32, v32, v12
    v_sub_f32 v33, v33, v12
    v_sub_f32 v34, v34, v12
    v_sub_f32 v35, v35, v12
    v_sub_f32 v36, v36, v12
    v_sub_f32 v37, v37, v12
    v_sub_f32 v38, v38, v12
    v_sub_f32 v39, v39, v12
    v_sub_f32 v40, v40, v12
    v_sub_f32 v41, v41, v12
    v_sub_f32 v42, v42, v12
    v_sub_f32 v43, v43, v12
    v_sub_f32 v44, v44, v12
    v_sub_f32 v45, v45, v12
    v_sub_f32 v46, v46, v12
    v_sub_f32 v47, v47, v12
    v_sub_f32 v104, v104, v12
    v_sub_f32 v105, v105, v12
    v_sub_f32 v106, v106, v12
    v_sub_f32 v107, v107, v12
    v_sub_f32 v108, v108, v12
    v_sub_f32 v109, v109, v12
    v_sub_f32 v110, v110, v12
    v_sub_f32 v111, v111, v12
    v_sub_f32 v112, v112, v12
    v_sub_f32 v113, v113, v12
    v_sub_f32 v114, v114, v12
    v_sub_f32 v115, v115, v12
    v_sub_f32 v116, v116, v12
    v_sub_f32 v117, v117, v12
    v_sub_f32 v118, v118, v12
    v_sub_f32 v119, v119, v12
    v_mul_f32 v88, v88, v13
    v_mul_f32 v89, v89, v13
    v_mul_f32 v90, v90, v13
    v_mul_f32 v91, v91, v13
    v_mul_f32 v92, v92, v13
    v_mul_f32 v93, v93, v13
    v_mul_f32 v94, v94, v13
    v_mul_f32 v95, v95, v13
    v_mul_f32 v96, v96, v13
    v_mul_f32 v97, v97, v13
    v_mul_f32 v98, v98, v13
    v_mul_f32 v99, v99, v13
    v_mul_f32 v100, v100, v13
    v_mul_f32 v101, v101, v13
    v_mul_f32 v102, v102, v13
    v_mul_f32 v103, v103, v13
    v_sub_f32 v48, v48, v12
    v_sub_f32 v49, v49, v12
    v_sub_f32 v50, v50, v12
    v_sub_f32 v51, v51, v12
    v_sub_f32 v52, v52, v12
    v_sub_f32 v53, v53, v12
    v_sub_f32 v54, v54, v12
    v_sub_f32 v55, v55, v12
    v_sub_f32 v56, v56, v12
    v_sub_f32 v57, v57, v12
    v_sub_f32 v58, v58, v12
    v_sub_f32 v59, v59, v12
    v_sub_f32 v60, v60, v12
    v_sub_f32 v61, v61, v12
    v_sub_f32 v62, v62, v12
    v_sub_f32 v63, v63, v12
    v_exp_f32 v64, v32
    v_exp_f32 v65, v33
    v_exp_f32 v66, v34
    v_exp_f32 v67, v35
    v_exp_f32 v68, v36
    v_exp_f32 v69, v37
    v_exp_f32 v70, v38
    v_exp_f32 v71, v39
    v_exp_f32 v72, v40
    v_exp_f32 v73, v41
    v_exp_f32 v74, v42
    v_exp_f32 v75, v43
    v_exp_f32 v76, v44
    v_exp_f32 v77, v45
    v_exp_f32 v78, v46
    v_exp_f32 v79, v47
    v_cvt_pk_bf16_f32 v80, v64, v65
    v_cvt_pk_bf16_f32 v81, v66, v67
    v_cvt_pk_bf16_f32 v82, v68, v69
    v_cvt_pk_bf16_f32 v83, v70, v71
    v_cvt_pk_bf16_f32 v84, v72, v73
    v_cvt_pk_bf16_f32 v85, v74, v75
    v_cvt_pk_bf16_f32 v86, v76, v77
    v_cvt_pk_bf16_f32 v87, v78, v79
    s_branch L_attn_kernel_back6
L_attn_kernel_rare7:
    v_max3_f32 v12, v48, v49, v50
    v_max3_f32 v12, v12, v51, v52
    v_max3_f32 v12, v12, v53, v54
    v_max3_f32 v12, v12, v55, v56
    v_max3_f32 v12, v12, v57, v58
    v_max3_f32 v12, v12, v59, v60
    v_max3_f32 v12, v12, v61, v62
    v_max_f32 v12, v12, v63
    v_mov_b32 v13, v12
    s_nop 1
    v_permlane32_swap_b32 v12, v13
    v_max_f32 v12, v12, v13
    v_add_f32 v12, 0x41800000, v12
    v_max_f32 v12, 0, v12
    v_sub_f32 v13, 0, v12
    v_exp_f32 v13, v13
    v_sub_f32 v48, v48, v12
    v_sub_f32 v49, v49, v12
    v_sub_f32 v50, v50, v12
    v_sub_f32 v51, v51, v12
    v_sub_f32 v52, v52, v12
    v_sub_f32 v53, v53, v12
    v_sub_f32 v54, v54, v12
    v_sub_f32 v55, v55, v12
    v_sub_f32 v56, v56, v12
    v_sub_f32 v57, v57, v12
    v_sub_f32 v58, v58, v12
    v_sub_f32 v59, v59, v12
    v_sub_f32 v60, v60, v12
    v_sub_f32 v61, v61, v12
    v_sub_f32 v62, v62, v12
    v_sub_f32 v63, v63, v12
    v_sub_f32 v104, v104, v12
    v_sub_f32 v105, v105, v12
    v_sub_f32 v106, v106, v12
    v_sub_f32 v107, v107, v12
    v_sub_f32 v108, v108, v12
    v_sub_f32 v109, v109, v12
    v_sub_f32 v110, v110, v12
    v_sub_f32 v111, v111, v12
    v_sub_f32 v112, v112, v12
    v_sub_f32 v113, v113, v12
    v_sub_f32 v114, v114, v12
    v_sub_f32 v115, v115, v12
    v_sub_f32 v116, v116, v12
    v_sub_f32 v117, v117, v12
    v_sub_f32 v118, v118, v12
    v_sub_f32 v119, v119, v12
    v_mul_f32 v88, v88, v13
    v_mul_f32 v89, v89, v13
    v_mul_f32 v90, v90, v13
    v_mul_f32 v91, v91, v13
    v_mul_f32 v92, v92, v13
    v_mul_f32 v93, v93, v13
    v_mul_f32 v94, v94, v13
    v_mul_f32 v95, v95, v13
    v_mul_f32 v96, v96, v13
    v_mul_f32 v97, v97, v13
    v_mul_f32 v98, v98, v13
    v_mul_f32 v99, v99, v13
    v_mul_f32 v100, v100, v13
    v_mul_f32 v101, v101, v13
    v_mul_f32 v102, v102, v13
    v_mul_f32 v103, v103, v13
    v_sub_f32 v32, v32, v12
    v_sub_f32 v33, v33, v12
    v_sub_f32 v34, v34, v12
    v_sub_f32 v35, v35, v12
    v_sub_f32 v36, v36, v12
    v_sub_f32 v37, v37, v12
    v_sub_f32 v38, v38, v12
    v_sub_f32 v39, v39, v12
    v_sub_f32 v40, v40, v12
    v_sub_f32 v41, v41, v12
    v_sub_f32 v42, v42, v12
    v_sub_f32 v43, v43, v12
    v_sub_f32 v44, v44, v12
    v_sub_f32 v45, v45, v12
    v_sub_f32 v46, v46, v12
    v_sub_f32 v47, v47, v12
    v_exp_f32 v64, v48
    v_exp_f32 v65, v49
    v_exp_f32 v66, v50
    v_exp_f32 v67, v51
    v_exp_f32 v68, v52
    v_exp_f32 v69, v53
    v_exp_f32 v70, v54
    v_exp_f32 v71, v55
    v_exp_f32 v72, v56
    v_exp_f32 v73, v57
    v_exp_f32 v74, v58
    v_exp_f32 v75, v59
    v_exp_f32 v76, v60
    v_exp_f32 v77, v61
    v_exp_f32 v78, v62
    v_exp_f32 v79, v63
    v_cvt_pk_bf16_f32 v80, v64, v65
    v_cvt_pk_bf16_f32 v81, v66, v67
    v_cvt_pk_bf16_f32 v82, v68, v69
    v_cvt_pk_bf16_f32 v83, v70, v71
    v_cvt_pk_bf16_f32 v84, v72, v73
    v_cvt_pk_bf16_f32 v85, v74, v75
    v_cvt_pk_bf16_f32 v86, v76, v77
    v_cvt_pk_bf16_f32 v87, v78, v79
    s_branch L_attn_kernel_back7
L_attn_kernel_rare8:
    v_max3_f32 v12, v32, v33, v34
    v_max3_f32 v12, v12, v35, v36
    v_max3_f32 v12, v12, v37, v38
    v_max3_f32 v12, v12, v39, v40
    v_max3_f32 v12, v12, v41, v42
    v_max3_f32 v12, v12, v43, v44
    v_max3_f32 v12, v12, v45, v46
    v_max_f32 v12, v12, v47
    v_mov_b32 v13, v12
    s_nop 1
    v_permlane32_swap_b32 v12, v13
    v_max_f32 v12, v12, v13
    v_add_f32 v12, 0x41800000, v12
    v_max_f32 v12, 0, v12
    v_sub_f32 v13, 0, v12
    v_exp_f32 v13, v13
    v_sub_f32 v32, v32, v12
    v_sub_f32 v33, v33, v12
    v_sub_f32 v34, v34, v12
    v_sub_f32 v35, v35, v12
    v_sub_f32 v36, v36, v12
    v_sub_f32 v37, v37, v12
    v_sub_f32 v38, v38, v12
    v_sub_f32 v39, v39, v12
    v_sub_f32 v40, v40, v12
    v_sub_f32 v41, v41, v12
    v_sub_f32 v42, v42, v12
    v_sub_f32 v43, v43, v12
    v_sub_f32 v44, v44, v12
    v_sub_f32 v45, v45, v12
    v_sub_f32 v46, v46, v12
    v_sub_f32 v47, v47, v12
    v_sub_f32 v104, v104, v12
    v_sub_f32 v105, v105, v12
    v_sub_f32 v106, v106, v12
    v_sub_f32 v107, v107, v12
    v_sub_f32 v108, v108, v12
    v_sub_f32 v109, v109, v12
    v_sub_f32 v110, v110, v12
    v_sub_f32 v111, v111, v12
    v_sub_f32 v112, v112, v12
    v_sub_f32 v113, v113, v12
    v_sub_f32 v114, v114, v12
    v_sub_f32 v115, v115, v12
    v_sub_f32 v116, v116, v12
    v_sub_f32 v117, v117, v12
    v_sub_f32 v118, v118, v12
    v_sub_f32 v119, v119, v12
    v_mul_f32 v88, v88, v13
    v_mul_f32 v89, v89, v13
    v_mul_f32 v90, v90, v13
    v_mul_f32 v91, v91, v13
    v_mul_f32 v92, v92, v13
    v_mul_f32 v93, v93, v13
    v_mul_f32 v94, v94, v13
    v_mul_f32 v95, v95, v13
    v_mul_f32 v96, v96, v13
    v_mul_f32 v97, v97, v13
    v_mul_f32 v98, v98, v13
    v_mul_f32 v99, v99, v13
    v_mul_f32 v100, v100, v13
    v_mul_f32 v101, v101, v13
    v_mul_f32 v102, v102, v13
    v_mul_f32 v103, v103, v13
    v_sub_f32 v48, v48, v12
    v_sub_f32 v49, v49, v12
    v_sub_f32 v50, v50, v12
    v_sub_f32 v51, v51, v12
    v_sub_f32 v52, v52, v12
    v_sub_f32 v53, v53, v12
    v_sub_f32 v54, v54, v12
    v_sub_f32 v55, v55, v12
    v_sub_f32 v56, v56, v12
    v_sub_f32 v57, v57, v12
    v_sub_f32 v58, v58, v12
    v_sub_f32 v59, v59, v12
    v_sub_f32 v60, v60, v12
    v_sub_f32 v61, v61, v12
    v_sub_f32 v62, v62, v12
    v_sub_f32 v63, v63, v12
    v_exp_f32 v64, v32
    v_exp_f32 v65, v33
    v_exp_f32 v66, v34
    v_exp_f32 v67, v35
    v_exp_f32 v68, v36
    v_exp_f32 v69, v37
    v_exp_f32 v70, v38
    v_exp_f32 v71, v39
    v_exp_f32 v72, v40
    v_exp_f32 v73, v41
    v_exp_f32 v74, v42
    v_exp_f32 v75, v43
    v_exp_f32 v76, v44
    v_exp_f32 v77, v45
    v_exp_f32 v78, v46
    v_exp_f32 v79, v47
    v_cvt_pk_bf16_f32 v80, v64, v65
    v_cvt_pk_bf16_f32 v81, v66, v67
    v_cvt_pk_bf16_f32 v82, v68, v69
    v_cvt_pk_bf16_f32 v83, v70, v71
    v_cvt_pk_bf16_f32 v84, v72, v73
    v_cvt_pk_bf16_f32 v85, v74, v75
    v_cvt_pk_bf16_f32 v86, v76, v77
    v_cvt_pk_bf16_f32 v87, v78, v79
    s_branch L_attn_kernel_back8
L_attn_kernel_rare9:
    v_max3_f32 v12, v48, v49, v50
    v_max3_f32 v12, v12, v51, v52
    v_max3_f32 v12, v12, v53, v54
    v_max3_f32 v12, v12, v55, v56
    v_max3_f32 v12, v12, v57, v58
    v_max3_f32 v12, v12, v59, v60
    v_max3_f32 v12, v12, v61, v62
    v_max_f32 v12, v12, v63
    v_mov_b32 v13, v12
    s_nop 1
    v_permlane32_swap_b32 v12, v13
    v_max_f32 v12, v12, v13
    v_add_f32 v12, 0x41800000, v12
    v_max_f32 v12, 0, v12
    v_sub_f32 v13, 0, v12
    v_exp_f32 v13, v13
    v_sub_f32 v48, v48, v12
    v_sub_f32 v49, v49, v12
    v_sub_f32 v50, v50, v12
    v_sub_f32 v51, v51, v12
    v_sub_f32 v52, v52, v12
    v_sub_f32 v53, v53, v12
    v_sub_f32 v54, v54, v12
    v_sub_f32 v55, v55, v12
    v_sub_f32 v56, v56, v12
    v_sub_f32 v57, v57, v12
    v_sub_f32 v58, v58, v12
    v_sub_f32 v59, v59, v12
    v_sub_f32 v60, v60, v12
    v_sub_f32 v61, v61, v12
    v_sub_f32 v62, v62, v12
    v_sub_f32 v63, v63, v12
    v_sub_f32 v104, v104, v12
    v_sub_f32 v105, v105, v12
    v_sub_f32 v106, v106, v12
    v_sub_f32 v107, v107, v12
    v_sub_f32 v108, v108, v12
    v_sub_f32 v109, v109, v12
    v_sub_f32 v110, v110, v12
    v_sub_f32 v111, v111, v12
    v_sub_f32 v112, v112, v12
    v_sub_f32 v113, v113, v12
    v_sub_f32 v114, v114, v12
    v_sub_f32 v115, v115, v12
    v_sub_f32 v116, v116, v12
    v_sub_f32 v117, v117, v12
    v_sub_f32 v118, v118, v12
    v_sub_f32 v119, v119, v12
    v_mul_f32 v88, v88, v13
    v_mul_f32 v89, v89, v13
    v_mul_f32 v90, v90, v13
    v_mul_f32 v91, v91, v13
    v_mul_f32 v92, v92, v13
    v_mul_f32 v93, v93, v13
    v_mul_f32 v94, v94, v13
    v_mul_f32 v95, v95, v13
    v_mul_f32 v96, v96, v13
    v_mul_f32 v97, v97, v13
    v_mul_f32 v98, v98, v13
    v_mul_f32 v99, v99, v13
    v_mul_f32 v100, v100, v13
    v_mul_f32 v101, v101, v13
    v_mul_f32 v102, v102, v13
    v_mul_f32 v103, v103, v13
    v_sub_f32 v32, v32, v12
    v_sub_f32 v33, v33, v12
    v_sub_f32 v34, v34, v12
    v_sub_f32 v35, v35, v12
    v_sub_f32 v36, v36, v12
    v_sub_f32 v37, v37, v12
    v_sub_f32 v38, v38, v12
    v_sub_f32 v39, v39, v12
    v_sub_f32 v40, v40, v12
    v_sub_f32 v41, v41, v12
    v_sub_f32 v42, v42, v12
    v_sub_f32 v43, v43, v12
    v_sub_f32 v44, v44, v12
    v_sub_f32 v45, v45, v12
    v_sub_f32 v46, v46, v12
    v_sub_f32 v47, v47, v12
    v_exp_f32 v64, v48
    v_exp_f32 v65, v49
    v_exp_f32 v66, v50
    v_exp_f32 v67, v51
    v_exp_f32 v68, v52
    v_exp_f32 v69, v53
    v_exp_f32 v70, v54
    v_exp_f32 v71, v55
    v_exp_f32 v72, v56
    v_exp_f32 v73, v57
    v_exp_f32 v74, v58
    v_exp_f32 v75, v59
    v_exp_f32 v76, v60
    v_exp_f32 v77, v61
    v_exp_f32 v78, v62
    v_exp_f32 v79, v63
    v_cvt_pk_bf16_f32 v80, v64, v65
    v_cvt_pk_bf16_f32 v81, v66, v67
    v_cvt_pk_bf16_f32 v82, v68, v69
    v_cvt_pk_bf16_f32 v83, v70, v71
    v_cvt_pk_bf16_f32 v84, v72, v73
    v_cvt_pk_bf16_f32 v85, v74, v75
    v_cvt_pk_bf16_f32 v86, v76, v77
    v_cvt_pk_bf16_f32 v87, v78, v79
    s_branch L_attn_kernel_back9
L_attn_kernel_rare10:
    v_max3_f32 v12, v32, v33, v34
    v_max3_f32 v12, v12, v35, v36
    v_max3_f32 v12, v12, v37, v38
    v_max3_f32 v12, v12, v39, v40
    v_max3_f32 v12, v12, v41, v42
    v_max3_f32 v12, v12, v43, v44
    v_max3_f32 v12, v12, v45, v46
    v_max_f32 v12, v12, v47
    v_mov_b32 v13, v12
    s_nop 1
    v_permlane32_swap_b32 v12, v13
    v_max_f32 v12, v12, v13
    v_add_f32 v12, 0x41800000, v12
    v_max_f32 v12, 0, v12
    v_sub_f32 v13, 0, v12
    v_exp_f32 v13, v13
    v_sub_f32 v32, v32, v12
    v_sub_f32 v33, v33, v12
    v_sub_f32 v34, v34, v12
    v_sub_f32 v35, v35, v12
    v_sub_f32 v36, v36, v12
    v_sub_f32 v37, v37, v12
    v_sub_f32 v38, v38, v12
    v_sub_f32 v39, v39, v12
    v_sub_f32 v40, v40, v12
    v_sub_f32 v41, v41, v12
    v_sub_f32 v42, v42, v12
    v_sub_f32 v43, v43, v12
    v_sub_f32 v44, v44, v12
    v_sub_f32 v45, v45, v12
    v_sub_f32 v46, v46, v12
    v_sub_f32 v47, v47, v12
    v_sub_f32 v104, v104, v12
    v_sub_f32 v105, v105, v12
    v_sub_f32 v106, v106, v12
    v_sub_f32 v107, v107, v12
    v_sub_f32 v108, v108, v12
    v_sub_f32 v109, v109, v12
    v_sub_f32 v110, v110, v12
    v_sub_f32 v111, v111, v12
    v_sub_f32 v112, v112, v12
    v_sub_f32 v113, v113, v12
    v_sub_f32 v114, v114, v12
    v_sub_f32 v115, v115, v12
    v_sub_f32 v116, v116, v12
    v_sub_f32 v117, v117, v12
    v_sub_f32 v118, v118, v12
    v_sub_f32 v119, v119, v12
    v_mul_f32 v88, v88, v13
    v_mul_f32 v89, v89, v13
    v_mul_f32 v90, v90, v13
    v_mul_f32 v91, v91, v13
    v_mul_f32 v92, v92, v13
    v_mul_f32 v93, v93, v13
    v_mul_f32 v94, v94, v13
    v_mul_f32 v95, v95, v13
    v_mul_f32 v96, v96, v13
    v_mul_f32 v97, v97, v13
    v_mul_f32 v98, v98, v13
    v_mul_f32 v99, v99, v13
    v_mul_f32 v100, v100, v13
    v_mul_f32 v101, v101, v13
    v_mul_f32 v102, v102, v13
    v_mul_f32 v103, v103, v13
    v_sub_f32 v48, v48, v12
    v_sub_f32 v49, v49, v12
    v_sub_f32 v50, v50, v12
    v_sub_f32 v51, v51, v12
    v_sub_f32 v52, v52, v12
    v_sub_f32 v53, v53, v12
    v_sub_f32 v54, v54, v12
    v_sub_f32 v55, v55, v12
    v_sub_f32 v56, v56, v12
    v_sub_f32 v57, v57, v12
    v_sub_f32 v58, v58, v12
    v_sub_f32 v59, v59, v12
    v_sub_f32 v60, v60, v12
    v_sub_f32 v61, v61, v12
    v_sub_f32 v62, v62, v12
    v_sub_f32 v63, v63, v12
    v_exp_f32 v64, v32
    v_exp_f32 v65, v33
    v_exp_f32 v66, v34
    v_exp_f32 v67, v35
    v_exp_f32 v68, v36
    v_exp_f32 v69, v37
    v_exp_f32 v70, v38
    v_exp_f32 v71, v39
    v_exp_f32 v72, v40
    v_exp_f32 v73, v41
    v_exp_f32 v74, v42
    v_exp_f32 v75, v43
    v_exp_f32 v76, v44
    v_exp_f32 v77, v45
    v_exp_f32 v78, v46
    v_exp_f32 v79, v47
    v_cvt_pk_bf16_f32 v80, v64, v65
    v_cvt_pk_bf16_f32 v81, v66, v67
    v_cvt_pk_bf16_f32 v82, v68, v69
    v_cvt_pk_bf16_f32 v83, v70, v71
    v_cvt_pk_bf16_f32 v84, v72, v73
    v_cvt_pk_bf16_f32 v85, v74, v75
    v_cvt_pk_bf16_f32 v86, v76, v77
    v_cvt_pk_bf16_f32 v87, v78, v79
    s_branch L_attn_kernel_back10
L_attn_kernel_rare11:
    v_max3_f32 v12, v48, v49, v50
    v_max3_f32 v12, v12, v51, v52
    v_max3_f32 v12, v12, v53, v54
    v_max3_f32 v12, v12, v55, v56
    v_max3_f32 v12, v12, v57, v58
    v_max3_f32 v12, v12, v59, v60
    v_max3_f32 v12, v12, v61, v62
    v_max_f32 v12, v12, v63
    v_mov_b32 v13, v12
    s_nop 1
    v_permlane32_swap_b32 v12, v13
    v_max_f32 v12, v12, v13
    v_add_f32 v12, 0x41800000, v12
    v_max_f32 v12, 0, v12
    v_sub_f32 v13, 0, v12
    v_exp_f32 v13, v13
    v_sub_f32 v48, v48, v12
    v_sub_f32 v49, v49, v12
    v_sub_f32 v50, v50, v12
    v_sub_f32 v51, v51, v12
    v_sub_f32 v52, v52, v12
    v_sub_f32 v53, v53, v12
    v_sub_f32 v54, v54, v12
    v_sub_f32 v55, v55, v12
    v_sub_f32 v56, v56, v12
    v_sub_f32 v57, v57, v12
    v_sub_f32 v58, v58, v12
    v_sub_f32 v59, v59, v12
    v_sub_f32 v60, v60, v12
    v_sub_f32 v61, v61, v12
    v_sub_f32 v62, v62, v12
    v_sub_f32 v63, v63, v12
    v_sub_f32 v104, v104, v12
    v_sub_f32 v105, v105, v12
    v_sub_f32 v106, v106, v12
    v_sub_f32 v107, v107, v12
    v_sub_f32 v108, v108, v12
    v_sub_f32 v109, v109, v12
    v_sub_f32 v110, v110, v12
    v_sub_f32 v111, v111, v12
    v_sub_f32 v112, v112, v12
    v_sub_f32 v113, v113, v12
    v_sub_f32 v114, v114, v12
    v_sub_f32 v115, v115, v12
    v_sub_f32 v116, v116, v12
    v_sub_f32 v117, v117, v12
    v_sub_f32 v118, v118, v12
    v_sub_f32 v119, v119, v12
    v_mul_f32 v88, v88, v13
    v_mul_f32 v89, v89, v13
    v_mul_f32 v90, v90, v13
    v_mul_f32 v91, v91, v13
    v_mul_f32 v92, v92, v13
    v_mul_f32 v93, v93, v13
    v_mul_f32 v94, v94, v13
    v_mul_f32 v95, v95, v13
    v_mul_f32 v96, v96, v13
    v_mul_f32 v97, v97, v13
    v_mul_f32 v98, v98, v13
    v_mul_f32 v99, v99, v13
    v_mul_f32 v100, v100, v13
    v_mul_f32 v101, v101, v13
    v_mul_f32 v102, v102, v13
    v_mul_f32 v103, v103, v13
    v_sub_f32 v32, v32, v12
    v_sub_f32 v33, v33, v12
    v_sub_f32 v34, v34, v12
    v_sub_f32 v35, v35, v12
    v_sub_f32 v36, v36, v12
    v_sub_f32 v37, v37, v12
    v_sub_f32 v38, v38, v12
    v_sub_f32 v39, v39, v12
    v_sub_f32 v40, v40, v12
    v_sub_f32 v41, v41, v12
    v_sub_f32 v42, v42, v12
    v_sub_f32 v43, v43, v12
    v_sub_f32 v44, v44, v12
    v_sub_f32 v45, v45, v12
    v_sub_f32 v46, v46, v12
    v_sub_f32 v47, v47, v12
    v_exp_f32 v64, v48
    v_exp_f32 v65, v49
    v_exp_f32 v66, v50
    v_exp_f32 v67, v51
    v_exp_f32 v68, v52
    v_exp_f32 v69, v53
    v_exp_f32 v70, v54
    v_exp_f32 v71, v55
    v_exp_f32 v72, v56
    v_exp_f32 v73, v57
    v_exp_f32 v74, v58
    v_exp_f32 v75, v59
    v_exp_f32 v76, v60
    v_exp_f32 v77, v61
    v_exp_f32 v78, v62
    v_exp_f32 v79, v63
    v_cvt_pk_bf16_f32 v80, v64, v65
    v_cvt_pk_bf16_f32 v81, v66, v67
    v_cvt_pk_bf16_f32 v82, v68, v69
    v_cvt_pk_bf16_f32 v83, v70, v71
    v_cvt_pk_bf16_f32 v84, v72, v73
    v_cvt_pk_bf16_f32 v85, v74, v75
    v_cvt_pk_bf16_f32 v86, v76, v77
    v_cvt_pk_bf16_f32 v87, v78, v79
    s_branch L_attn_kernel_back11
L_attn_kernel_rare12:
    v_max3_f32 v12, v32, v33, v34
    v_max3_f32 v12, v12, v35, v36
    v_max3_f32 v12, v12, v37, v38
    v_max3_f32 v12, v12, v39, v40
    v_max3_f32 v12, v12, v41, v42
    v_max3_f32 v12, v12, v43, v44
    v_max3_f32 v12, v12, v45, v46
    v_max_f32 v12, v12, v47
    v_mov_b32 v13, v12
    s_nop 1
    v_permlane32_swap_b32 v12, v13
    v_max_f32 v12, v12, v13
    v_add_f32 v12, 0x41800000, v12
    v_max_f32 v12, 0, v12
    v_sub_f32 v13, 0, v12
    v_exp_f32 v13, v13
    v_sub_f32 v32, v32, v12
    v_sub_f32 v33, v33, v12
    v_sub_f32 v34, v34, v12
    v_sub_f32 v35, v35, v12
    v_sub_f32 v36, v36, v12
    v_sub_f32 v37, v37, v12
    v_sub_f32 v38, v38, v12
    v_sub_f32 v39, v39, v12
    v_sub_f32 v40, v40, v12
    v_sub_f32 v41, v41, v12
    v_sub_f32 v42, v42, v12
    v_sub_f32 v43, v43, v12
    v_sub_f32 v44, v44, v12
    v_sub_f32 v45, v45, v12
    v_sub_f32 v46, v46, v12
    v_sub_f32 v47, v47, v12
    v_sub_f32 v104, v104, v12
    v_sub_f32 v105, v105, v12
    v_sub_f32 v106, v106, v12
    v_sub_f32 v107, v107, v12
    v_sub_f32 v108, v108, v12
    v_sub_f32 v109, v109, v12
    v_sub_f32 v110, v110, v12
    v_sub_f32 v111, v111, v12
    v_sub_f32 v112, v112, v12
    v_sub_f32 v113, v113, v12
    v_sub_f32 v114, v114, v12
    v_sub_f32 v115, v115, v12
    v_sub_f32 v116, v116, v12
    v_sub_f32 v117, v117, v12
    v_sub_f32 v118, v118, v12
    v_sub_f32 v119, v119, v12
    v_mul_f32 v88, v88, v13
    v_mul_f32 v89, v89, v13
    v_mul_f32 v90, v90, v13
    v_mul_f32 v91, v91, v13
    v_mul_f32 v92, v92, v13
    v_mul_f32 v93, v93, v13
    v_mul_f32 v94, v94, v13
    v_mul_f32 v95, v95, v13
    v_mul_f32 v96, v96, v13
    v_mul_f32 v97, v97, v13
    v_mul_f32 v98, v98, v13
    v_mul_f32 v99, v99, v13
    v_mul_f32 v100, v100, v13
    v_mul_f32 v101, v101, v13
    v_mul_f32 v102, v102, v13
    v_mul_f32 v103, v103, v13
    v_sub_f32 v48, v48, v12
    v_sub_f32 v49, v49, v12
    v_sub_f32 v50, v50, v12
    v_sub_f32 v51, v51, v12
    v_sub_f32 v52, v52, v12
    v_sub_f32 v53, v53, v12
    v_sub_f32 v54, v54, v12
    v_sub_f32 v55, v55, v12
    v_sub_f32 v56, v56, v12
    v_sub_f32 v57, v57, v12
    v_sub_f32 v58, v58, v12
    v_sub_f32 v59, v59, v12
    v_sub_f32 v60, v60, v12
    v_sub_f32 v61, v61, v12
    v_sub_f32 v62, v62, v12
    v_sub_f32 v63, v63, v12
    v_exp_f32 v64, v32
    v_exp_f32 v65, v33
    v_exp_f32 v66, v34
    v_exp_f32 v67, v35
    v_exp_f32 v68, v36
    v_exp_f32 v69, v37
    v_exp_f32 v70, v38
    v_exp_f32 v71, v39
    v_exp_f32 v72, v40
    v_exp_f32 v73, v41
    v_exp_f32 v74, v42
    v_exp_f32 v75, v43
    v_exp_f32 v76, v44
    v_exp_f32 v77, v45
    v_exp_f32 v78, v46
    v_exp_f32 v79, v47
    v_cvt_pk_bf16_f32 v80, v64, v65
    v_cvt_pk_bf16_f32 v81, v66, v67
    v_cvt_pk_bf16_f32 v82, v68, v69
    v_cvt_pk_bf16_f32 v83, v70, v71
    v_cvt_pk_bf16_f32 v84, v72, v73
    v_cvt_pk_bf16_f32 v85, v74, v75
    v_cvt_pk_bf16_f32 v86, v76, v77
    v_cvt_pk_bf16_f32 v87, v78, v79
    s_branch L_attn_kernel_back12
L_attn_kernel_rare13:
    v_max3_f32 v12, v48, v49, v50
    v_max3_f32 v12, v12, v51, v52
    v_max3_f32 v12, v12, v53, v54
    v_max3_f32 v12, v12, v55, v56
    v_max3_f32 v12, v12, v57, v58
    v_max3_f32 v12, v12, v59, v60
    v_max3_f32 v12, v12, v61, v62
    v_max_f32 v12, v12, v63
    v_mov_b32 v13, v12
    s_nop 1
    v_permlane32_swap_b32 v12, v13
    v_max_f32 v12, v12, v13
    v_add_f32 v12, 0x41800000, v12
    v_max_f32 v12, 0, v12
    v_sub_f32 v13, 0, v12
    v_exp_f32 v13, v13
    v_sub_f32 v48, v48, v12
    v_sub_f32 v49, v49, v12
    v_sub_f32 v50, v50, v12
    v_sub_f32 v51, v51, v12
    v_sub_f32 v52, v52, v12
    v_sub_f32 v53, v53, v12
    v_sub_f32 v54, v54, v12
    v_sub_f32 v55, v55, v12
    v_sub_f32 v56, v56, v12
    v_sub_f32 v57, v57, v12
    v_sub_f32 v58, v58, v12
    v_sub_f32 v59, v59, v12
    v_sub_f32 v60, v60, v12
    v_sub_f32 v61, v61, v12
    v_sub_f32 v62, v62, v12
    v_sub_f32 v63, v63, v12
    v_sub_f32 v104, v104, v12
    v_sub_f32 v105, v105, v12
    v_sub_f32 v106, v106, v12
    v_sub_f32 v107, v107, v12
    v_sub_f32 v108, v108, v12
    v_sub_f32 v109, v109, v12
    v_sub_f32 v110, v110, v12
    v_sub_f32 v111, v111, v12
    v_sub_f32 v112, v112, v12
    v_sub_f32 v113, v113, v12
    v_sub_f32 v114, v114, v12
    v_sub_f32 v115, v115, v12
    v_sub_f32 v116, v116, v12
    v_sub_f32 v117, v117, v12
    v_sub_f32 v118, v118, v12
    v_sub_f32 v119, v119, v12
    v_mul_f32 v88, v88, v13
    v_mul_f32 v89, v89, v13
    v_mul_f32 v90, v90, v13
    v_mul_f32 v91, v91, v13
    v_mul_f32 v92, v92, v13
    v_mul_f32 v93, v93, v13
    v_mul_f32 v94, v94, v13
    v_mul_f32 v95, v95, v13
    v_mul_f32 v96, v96, v13
    v_mul_f32 v97, v97, v13
    v_mul_f32 v98, v98, v13
    v_mul_f32 v99, v99, v13
    v_mul_f32 v100, v100, v13
    v_mul_f32 v101, v101, v13
    v_mul_f32 v102, v102, v13
    v_mul_f32 v103, v103, v13
    v_sub_f32 v32, v32, v12
    v_sub_f32 v33, v33, v12
    v_sub_f32 v34, v34, v12
    v_sub_f32 v35, v35, v12
    v_sub_f32 v36, v36, v12
    v_sub_f32 v37, v37, v12
    v_sub_f32 v38, v38, v12
    v_sub_f32 v39, v39, v12
    v_sub_f32 v40, v40, v12
    v_sub_f32 v41, v41, v12
    v_sub_f32 v42, v42, v12
    v_sub_f32 v43, v43, v12
    v_sub_f32 v44, v44, v12
    v_sub_f32 v45, v45, v12
    v_sub_f32 v46, v46, v12
    v_sub_f32 v47, v47, v12
    v_exp_f32 v64, v48
    v_exp_f32 v65, v49
    v_exp_f32 v66, v50
    v_exp_f32 v67, v51
    v_exp_f32 v68, v52
    v_exp_f32 v69, v53
    v_exp_f32 v70, v54
    v_exp_f32 v71, v55
    v_exp_f32 v72, v56
    v_exp_f32 v73, v57
    v_exp_f32 v74, v58
    v_exp_f32 v75, v59
    v_exp_f32 v76, v60
    v_exp_f32 v77, v61
    v_exp_f32 v78, v62
    v_exp_f32 v79, v63
    v_cvt_pk_bf16_f32 v80, v64, v65
    v_cvt_pk_bf16_f32 v81, v66, v67
    v_cvt_pk_bf16_f32 v82, v68, v69
    v_cvt_pk_bf16_f32 v83, v70, v71
    v_cvt_pk_bf16_f32 v84, v72, v73
    v_cvt_pk_bf16_f32 v85, v74, v75
    v_cvt_pk_bf16_f32 v86, v76, v77
    v_cvt_pk_bf16_f32 v87, v78, v79
    s_branch L_attn_kernel_back13
L_attn_kernel_rare14:
    v_max3_f32 v12, v32, v33, v34
    v_max3_f32 v12, v12, v35, v36
    v_max3_f32 v12, v12, v37, v38
    v_max3_f32 v12, v12, v39, v40
    v_max3_f32 v12, v12, v41, v42
    v_max3_f32 v12, v12, v43, v44
    v_max3_f32 v12, v12, v45, v46
    v_max_f32 v12, v12, v47
    v_mov_b32 v13, v12
    s_nop 1
    v_permlane32_swap_b32 v12, v13
    v_max_f32 v12, v12, v13
    v_add_f32 v12, 0x41800000, v12
    v_max_f32 v12, 0, v12
    v_sub_f32 v13, 0, v12
    v_exp_f32 v13, v13
    v_sub_f32 v32, v32, v12
    v_sub_f32 v33, v33, v12
    v_sub_f32 v34, v34, v12
    v_sub_f32 v35, v35, v12
    v_sub_f32 v36, v36, v12
    v_sub_f32 v37, v37, v12
    v_sub_f32 v38, v38, v12
    v_sub_f32 v39, v39, v12
    v_sub_f32 v40, v40, v12
    v_sub_f32 v41, v41, v12
    v_sub_f32 v42, v42, v12
    v_sub_f32 v43, v43, v12
    v_sub_f32 v44, v44, v12
    v_sub_f32 v45, v45, v12
    v_sub_f32 v46, v46, v12
    v_sub_f32 v47, v47, v12
    v_sub_f32 v104, v104, v12
    v_sub_f32 v105, v105, v12
    v_sub_f32 v106, v106, v12
    v_sub_f32 v107, v107, v12
    v_sub_f32 v108, v108, v12
    v_sub_f32 v109, v109, v12
    v_sub_f32 v110, v110, v12
    v_sub_f32 v111, v111, v12
    v_sub_f32 v112, v112, v12
    v_sub_f32 v113, v113, v12
    v_sub_f32 v114, v114, v12
    v_sub_f32 v115, v115, v12
    v_sub_f32 v116, v116, v12
    v_sub_f32 v117, v117, v12
    v_sub_f32 v118, v118, v12
    v_sub_f32 v119, v119, v12
    v_mul_f32 v88, v88, v13
    v_mul_f32 v89, v89, v13
    v_mul_f32 v90, v90, v13
    v_mul_f32 v91, v91, v13
    v_mul_f32 v92, v92, v13
    v_mul_f32 v93, v93, v13
    v_mul_f32 v94, v94, v13
    v_mul_f32 v95, v95, v13
    v_mul_f32 v96, v96, v13
    v_mul_f32 v97, v97, v13
    v_mul_f32 v98, v98, v13
    v_mul_f32 v99, v99, v13
    v_mul_f32 v100, v100, v13
    v_mul_f32 v101, v101, v13
    v_mul_f32 v102, v102, v13
    v_mul_f32 v103, v103, v13
    v_sub_f32 v48, v48, v12
    v_sub_f32 v49, v49, v12
    v_sub_f32 v50, v50, v12
    v_sub_f32 v51, v51, v12
    v_sub_f32 v52, v52, v12
    v_sub_f32 v53, v53, v12
    v_sub_f32 v54, v54, v12
    v_sub_f32 v55, v55, v12
    v_sub_f32 v56, v56, v12
    v_sub_f32 v57, v57, v12
    v_sub_f32 v58, v58, v12
    v_sub_f32 v59, v59, v12
    v_sub_f32 v60, v60, v12
    v_sub_f32 v61, v61, v12
    v_sub_f32 v62, v62, v12
    v_sub_f32 v63, v63, v12
    v_exp_f32 v64, v32
    v_exp_f32 v65, v33
    v_exp_f32 v66, v34
    v_exp_f32 v67, v35
    v_exp_f32 v68, v36
    v_exp_f32 v69, v37
    v_exp_f32 v70, v38
    v_exp_f32 v71, v39
    v_exp_f32 v72, v40
    v_exp_f32 v73, v41
    v_exp_f32 v74, v42
    v_exp_f32 v75, v43
    v_exp_f32 v76, v44
    v_exp_f32 v77, v45
    v_exp_f32 v78, v46
    v_exp_f32 v79, v47
    v_cvt_pk_bf16_f32 v80, v64, v65
    v_cvt_pk_bf16_f32 v81, v66, v67
    v_cvt_pk_bf16_f32 v82, v68, v69
    v_cvt_pk_bf16_f32 v83, v70, v71
    v_cvt_pk_bf16_f32 v84, v72, v73
    v_cvt_pk_bf16_f32 v85, v74, v75
    v_cvt_pk_bf16_f32 v86, v76, v77
    v_cvt_pk_bf16_f32 v87, v78, v79
    s_branch L_attn_kernel_back14
L_attn_kernel_rare15:
    v_max3_f32 v12, v48, v49, v50
    v_max3_f32 v12, v12, v51, v52
    v_max3_f32 v12, v12, v53, v54
    v_max3_f32 v12, v12, v55, v56
    v_max3_f32 v12, v12, v57, v58
    v_max3_f32 v12, v12, v59, v60
    v_max3_f32 v12, v12, v61, v62
    v_max_f32 v12, v12, v63
    v_mov_b32 v13, v12
    s_nop 1
    v_permlane32_swap_b32 v12, v13
    v_max_f32 v12, v12, v13
    v_add_f32 v12, 0x41800000, v12
    v_max_f32 v12, 0, v12
    v_sub_f32 v13, 0, v12
    v_exp_f32 v13, v13
    v_sub_f32 v48, v48, v12
    v_sub_f32 v49, v49, v12
    v_sub_f32 v50, v50, v12
    v_sub_f32 v51, v51, v12
    v_sub_f32 v52, v52, v12
    v_sub_f32 v53, v53, v12
    v_sub_f32 v54, v54, v12
    v_sub_f32 v55, v55, v12
    v_sub_f32 v56, v56, v12
    v_sub_f32 v57, v57, v12
    v_sub_f32 v58, v58, v12
    v_sub_f32 v59, v59, v12
    v_sub_f32 v60, v60, v12
    v_sub_f32 v61, v61, v12
    v_sub_f32 v62, v62, v12
    v_sub_f32 v63, v63, v12
    v_sub_f32 v104, v104, v12
    v_sub_f32 v105, v105, v12
    v_sub_f32 v106, v106, v12
    v_sub_f32 v107, v107, v12
    v_sub_f32 v108, v108, v12
    v_sub_f32 v109, v109, v12
    v_sub_f32 v110, v110, v12
    v_sub_f32 v111, v111, v12
    v_sub_f32 v112, v112, v12
    v_sub_f32 v113, v113, v12
    v_sub_f32 v114, v114, v12
    v_sub_f32 v115, v115, v12
    v_sub_f32 v116, v116, v12
    v_sub_f32 v117, v117, v12
    v_sub_f32 v118, v118, v12
    v_sub_f32 v119, v119, v12
    v_mul_f32 v88, v88, v13
    v_mul_f32 v89, v89, v13
    v_mul_f32 v90, v90, v13
    v_mul_f32 v91, v91, v13
    v_mul_f32 v92, v92, v13
    v_mul_f32 v93, v93, v13
    v_mul_f32 v94, v94, v13
    v_mul_f32 v95, v95, v13
    v_mul_f32 v96, v96, v13
    v_mul_f32 v97, v97, v13
    v_mul_f32 v98, v98, v13
    v_mul_f32 v99, v99, v13
    v_mul_f32 v100, v100, v13
    v_mul_f32 v101, v101, v13
    v_mul_f32 v102, v102, v13
    v_mul_f32 v103, v103, v13
    v_sub_f32 v32, v32, v12
    v_sub_f32 v33, v33, v12
    v_sub_f32 v34, v34, v12
    v_sub_f32 v35, v35, v12
    v_sub_f32 v36, v36, v12
    v_sub_f32 v37, v37, v12
    v_sub_f32 v38, v38, v12
    v_sub_f32 v39, v39, v12
    v_sub_f32 v40, v40, v12
    v_sub_f32 v41, v41, v12
    v_sub_f32 v42, v42, v12
    v_sub_f32 v43, v43, v12
    v_sub_f32 v44, v44, v12
    v_sub_f32 v45, v45, v12
    v_sub_f32 v46, v46, v12
    v_sub_f32 v47, v47, v12
    v_exp_f32 v64, v48
    v_exp_f32 v65, v49
    v_exp_f32 v66, v50
    v_exp_f32 v67, v51
    v_exp_f32 v68, v52
    v_exp_f32 v69, v53
    v_exp_f32 v70, v54
    v_exp_f32 v71, v55
    v_exp_f32 v72, v56
    v_exp_f32 v73, v57
    v_exp_f32 v74, v58
    v_exp_f32 v75, v59
    v_exp_f32 v76, v60
    v_exp_f32 v77, v61
    v_exp_f32 v78, v62
    v_exp_f32 v79, v63
    v_cvt_pk_bf16_f32 v80, v64, v65
    v_cvt_pk_bf16_f32 v81, v66, v67
    v_cvt_pk_bf16_f32 v82, v68, v69
    v_cvt_pk_bf16_f32 v83, v70, v71
    v_cvt_pk_bf16_f32 v84, v72, v73
    v_cvt_pk_bf16_f32 v85, v74, v75
    v_cvt_pk_bf16_f32 v86, v76, v77
    v_cvt_pk_bf16_f32 v87, v78, v79
    s_branch L_attn_kernel_back15
.globl wo_kernel
.p2align 8
.type wo_kernel,@function
wo_kernel:
    s_cmp_ge_u32 s2, 192
    s_cbranch_scc1 L_wo_kernel_end
    s_load_dwordx16 s[64:79], s[0:1], 0
    s_load_dwordx4 s[80:83], s[0:1], 64
    s_load_dwordx2 s[84:85], s[0:1], 80
    s_waitcnt lgkmcnt(0)
    s_mov_b32 s8, s68
    s_and_b32 s9, s69, 0xffff
    s_mov_b32 s10, 663552
    s_mov_b32 s11, 0x20000
    s_add_u32 s12, s84, 7208960
    s_addc_u32 s13, s85, 0
    s_and_b32 s13, s13, 0xffff
    s_mov_b32 s14, 2359296
    s_mov_b32 s15, 0x20000
    s_and_b32 s31, s2, 7
    s_lshr_b32 s32, s2, 3
    s_mov_b32 s33, 0x55555556
    s_mul_hi_u32 s33, s32, s33
    s_mul_i32 s34, s33, 3
    s_sub_u32 s32, s32, s34
    s_and_b32 s34, s31, 1
    s_mul_i32 s34, s34, 3
    s_add_u32 s32, s32, s34
    s_lshr_b32 s34, s31, 1
    s_lshl_b32 s34, s34, 3
    s_add_u32 s33, s33, s34
    s_mul_i32 s36, s32, 192
    s_mul_i32 s37, s33, 128
    s_mov_b32 s52, 4096
    s_lshl_b32 s53, s52, 6
    v_lshrrev_b32 v1, 6, v0
    v_and_b32 v2, 63, v0
    v_readfirstlane_b32 s38, v1
    s_lshr_b32 s55, s38, 2
    s_and_b32 s38, s38, 3
    s_cmp_eq_u32 s55, 0
    s_cbranch_scc1 L_wo_kernel_comp
    s_and_b32 s39, s38, 1
    s_lshr_b32 s40, s38, 1
    s_mul_i32 s34, s38, 3072
    s_mul_i32 s35, s38, 2048
    s_add_u32 s35, s35, 12288
    s_mul_i32 s42, s38, 192
    s_add_u32 s42, s42, 0
    v_add_u32 v6, s42, v2
    v_mul_u32_u24 v7, 0xAAAB, v6
    v_lshrrev_b32 v7, 19, v7
    v_mul_u32_u24 v8, 12, v7
    v_sub_u32 v8, v6, v8
    v_lshrrev_b32 v9, 1, v7
    v_and_b32 v9, 2, v9
    v_xor_b32 v8, v8, v9
    v_mul_u32_u24 v7, 1152, v7
    v_lshl_add_u32 v7, v8, 4, v7
    s_sub_u32 s42, s36, 0
    v_add_u32 v16, s42, v7
    s_mul_i32 s42, s38, 192
    s_add_u32 s42, s42, 64
    v_add_u32 v6, s42, v2
    v_mul_u32_u24 v7, 0xAAAB, v6
    v_lshrrev_b32 v7, 19, v7
    v_mul_u32_u24 v8, 12, v7
    v_sub_u32 v8, v6, v8
    v_lshrrev_b32 v9, 1, v7
    v_and_b32 v9, 2, v9
    v_xor_b32 v8, v8, v9
    v_mul_u32_u24 v7, 1152, v7
    v_lshl_add_u32 v7, v8, 4, v7
    s_sub_u32 s42, s36, 1024
    v_add_u32 v17, s42, v7
    s_mul_i32 s42, s38, 192
    s_add_u32 s42, s42, 128
    v_add_u32 v6, s42, v2
    v_mul_u32_u24 v7, 0xAAAB, v6
    v_lshrrev_b32 v7, 19, v7
    v_mul_u32_u24 v8, 12, v7
    v_sub_u32 v8, v6, v8
    v_lshrrev_b32 v9, 1, v7
    v_and_b32 v9, 2, v9
    v_xor_b32 v8, v8, v9
    v_mul_u32_u24 v7, 1152, v7
    v_lshl_add_u32 v7, v8, 4, v7
    s_sub_u32 s42, s36, 2048
    v_add_u32 v18, s42, v7
    s_mov_b32 s43, s52
    s_lshl_b32 s42, s38, 4
    s_add_u32 s42, s42, 0
    v_lshrrev_b32 v6, 3, v2
    v_add_u32 v6, s42, v6
    v_and_b32 v7, 6, v6
    v_and_b32 v8, 7, v2
    v_xor_b32 v8, v8, v7
    v_mul_lo_u32 v6, v6, s43
    v_lshl_add_u32 v6, v8, 4, v6
    s_sub_u32 s42, s37, 0
    v_add_u32 v19, s42, v6
    s_lshl_b32 s42, s38, 4
    s_add_u32 s42, s42, 8
    v_lshrrev_b32 v6, 3, v2
    v_add_u32 v6, s42, v6
    v_and_b32 v7, 6, v6
    v_and_b32 v8, 7, v2
    v_xor_b32 v8, v8, v7
    v_mul_lo_u32 v6, v6, s43
    v_lshl_add_u32 v6, v8, 4, v6
    s_sub_u32 s42, s37, 1024
    v_add_u32 v20, s42, v6
    s_mov_b32 s28, 0
    s_mov_b32 s29, 0
    s_add_u32 m0, s34, 0
    s_nop 0
    buffer_load_dwordx4 v16, s[8:11], s28 offen offset:0 lds
    buffer_load_dwordx4 v17, s[8:11], s28 offen offset:1024 lds
    buffer_load_dwordx4 v18, s[8:11], s28 offen offset:2048 lds
    s_add_u32 m0, s35, 0
    s_nop 0
    buffer_load_dwordx4 v19, s[12:15], s29 offen offset:0 lds
    buffer_load_dwordx4 v20, s[12:15], s29 offen offset:1024 lds
    s_add_u32 s28, s28, 73728
    s_add_u32 s29, s29, s53
    s_add_u32 m0, s34, 20480
    s_nop 0
    buffer_load_dwordx4 v16, s[8:11], s28 offen offset:0 lds
    buffer_load_dwordx4 v17, s[8:11], s28 offen offset:1024 lds
    buffer_load_dwordx4 v18, s[8:11], s28 offen offset:2048 lds
    s_add_u32 m0, s35, 20480
    s_nop 0
    buffer_load_dwordx4 v19, s[12:15], s29 offen offset:0 lds
    buffer_load_dwordx4 v20, s[12:15], s29 offen offset:1024 lds
    s_add_u32 s28, s28, 73728
    s_add_u32 s29, s29, s53
    s_waitcnt vmcnt(5)
    s_barrier
    s_add_u32 m0, s34, 40960
    s_nop 0
    buffer_load_dwordx4 v16, s[8:11], s28 offen offset:0 lds
    buffer_load_dwordx4 v17, s[8:11], s28 offen offset:1024 lds
    buffer_load_dwordx4 v18, s[8:11], s28 offen offset:2048 lds
    s_add_u32 m0, s35, 40960
    s_nop 0
    buffer_load_dwordx4 v19, s[12:15], s29 offen offset:0 lds
    buffer_load_dwordx4 v20, s[12:15], s29 offen offset:1024 lds
    s_add_u32 s28, s28, 73728
    s_add_u32 s29, s29, s53
    s_add_u32 m0, s34, 61440
    s_nop 0
    buffer_load_dwordx4 v16, s[8:11], s28 offen offset:0 lds
    buffer_load_dwordx4 v17, s[8:11], s28 offen offset:1024 lds
    buffer_load_dwordx4 v18, s[8:11], s28 offen offset:2048 lds
    s_add_u32 m0, s35, 61440
    s_nop 0
    buffer_load_dwordx4 v19, s[12:15], s29 offen offset:0 lds
    buffer_load_dwordx4 v20, s[12:15], s29 offen offset:1024 lds
    s_add_u32 s28, s28, 73728
    s_add_u32 s29, s29, s53
    s_waitcnt vmcnt(10)
    s_barrier
    s_add_u32 m0, s34, 81920
    s_nop 0
    buffer_load_dwordx4 v16, s[8:11], s28 offen offset:0 lds
    buffer_load_dwordx4 v17, s[8:11], s28 offen offset:1024 lds
    buffer_load_dwordx4 v18, s[8:11], s28 offen offset:2048 lds
    s_add_u32 m0, s35, 81920
    s_nop 0
    buffer_load_dwordx4 v19, s[12:15], s29 offen offset:0 lds
    buffer_load_dwordx4 v20, s[12:15], s29 offen offset:1024 lds
    s_add_u32 s28, s28, 73728
    s_add_u32 s29, s29, s53
    s_add_u32 m0, s34, 102400
    s_nop 0
    buffer_load_dwordx4 v16, s[8:11], s28 offen offset:0 lds
    buffer_load_dwordx4 v17, s[8:11], s28 offen offset:1024 lds
    buffer_load_dwordx4 v18, s[8:11], s28 offen offset:2048 lds
    s_add_u32 m0, s35, 102400
    s_nop 0
    buffer_load_dwordx4 v19, s[12:15], s29 offen offset:0 lds
    buffer_load_dwordx4 v20, s[12:15], s29 offen offset:1024 lds
    s_add_u32 s28, s28, 73728
    s_add_u32 s29, s29, s53
    s_waitcnt vmcnt(15)
    s_barrier
    s_add_u32 m0, s34, 122880
    s_nop 0
    buffer_load_dwordx4 v16, s[8:11], s28 offen offset:0 lds
    buffer_load_dwordx4 v17, s[8:11], s28 offen offset:1024 lds
    buffer_load_dwordx4 v18, s[8:11], s28 offen offset:2048 lds
    s_add_u32 m0, s35, 122880
    s_nop 0
    buffer_load_dwordx4 v19, s[12:15], s29 offen offset:0 lds
    buffer_load_dwordx4 v20, s[12:15], s29 offen offset:1024 lds
    s_add_u32 s28, s28, 73728
    s_add_u32 s29, s29, s53
    s_add_u32 m0, s34, 143360
    s_nop 0
    buffer_load_dwordx4 v16, s[8:11], s28 offen offset:0 lds
    buffer_load_dwordx4 v17, s[8:11], s28 offen offset:1024 lds
    buffer_load_dwordx4 v18, s[8:11], s28 offen offset:2048 lds
    s_add_u32 m0, s35, 143360
    s_nop 0
    buffer_load_dwordx4 v19, s[12:15], s29 offen offset:0 lds
    buffer_load_dwordx4 v20, s[12:15], s29 offen offset:1024 lds
    s_add_u32 s28, s28, 73728
    s_add_u32 s29, s29, s53
    s_waitcnt vmcnt(20)
    s_barrier
    s_add_u32 m0, s34, 0
    s_nop 0
    buffer_load_dwordx4 v16, s[8:11], s28 offen offset:0 lds
    buffer_load_dwordx4 v17, s[8:11], s28 offen offset:1024 lds
    buffer_load_dwordx4 v18, s[8:11], s28 offen offset:2048 lds
    s_add_u32 m0, s35, 0
    s_nop 0
    buffer_load_dwordx4 v19, s[12:15], s29 offen offset:0 lds
    buffer_load_dwordx4 v20, s[12:15], s29 offen offset:1024 lds
    s_add_u32 s28, s28, 73728
    s_add_u32 s29, s29, s53
    s_waitcnt vmcnt(20)
    s_barrier
    s_waitcnt vmcnt(15)
    s_barrier
    s_waitcnt vmcnt(10)
    s_barrier
    s_waitcnt vmcnt(5)
    s_barrier
    s_waitcnt vmcnt(0)
    s_barrier
    s_endpgm
L_wo_kernel_comp:
    s_and_b32 s39, s38, 1
    s_lshr_b32 s40, s38, 1
    s_add_u32 s16, s84, 9568256
    s_addc_u32 s17, s85, 0
    s_and_b32 s17, s17, 0xffff
    s_mov_b32 s18, 2359296
    s_mov_b32 s19, 0x20000
    s_mov_b32 s20, s64
    s_and_b32 s21, s65, 0xffff
    s_mov_b32 s22, 2359296
    s_mov_b32 s23, 0x20000
    v_and_b32 v3, 15, v2
    v_lshrrev_b32 v4, 4, v2
    s_mul_i32 s41, s33, 64
    s_mul_i32 s42, s40, 32
    s_add_u32 s41, s41, s42
    v_add_u32 v5, s41, v3
    s_mul_i32 s42, s39, 96
    v_lshl_add_u32 v6, v4, 3, s42
    v_mul_u32_u24 v143, 1152, v5
    s_mul_i32 s42, s32, 192
    v_add3_u32 v143, v143, v6, s42
    v_mov_b32 v142, v143
    s_mov_b32 s44, 0
    s_mov_b32 s48, 0
    s_mov_b32 s45, 18432
    s_mov_b32 s49, 18432
    buffer_load_dwordx2 v[128:129], v143, s[20:23], s44 offen offset:0
    buffer_load_dwordx2 v[130:131], v143, s[20:23], s44 offen offset:32
    buffer_load_dwordx2 v[132:133], v143, s[20:23], s44 offen offset:64
    buffer_load_dwordx2 v[134:135], v143, s[20:23], s45 offen offset:0
    buffer_load_dwordx2 v[136:137], v143, s[20:23], s45 offen offset:32
    buffer_load_dwordx2 v[138:139], v143, s[20:23], s45 offen offset:64
    v_lshrrev_b32 v5, 2, v2
    v_and_b32 v5, 3, v5
    v_lshl_add_u32 v6, v4, 2, v5
    v_and_b32 v7, 3, v2
    v_lshlrev_b32 v7, 3, v7
    v_and_b32 v8, 1, v4
    v_mul_u32_u24 v9, 192, v6
    v_add_u32 v9, v9, v7
    s_mul_i32 s42, s39, 3
    s_add_u32 s43, s42, 0
    v_xor_b32 v10, s43, v8
    v_lshl_add_u32 v21, v10, 5, v9
    v_add_u32 v24, 20480, v21
    v_add_u32 v27, 40960, v21
    v_add_u32 v30, 61440, v21
    v_add_u32 v33, 81920, v21
    v_add_u32 v36, 102400, v21
    v_add_u32 v39, 122880, v21
    v_add_u32 v42, 143360, v21
    s_add_u32 s43, s42, 1
    v_xor_b32 v10, s43, v8
    v_lshl_add_u32 v22, v10, 5, v9
    v_add_u32 v25, 20480, v22
    v_add_u32 v28, 40960, v22
    v_add_u32 v31, 61440, v22
    v_add_u32 v34, 81920, v22
    v_add_u32 v37, 102400, v22
    v_add_u32 v40, 122880, v22
    v_add_u32 v43, 143360, v22
    s_add_u32 s43, s42, 2
    v_xor_b32 v10, s43, v8
    v_lshl_add_u32 v23, v10, 5, v9
    v_add_u32 v26, 20480, v23
    v_add_u32 v29, 40960, v23
    v_add_u32 v32, 61440, v23
    v_add_u32 v35, 81920, v23
    v_add_u32 v38, 102400, v23
    v_add_u32 v41, 122880, v23
    v_add_u32 v44, 143360, v23
    v_mul_u32_u24 v9, 128, v6
    v_add_u32 v9, v9, v7
    v_add_u32 v9, 12288, v9
    v_lshrrev_b32 v11, 1, v6
    v_and_b32 v11, 3, v11
    s_mul_i32 s42, s40, 2
    s_add_u32 s43, s42, 0
    v_xor_b32 v10, s43, v11
    v_lshl_add_u32 v45, v10, 5, v9
    v_add_u32 v47, 20480, v45
    v_add_u32 v49, 40960, v45
    v_add_u32 v51, 61440, v45
    v_add_u32 v53, 81920, v45
    v_add_u32 v55, 102400, v45
    v_add_u32 v57, 122880, v45
    v_add_u32 v59, 143360, v45
    s_add_u32 s43, s42, 1
    v_xor_b32 v10, s43, v11
    v_lshl_add_u32 v46, v10, 5, v9
    v_add_u32 v48, 20480, v46
    v_add_u32 v50, 40960, v46
    v_add_u32 v52, 61440, v46
    v_add_u32 v54, 81920, v46
    v_add_u32 v56, 102400, v46
    v_add_u32 v58, 122880, v46
    v_add_u32 v60, 143360, v46
    v_mov_b32 v104, 0
    v_mov_b32 v105, 0
    v_mov_b32 v106, 0
    v_mov_b32 v107, 0
    v_mov_b32 v108, 0
    v_mov_b32 v109, 0
    v_mov_b32 v110, 0
    v_mov_b32 v111, 0
    v_mov_b32 v112, 0
    v_mov_b32 v113, 0
    v_mov_b32 v114, 0
    v_mov_b32 v115, 0
    v_mov_b32 v116, 0
    v_mov_b32 v117, 0
    v_mov_b32 v118, 0
    v_mov_b32 v119, 0
    v_mov_b32 v120, 0
    v_mov_b32 v121, 0
    v_mov_b32 v122, 0
    v_mov_b32 v123, 0
    v_mov_b32 v124, 0
    v_mov_b32 v125, 0
    v_mov_b32 v126, 0
    v_mov_b32 v127, 0
    s_barrier
    ds_read_b64_tr_b16 v[64:65], v21 offset:0
    ds_read_b64_tr_b16 v[66:67], v21 offset:3072
    ds_read_b64_tr_b16 v[76:77], v45 offset:0
    ds_read_b64_tr_b16 v[78:79], v45 offset:2048
    ds_read_b64_tr_b16 v[68:69], v22 offset:0
    ds_read_b64_tr_b16 v[70:71], v22 offset:3072
    ds_read_b64_tr_b16 v[72:73], v23 offset:0
    ds_read_b64_tr_b16 v[74:75], v23 offset:3072
    ds_read_b64_tr_b16 v[80:81], v46 offset:0
    ds_read_b64_tr_b16 v[82:83], v46 offset:2048
    s_waitcnt lgkmcnt(6)
    v_mfma_f32_16x16x32_bf16 v[104:107], v[64:67], v[76:79], v[104:107]
    ds_read_b64_tr_b16 v[84:85], v21 offset:6144
    ds_read_b64_tr_b16 v[86:87], v21 offset:9216
    s_waitcnt lgkmcnt(6)
    v_mfma_f32_16x16x32_bf16 v[108:111], v[68:71], v[76:79], v[108:111]
    ds_read_b64_tr_b16 v[96:97], v45 offset:4096
    ds_read_b64_tr_b16 v[98:99], v45 offset:6144
    s_waitcnt lgkmcnt(6)
    v_mfma_f32_16x16x32_bf16 v[112:115], v[72:75], v[76:79], v[112:115]
    ds_read_b64_tr_b16 v[88:89], v22 offset:6144
    ds_read_b64_tr_b16 v[90:91], v22 offset:9216
    s_waitcnt lgkmcnt(6)
    v_mfma_f32_16x16x32_bf16 v[116:119], v[64:67], v[80:83], v[116:119]
    ds_read_b64_tr_b16 v[92:93], v23 offset:6144
    ds_read_b64_tr_b16 v[94:95], v23 offset:9216
    v_mfma_f32_16x16x32_bf16 v[120:123], v[68:71], v[80:83], v[120:123]
    ds_read_b64_tr_b16 v[100:101], v46 offset:4096
    v_mfma_f32_16x16x32_bf16 v[124:127], v[72:75], v[80:83], v[124:127]
    ds_read_b64_tr_b16 v[102:103], v46 offset:6144
    s_barrier
    s_waitcnt lgkmcnt(6)
    v_mfma_f32_16x16x32_bf16 v[104:107], v[84:87], v[96:99], v[104:107]
    ds_read_b64_tr_b16 v[64:65], v24 offset:0
    ds_read_b64_tr_b16 v[66:67], v24 offset:3072
    s_waitcnt lgkmcnt(6)
    v_mfma_f32_16x16x32_bf16 v[108:111], v[88:91], v[96:99], v[108:111]
    ds_read_b64_tr_b16 v[76:77], v47 offset:0
    ds_read_b64_tr_b16 v[78:79], v47 offset:2048
    s_waitcnt lgkmcnt(6)
    v_mfma_f32_16x16x32_bf16 v[112:115], v[92:95], v[96:99], v[112:115]
    ds_read_b64_tr_b16 v[68:69], v25 offset:0
    ds_read_b64_tr_b16 v[70:71], v25 offset:3072
    s_waitcnt lgkmcnt(6)
    v_mfma_f32_16x16x32_bf16 v[116:119], v[84:87], v[100:103], v[116:119]
    ds_read_b64_tr_b16 v[72:73], v26 offset:0
    ds_read_b64_tr_b16 v[74:75], v26 offset:3072
    v_mfma_f32_16x16x32_bf16 v[120:123], v[88:91], v[100:103], v[120:123]
    ds_read_b64_tr_b16 v[80:81], v48 offset:0
    v_mfma_f32_16x16x32_bf16 v[124:127], v[92:95], v[100:103], v[124:127]
    ds_read_b64_tr_b16 v[82:83], v48 offset:2048
    s_waitcnt lgkmcnt(6)
    v_mfma_f32_16x16x32_bf16 v[104:107], v[64:67], v[76:79], v[104:107]
    ds_read_b64_tr_b16 v[84:85], v24 offset:6144
    ds_read_b64_tr_b16 v[86:87], v24 offset:9216
    s_waitcnt lgkmcnt(6)
    v_mfma_f32_16x16x32_bf16 v[108:111], v[68:71], v[76:79], v[108:111]
    ds_read_b64_tr_b16 v[96:97], v47 offset:4096
    ds_read_b64_tr_b16 v[98:99], v47 offset:6144
    s_waitcnt lgkmcnt(6)
    v_mfma_f32_16x16x32_bf16 v[112:115], v[72:75], v[76:79], v[112:115]
    ds_read_b64_tr_b16 v[88:89], v25 offset:6144
    ds_read_b64_tr_b16 v[90:91], v25 offset:9216
    s_waitcnt lgkmcnt(6)
    v_mfma_f32_16x16x32_bf16 v[116:119], v[64:67], v[80:83], v[116:119]
    ds_read_b64_tr_b16 v[92:93], v26 offset:6144
    ds_read_b64_tr_b16 v[94:95], v26 offset:9216
    v_mfma_f32_16x16x32_bf16 v[120:123], v[68:71], v[80:83], v[120:123]
    ds_read_b64_tr_b16 v[100:101], v48 offset:4096
    v_mfma_f32_16x16x32_bf16 v[124:127], v[72:75], v[80:83], v[124:127]
    ds_read_b64_tr_b16 v[102:103], v48 offset:6144
    s_barrier
    s_waitcnt lgkmcnt(6)
    v_mfma_f32_16x16x32_bf16 v[104:107], v[84:87], v[96:99], v[104:107]
    ds_read_b64_tr_b16 v[64:65], v27 offset:0
    ds_read_b64_tr_b16 v[66:67], v27 offset:3072
    s_waitcnt lgkmcnt(6)
    v_mfma_f32_16x16x32_bf16 v[108:111], v[88:91], v[96:99], v[108:111]
    ds_read_b64_tr_b16 v[76:77], v49 offset:0
    ds_read_b64_tr_b16 v[78:79], v49 offset:2048
    s_waitcnt lgkmcnt(6)
    v_mfma_f32_16x16x32_bf16 v[112:115], v[92:95], v[96:99], v[112:115]
    ds_read_b64_tr_b16 v[68:69], v28 offset:0
    ds_read_b64_tr_b16 v[70:71], v28 offset:3072
    s_waitcnt lgkmcnt(6)
    v_mfma_f32_16x16x32_bf16 v[116:119], v[84:87], v[100:103], v[116:119]
    ds_read_b64_tr_b16 v[72:73], v29 offset:0
    ds_read_b64_tr_b16 v[74:75], v29 offset:3072
    v_mfma_f32_16x16x32_bf16 v[120:123], v[88:91], v[100:103], v[120:123]
    ds_read_b64_tr_b16 v[80:81], v50 offset:0
    v_mfma_f32_16x16x32_bf16 v[124:127], v[92:95], v[100:103], v[124:127]
    ds_read_b64_tr_b16 v[82:83], v50 offset:2048
    s_waitcnt lgkmcnt(6)
    v_mfma_f32_16x16x32_bf16 v[104:107], v[64:67], v[76:79], v[104:107]
    ds_read_b64_tr_b16 v[84:85], v27 offset:6144
    ds_read_b64_tr_b16 v[86:87], v27 offset:9216
    s_waitcnt lgkmcnt(6)
    v_mfma_f32_16x16x32_bf16 v[108:111], v[68:71], v[76:79], v[108:111]
    ds_read_b64_tr_b16 v[96:97], v49 offset:4096
    ds_read_b64_tr_b16 v[98:99], v49 offset:6144
    s_waitcnt lgkmcnt(6)
    v_mfma_f32_16x16x32_bf16 v[112:115], v[72:75], v[76:79], v[112:115]
    ds_read_b64_tr_b16 v[88:89], v28 offset:6144
    ds_read_b64_tr_b16 v[90:91], v28 offset:9216
    s_waitcnt lgkmcnt(6)
    v_mfma_f32_16x16x32_bf16 v[116:119], v[64:67], v[80:83], v[116:119]
    ds_read_b64_tr_b16 v[92:93], v29 offset:6144
    ds_read_b64_tr_b16 v[94:95], v29 offset:9216
    v_mfma_f32_16x16x32_bf16 v[120:123], v[68:71], v[80:83], v[120:123]
    ds_read_b64_tr_b16 v[100:101], v50 offset:4096
    v_mfma_f32_16x16x32_bf16 v[124:127], v[72:75], v[80:83], v[124:127]
    ds_read_b64_tr_b16 v[102:103], v50 offset:6144
    s_barrier
    s_waitcnt lgkmcnt(6)
    v_mfma_f32_16x16x32_bf16 v[104:107], v[84:87], v[96:99], v[104:107]
    ds_read_b64_tr_b16 v[64:65], v30 offset:0
    ds_read_b64_tr_b16 v[66:67], v30 offset:3072
    s_waitcnt lgkmcnt(6)
    v_mfma_f32_16x16x32_bf16 v[108:111], v[88:91], v[96:99], v[108:111]
    ds_read_b64_tr_b16 v[76:77], v51 offset:0
    ds_read_b64_tr_b16 v[78:79], v51 offset:2048
    s_waitcnt lgkmcnt(6)
    v_mfma_f32_16x16x32_bf16 v[112:115], v[92:95], v[96:99], v[112:115]
    ds_read_b64_tr_b16 v[68:69], v31 offset:0
    ds_read_b64_tr_b16 v[70:71], v31 offset:3072
    s_waitcnt lgkmcnt(6)
    v_mfma_f32_16x16x32_bf16 v[116:119], v[84:87], v[100:103], v[116:119]
    ds_read_b64_tr_b16 v[72:73], v32 offset:0
    ds_read_b64_tr_b16 v[74:75], v32 offset:3072
    v_mfma_f32_16x16x32_bf16 v[120:123], v[88:91], v[100:103], v[120:123]
    ds_read_b64_tr_b16 v[80:81], v52 offset:0
    v_mfma_f32_16x16x32_bf16 v[124:127], v[92:95], v[100:103], v[124:127]
    ds_read_b64_tr_b16 v[82:83], v52 offset:2048
    s_waitcnt lgkmcnt(6)
    v_mfma_f32_16x16x32_bf16 v[104:107], v[64:67], v[76:79], v[104:107]
    ds_read_b64_tr_b16 v[84:85], v30 offset:6144
    ds_read_b64_tr_b16 v[86:87], v30 offset:9216
    s_waitcnt lgkmcnt(6)
    v_mfma_f32_16x16x32_bf16 v[108:111], v[68:71], v[76:79], v[108:111]
    ds_read_b64_tr_b16 v[96:97], v51 offset:4096
    ds_read_b64_tr_b16 v[98:99], v51 offset:6144
    s_waitcnt lgkmcnt(6)
    v_mfma_f32_16x16x32_bf16 v[112:115], v[72:75], v[76:79], v[112:115]
    ds_read_b64_tr_b16 v[88:89], v31 offset:6144
    ds_read_b64_tr_b16 v[90:91], v31 offset:9216
    s_waitcnt lgkmcnt(6)
    v_mfma_f32_16x16x32_bf16 v[116:119], v[64:67], v[80:83], v[116:119]
    ds_read_b64_tr_b16 v[92:93], v32 offset:6144
    ds_read_b64_tr_b16 v[94:95], v32 offset:9216
    v_mfma_f32_16x16x32_bf16 v[120:123], v[68:71], v[80:83], v[120:123]
    ds_read_b64_tr_b16 v[100:101], v52 offset:4096
    v_mfma_f32_16x16x32_bf16 v[124:127], v[72:75], v[80:83], v[124:127]
    ds_read_b64_tr_b16 v[102:103], v52 offset:6144
    s_barrier
    s_waitcnt lgkmcnt(6)
    v_mfma_f32_16x16x32_bf16 v[104:107], v[84:87], v[96:99], v[104:107]
    ds_read_b64_tr_b16 v[64:65], v33 offset:0
    ds_read_b64_tr_b16 v[66:67], v33 offset:3072
    s_waitcnt lgkmcnt(6)
    v_mfma_f32_16x16x32_bf16 v[108:111], v[88:91], v[96:99], v[108:111]
    ds_read_b64_tr_b16 v[76:77], v53 offset:0
    ds_read_b64_tr_b16 v[78:79], v53 offset:2048
    s_waitcnt lgkmcnt(6)
    v_mfma_f32_16x16x32_bf16 v[112:115], v[92:95], v[96:99], v[112:115]
    ds_read_b64_tr_b16 v[68:69], v34 offset:0
    ds_read_b64_tr_b16 v[70:71], v34 offset:3072
    s_waitcnt lgkmcnt(6)
    v_mfma_f32_16x16x32_bf16 v[116:119], v[84:87], v[100:103], v[116:119]
    ds_read_b64_tr_b16 v[72:73], v35 offset:0
    ds_read_b64_tr_b16 v[74:75], v35 offset:3072
    v_mfma_f32_16x16x32_bf16 v[120:123], v[88:91], v[100:103], v[120:123]
    ds_read_b64_tr_b16 v[80:81], v54 offset:0
    v_mfma_f32_16x16x32_bf16 v[124:127], v[92:95], v[100:103], v[124:127]
    ds_read_b64_tr_b16 v[82:83], v54 offset:2048
    s_waitcnt lgkmcnt(6)
    v_mfma_f32_16x16x32_bf16 v[104:107], v[64:67], v[76:79], v[104:107]
    ds_read_b64_tr_b16 v[84:85], v33 offset:6144
    ds_read_b64_tr_b16 v[86:87], v33 offset:9216
    s_waitcnt lgkmcnt(6)
    v_mfma_f32_16x16x32_bf16 v[108:111], v[68:71], v[76:79], v[108:111]
    ds_read_b64_tr_b16 v[96:97], v53 offset:4096
    ds_read_b64_tr_b16 v[98:99], v53 offset:6144
    s_waitcnt lgkmcnt(6)
    v_mfma_f32_16x16x32_bf16 v[112:115], v[72:75], v[76:79], v[112:115]
    ds_read_b64_tr_b16 v[88:89], v34 offset:6144
    ds_read_b64_tr_b16 v[90:91], v34 offset:9216
    s_waitcnt lgkmcnt(6)
    v_mfma_f32_16x16x32_bf16 v[116:119], v[64:67], v[80:83], v[116:119]
    ds_read_b64_tr_b16 v[92:93], v35 offset:6144
    ds_read_b64_tr_b16 v[94:95], v35 offset:9216
    v_mfma_f32_16x16x32_bf16 v[120:123], v[68:71], v[80:83], v[120:123]
    ds_read_b64_tr_b16 v[100:101], v54 offset:4096
    v_mfma_f32_16x16x32_bf16 v[124:127], v[72:75], v[80:83], v[124:127]
    ds_read_b64_tr_b16 v[102:103], v54 offset:6144
    s_barrier
    s_waitcnt lgkmcnt(6)
    v_mfma_f32_16x16x32_bf16 v[104:107], v[84:87], v[96:99], v[104:107]
    ds_read_b64_tr_b16 v[64:65], v36 offset:0
    ds_read_b64_tr_b16 v[66:67], v36 offset:3072
    s_waitcnt lgkmcnt(6)
    v_mfma_f32_16x16x32_bf16 v[108:111], v[88:91], v[96:99], v[108:111]
    ds_read_b64_tr_b16 v[76:77], v55 offset:0
    ds_read_b64_tr_b16 v[78:79], v55 offset:2048
    s_waitcnt lgkmcnt(6)
    v_mfma_f32_16x16x32_bf16 v[112:115], v[92:95], v[96:99], v[112:115]
    ds_read_b64_tr_b16 v[68:69], v37 offset:0
    ds_read_b64_tr_b16 v[70:71], v37 offset:3072
    s_waitcnt lgkmcnt(6)
    v_mfma_f32_16x16x32_bf16 v[116:119], v[84:87], v[100:103], v[116:119]
    ds_read_b64_tr_b16 v[72:73], v38 offset:0
    ds_read_b64_tr_b16 v[74:75], v38 offset:3072
    v_mfma_f32_16x16x32_bf16 v[120:123], v[88:91], v[100:103], v[120:123]
    ds_read_b64_tr_b16 v[80:81], v56 offset:0
    v_mfma_f32_16x16x32_bf16 v[124:127], v[92:95], v[100:103], v[124:127]
    ds_read_b64_tr_b16 v[82:83], v56 offset:2048
    s_waitcnt lgkmcnt(6)
    v_mfma_f32_16x16x32_bf16 v[104:107], v[64:67], v[76:79], v[104:107]
    ds_read_b64_tr_b16 v[84:85], v36 offset:6144
    ds_read_b64_tr_b16 v[86:87], v36 offset:9216
    s_waitcnt lgkmcnt(6)
    v_mfma_f32_16x16x32_bf16 v[108:111], v[68:71], v[76:79], v[108:111]
    ds_read_b64_tr_b16 v[96:97], v55 offset:4096
    ds_read_b64_tr_b16 v[98:99], v55 offset:6144
    s_waitcnt lgkmcnt(6)
    v_mfma_f32_16x16x32_bf16 v[112:115], v[72:75], v[76:79], v[112:115]
    ds_read_b64_tr_b16 v[88:89], v37 offset:6144
    ds_read_b64_tr_b16 v[90:91], v37 offset:9216
    s_waitcnt lgkmcnt(6)
    v_mfma_f32_16x16x32_bf16 v[116:119], v[64:67], v[80:83], v[116:119]
    ds_read_b64_tr_b16 v[92:93], v38 offset:6144
    ds_read_b64_tr_b16 v[94:95], v38 offset:9216
    v_mfma_f32_16x16x32_bf16 v[120:123], v[68:71], v[80:83], v[120:123]
    ds_read_b64_tr_b16 v[100:101], v56 offset:4096
    v_mfma_f32_16x16x32_bf16 v[124:127], v[72:75], v[80:83], v[124:127]
    ds_read_b64_tr_b16 v[102:103], v56 offset:6144
    s_barrier
    s_waitcnt lgkmcnt(6)
    v_mfma_f32_16x16x32_bf16 v[104:107], v[84:87], v[96:99], v[104:107]
    ds_read_b64_tr_b16 v[64:65], v39 offset:0
    ds_read_b64_tr_b16 v[66:67], v39 offset:3072
    s_waitcnt lgkmcnt(6)
    v_mfma_f32_16x16x32_bf16 v[108:111], v[88:91], v[96:99], v[108:111]
    ds_read_b64_tr_b16 v[76:77], v57 offset:0
    ds_read_b64_tr_b16 v[78:79], v57 offset:2048
    s_waitcnt lgkmcnt(6)
    v_mfma_f32_16x16x32_bf16 v[112:115], v[92:95], v[96:99], v[112:115]
    ds_read_b64_tr_b16 v[68:69], v40 offset:0
    ds_read_b64_tr_b16 v[70:71], v40 offset:3072
    s_waitcnt lgkmcnt(6)
    v_mfma_f32_16x16x32_bf16 v[116:119], v[84:87], v[100:103], v[116:119]
    ds_read_b64_tr_b16 v[72:73], v41 offset:0
    ds_read_b64_tr_b16 v[74:75], v41 offset:3072
    v_mfma_f32_16x16x32_bf16 v[120:123], v[88:91], v[100:103], v[120:123]
    ds_read_b64_tr_b16 v[80:81], v58 offset:0
    v_mfma_f32_16x16x32_bf16 v[124:127], v[92:95], v[100:103], v[124:127]
    ds_read_b64_tr_b16 v[82:83], v58 offset:2048
    s_waitcnt lgkmcnt(6)
    v_mfma_f32_16x16x32_bf16 v[104:107], v[64:67], v[76:79], v[104:107]
    ds_read_b64_tr_b16 v[84:85], v39 offset:6144
    ds_read_b64_tr_b16 v[86:87], v39 offset:9216
    s_waitcnt lgkmcnt(6)
    v_mfma_f32_16x16x32_bf16 v[108:111], v[68:71], v[76:79], v[108:111]
    ds_read_b64_tr_b16 v[96:97], v57 offset:4096
    ds_read_b64_tr_b16 v[98:99], v57 offset:6144
    s_waitcnt lgkmcnt(6)
    v_mfma_f32_16x16x32_bf16 v[112:115], v[72:75], v[76:79], v[112:115]
    ds_read_b64_tr_b16 v[88:89], v40 offset:6144
    ds_read_b64_tr_b16 v[90:91], v40 offset:9216
    s_waitcnt lgkmcnt(6)
    v_mfma_f32_16x16x32_bf16 v[116:119], v[64:67], v[80:83], v[116:119]
    ds_read_b64_tr_b16 v[92:93], v41 offset:6144
    ds_read_b64_tr_b16 v[94:95], v41 offset:9216
    v_mfma_f32_16x16x32_bf16 v[120:123], v[68:71], v[80:83], v[120:123]
    ds_read_b64_tr_b16 v[100:101], v58 offset:4096
    v_mfma_f32_16x16x32_bf16 v[124:127], v[72:75], v[80:83], v[124:127]
    ds_read_b64_tr_b16 v[102:103], v58 offset:6144
    s_barrier
    s_waitcnt lgkmcnt(6)
    v_mfma_f32_16x16x32_bf16 v[104:107], v[84:87], v[96:99], v[104:107]
    ds_read_b64_tr_b16 v[64:65], v42 offset:0
    ds_read_b64_tr_b16 v[66:67], v42 offset:3072
    s_waitcnt lgkmcnt(6)
    v_mfma_f32_16x16x32_bf16 v[108:111], v[88:91], v[96:99], v[108:111]
    ds_read_b64_tr_b16 v[76:77], v59 offset:0
    ds_read_b64_tr_b16 v[78:79], v59 offset:2048
    s_waitcnt lgkmcnt(6)
    v_mfma_f32_16x16x32_bf16 v[112:115], v[92:95], v[96:99], v[112:115]
    ds_read_b64_tr_b16 v[68:69], v43 offset:0
    ds_read_b64_tr_b16 v[70:71], v43 offset:3072
    s_waitcnt lgkmcnt(6)
    v_mfma_f32_16x16x32_bf16 v[116:119], v[84:87], v[100:103], v[116:119]
    ds_read_b64_tr_b16 v[72:73], v44 offset:0
    ds_read_b64_tr_b16 v[74:75], v44 offset:3072
    v_mfma_f32_16x16x32_bf16 v[120:123], v[88:91], v[100:103], v[120:123]
    ds_read_b64_tr_b16 v[80:81], v60 offset:0
    v_mfma_f32_16x16x32_bf16 v[124:127], v[92:95], v[100:103], v[124:127]
    ds_read_b64_tr_b16 v[82:83], v60 offset:2048
    s_waitcnt lgkmcnt(6)
    v_mfma_f32_16x16x32_bf16 v[104:107], v[64:67], v[76:79], v[104:107]
    ds_read_b64_tr_b16 v[84:85], v42 offset:6144
    ds_read_b64_tr_b16 v[86:87], v42 offset:9216
    s_waitcnt lgkmcnt(6)
    v_mfma_f32_16x16x32_bf16 v[108:111], v[68:71], v[76:79], v[108:111]
    ds_read_b64_tr_b16 v[96:97], v59 offset:4096
    ds_read_b64_tr_b16 v[98:99], v59 offset:6144
    s_waitcnt lgkmcnt(6)
    v_mfma_f32_16x16x32_bf16 v[112:115], v[72:75], v[76:79], v[112:115]
    ds_read_b64_tr_b16 v[88:89], v43 offset:6144
    ds_read_b64_tr_b16 v[90:91], v43 offset:9216
    s_waitcnt lgkmcnt(6)
    v_mfma_f32_16x16x32_bf16 v[116:119], v[64:67], v[80:83], v[116:119]
    ds_read_b64_tr_b16 v[92:93], v44 offset:6144
    ds_read_b64_tr_b16 v[94:95], v44 offset:9216
    v_mfma_f32_16x16x32_bf16 v[120:123], v[68:71], v[80:83], v[120:123]
    ds_read_b64_tr_b16 v[100:101], v60 offset:4096
    v_mfma_f32_16x16x32_bf16 v[124:127], v[72:75], v[80:83], v[124:127]
    ds_read_b64_tr_b16 v[102:103], v60 offset:6144
    s_barrier
    s_waitcnt lgkmcnt(6)
    v_mfma_f32_16x16x32_bf16 v[104:107], v[84:87], v[96:99], v[104:107]
    ds_read_b64_tr_b16 v[64:65], v21 offset:0
    ds_read_b64_tr_b16 v[66:67], v21 offset:3072
    s_waitcnt lgkmcnt(6)
    v_mfma_f32_16x16x32_bf16 v[108:111], v[88:91], v[96:99], v[108:111]
    ds_read_b64_tr_b16 v[76:77], v45 offset:0
    ds_read_b64_tr_b16 v[78:79], v45 offset:2048
    s_waitcnt lgkmcnt(6)
    v_mfma_f32_16x16x32_bf16 v[112:115], v[92:95], v[96:99], v[112:115]
    ds_read_b64_tr_b16 v[68:69], v22 offset:0
    ds_read_b64_tr_b16 v[70:71], v22 offset:3072
    s_waitcnt lgkmcnt(6)
    v_mfma_f32_16x16x32_bf16 v[116:119], v[84:87], v[100:103], v[116:119]
    ds_read_b64_tr_b16 v[72:73], v23 offset:0
    ds_read_b64_tr_b16 v[74:75], v23 offset:3072
    v_mfma_f32_16x16x32_bf16 v[120:123], v[88:91], v[100:103], v[120:123]
    ds_read_b64_tr_b16 v[80:81], v46 offset:0
    v_mfma_f32_16x16x32_bf16 v[124:127], v[92:95], v[100:103], v[124:127]
    ds_read_b64_tr_b16 v[82:83], v46 offset:2048
    s_waitcnt lgkmcnt(6)
    v_mfma_f32_16x16x32_bf16 v[104:107], v[64:67], v[76:79], v[104:107]
    ds_read_b64_tr_b16 v[84:85], v21 offset:6144
    ds_read_b64_tr_b16 v[86:87], v21 offset:9216
    s_waitcnt lgkmcnt(6)
    v_mfma_f32_16x16x32_bf16 v[108:111], v[68:71], v[76:79], v[108:111]
    ds_read_b64_tr_b16 v[96:97], v45 offset:4096
    ds_read_b64_tr_b16 v[98:99], v45 offset:6144
    s_waitcnt lgkmcnt(6)
    v_mfma_f32_16x16x32_bf16 v[112:115], v[72:75], v[76:79], v[112:115]
    ds_read_b64_tr_b16 v[88:89], v22 offset:6144
    ds_read_b64_tr_b16 v[90:91], v22 offset:9216
    s_waitcnt lgkmcnt(6)
    v_mfma_f32_16x16x32_bf16 v[116:119], v[64:67], v[80:83], v[116:119]
    ds_read_b64_tr_b16 v[92:93], v23 offset:6144
    ds_read_b64_tr_b16 v[94:95], v23 offset:9216
    v_mfma_f32_16x16x32_bf16 v[120:123], v[68:71], v[80:83], v[120:123]
    ds_read_b64_tr_b16 v[100:101], v46 offset:4096
    v_mfma_f32_16x16x32_bf16 v[124:127], v[72:75], v[80:83], v[124:127]
    ds_read_b64_tr_b16 v[102:103], v46 offset:6144
    s_waitcnt lgkmcnt(6)
    v_mfma_f32_16x16x32_bf16 v[104:107], v[84:87], v[96:99], v[104:107]
    s_waitcnt lgkmcnt(4)
    v_mfma_f32_16x16x32_bf16 v[108:111], v[88:91], v[96:99], v[108:111]
    s_waitcnt lgkmcnt(2)
    v_mfma_f32_16x16x32_bf16 v[112:115], v[92:95], v[96:99], v[112:115]
    s_waitcnt lgkmcnt(0)
    v_mfma_f32_16x16x32_bf16 v[116:119], v[84:87], v[100:103], v[116:119]
    v_mfma_f32_16x16x32_bf16 v[120:123], v[88:91], v[100:103], v[120:123]
    v_mfma_f32_16x16x32_bf16 v[124:127], v[92:95], v[100:103], v[124:127]
    s_waitcnt vmcnt(0) lgkmcnt(0)
    v_lshlrev_b32 v144, 16, v128
    v_and_b32 v145, 0xffff0000, v128
    v_lshlrev_b32 v146, 16, v129
    v_and_b32 v147, 0xffff0000, v129
    v_add_f32 v104, v104, v144
    v_add_f32 v105, v105, v145
    v_add_f32 v106, v106, v146
    v_add_f32 v107, v107, v147
    v_cvt_pk_bf16_f32 v148, v104, v105
    v_cvt_pk_bf16_f32 v149, v106, v107
    buffer_store_dwordx2 v[148:149], v142, s[16:19], s48 offen offset:0
    v_lshlrev_b32 v144, 16, v130
    v_and_b32 v145, 0xffff0000, v130
    v_lshlrev_b32 v146, 16, v131
    v_and_b32 v147, 0xffff0000, v131
    v_add_f32 v108, v108, v144
    v_add_f32 v109, v109, v145
    v_add_f32 v110, v110, v146
    v_add_f32 v111, v111, v147
    v_cvt_pk_bf16_f32 v150, v108, v109
    v_cvt_pk_bf16_f32 v151, v110, v111
    buffer_store_dwordx2 v[150:151], v142, s[16:19], s48 offen offset:32
    v_lshlrev_b32 v144, 16, v132
    v_and_b32 v145, 0xffff0000, v132
    v_lshlrev_b32 v146, 16, v133
    v_and_b32 v147, 0xffff0000, v133
    v_add_f32 v112, v112, v144
    v_add_f32 v113, v113, v145
    v_add_f32 v114, v114, v146
    v_add_f32 v115, v115, v147
    v_cvt_pk_bf16_f32 v152, v112, v113
    v_cvt_pk_bf16_f32 v153, v114, v115
    buffer_store_dwordx2 v[152:153], v142, s[16:19], s48 offen offset:64
    v_lshlrev_b32 v144, 16, v134
    v_and_b32 v145, 0xffff0000, v134
    v_lshlrev_b32 v146, 16, v135
    v_and_b32 v147, 0xffff0000, v135
    v_add_f32 v116, v116, v144
    v_add_f32 v117, v117, v145
    v_add_f32 v118, v118, v146
    v_add_f32 v119, v119, v147
    v_cvt_pk_bf16_f32 v148, v116, v117
    v_cvt_pk_bf16_f32 v149, v118, v119
    buffer_store_dwordx2 v[148:149], v142, s[16:19], s49 offen offset:0
    v_lshlrev_b32 v144, 16, v136
    v_and_b32 v145, 0xffff0000, v136
    v_lshlrev_b32 v146, 16, v137
    v_and_b32 v147, 0xffff0000, v137
    v_add_f32 v120, v120, v144
    v_add_f32 v121, v121, v145
    v_add_f32 v122, v122, v146
    v_add_f32 v123, v123, v147
    v_cvt_pk_bf16_f32 v150, v120, v121
    v_cvt_pk_bf16_f32 v151, v122, v123
    buffer_store_dwordx2 v[150:151], v142, s[16:19], s49 offen offset:32
    v_lshlrev_b32 v144, 16, v138
    v_and_b32 v145, 0xffff0000, v138
    v_lshlrev_b32 v146, 16, v139
    v_and_b32 v147, 0xffff0000, v139
    v_add_f32 v124, v124, v144
    v_add_f32 v125, v125, v145
    v_add_f32 v126, v126, v146
    v_add_f32 v127, v127, v147
    v_cvt_pk_bf16_f32 v152, v124, v125
    v_cvt_pk_bf16_f32 v153, v126, v127
    buffer_store_dwordx2 v[152:153], v142, s[16:19], s49 offen offset:64
L_wo_kernel_end:
    s_endpgm
.globl ln2_kernel
.p2align 8
.type ln2_kernel,@function
ln2_kernel:
    s_cmp_ge_u32 s2, 128
    s_cbranch_scc1 L_ln2_kernel_end
    s_load_dwordx16 s[64:79], s[0:1], 0
    s_load_dwordx4 s[80:83], s[0:1], 64
    s_load_dwordx2 s[84:85], s[0:1], 80
    s_waitcnt lgkmcnt(0)
    s_add_u32 s8, s84, 9568256
    s_addc_u32 s9, s85, 0
    s_and_b32 s9, s9, 0xffff
    s_mov_b32 s10, 2359296
    s_mov_b32 s11, 0x20000
    s_add_u32 s12, s84, 11927552
    s_addc_u32 s13, s85, 0
    s_and_b32 s13, s13, 0xffff
    s_mov_b32 s14, 2359296
    s_mov_b32 s15, 0x20000
    v_and_b32 v1, 15, v0
    v_lshrrev_b32 v2, 4, v0
    s_lshl_b32 s3, s2, 4
    v_add_u32 v2, s3, v2
    v_mul_u32_u24 v3, 1152, v2
    v_lshl_add_u32 v3, v1, 3, v3
    buffer_load_dwordx2 v[8:9], v3, s[8:11], 0 offen offset:0
    buffer_load_dwordx2 v[10:11], v3, s[8:11], 0 offen offset:128
    buffer_load_dwordx2 v[12:13], v3, s[8:11], 0 offen offset:256
    buffer_load_dwordx2 v[14:15], v3, s[8:11], 0 offen offset:384
    buffer_load_dwordx2 v[16:17], v3, s[8:11], 0 offen offset:512
    buffer_load_dwordx2 v[18:19], v3, s[8:11], 0 offen offset:640
    buffer_load_dwordx2 v[20:21], v3, s[8:11], 0 offen offset:768
    buffer_load_dwordx2 v[22:23], v3, s[8:11], 0 offen offset:896
    buffer_load_dwordx2 v[24:25], v3, s[8:11], 0 offen offset:1024
    s_mov_b32 s16, s76
    s_and_b32 s17, s77, 0xffff
    s_mov_b32 s18, 18874368
    s_mov_b32 s19, 0x20000
    s_add_u32 s20, s84, 134217728
    s_addc_u32 s21, s85, 0
    s_and_b32 s21, s21, 0xffff
    s_mov_b32 s22, 2359296
    s_mov_b32 s23, 0x20000
    v_lshrrev_b32 v5, 6, v0
    s_lshl_b32 s4, s2, 2
    v_add_u32 v5, s4, v5
    v_mul_u32_u24 v5, 36, v5
    v_bfe_u32 v6, v0, 3, 3
    v_add_u32 v5, v5, v6
    v_and_b32 v7, 7, v0
    v_add_u32 v6, 0, v5
    v_lshrrev_b32 v124, 2, v6
    v_and_b32 v6, 3, v6
    v_lshlrev_b32 v125, 12, v124
    v_lshl_add_u32 v125, v6, 10, v125
    v_lshl_add_u32 v125, v7, 4, v125
    v_mul_u32_u24 v6, 589824, v6
    v_lshl_add_u32 v6, v124, 7, v6
    v_lshl_add_u32 v128, v7, 4, v6
    buffer_load_dwordx4 v[136:139], v125, s[16:19], 0 offen offset:384
    v_add_u32 v6, 8, v5
    v_lshrrev_b32 v124, 2, v6
    v_and_b32 v6, 3, v6
    v_lshlrev_b32 v125, 12, v124
    v_lshl_add_u32 v125, v6, 10, v125
    v_lshl_add_u32 v125, v7, 4, v125
    v_mul_u32_u24 v6, 589824, v6
    v_lshl_add_u32 v6, v124, 7, v6
    v_lshl_add_u32 v129, v7, 4, v6
    buffer_load_dwordx4 v[140:143], v125, s[16:19], 0 offen offset:384
    v_add_u32 v6, 16, v5
    v_lshrrev_b32 v124, 2, v6
    v_and_b32 v6, 3, v6
    v_lshlrev_b32 v125, 12, v124
    v_lshl_add_u32 v125, v6, 10, v125
    v_lshl_add_u32 v125, v7, 4, v125
    v_mul_u32_u24 v6, 589824, v6
    v_lshl_add_u32 v6, v124, 7, v6
    v_lshl_add_u32 v130, v7, 4, v6
    buffer_load_dwordx4 v[144:147], v125, s[16:19], 0 offen offset:384
    v_add_u32 v6, 24, v5
    v_lshrrev_b32 v124, 2, v6
    v_and_b32 v6, 3, v6
    v_lshlrev_b32 v125, 12, v124
    v_lshl_add_u32 v125, v6, 10, v125
    v_lshl_add_u32 v125, v7, 4, v125
    v_mul_u32_u24 v6, 589824, v6
    v_lshl_add_u32 v6, v124, 7, v6
    v_lshl_add_u32 v131, v7, 4, v6
    buffer_load_dwordx4 v[148:151], v125, s[16:19], 0 offen offset:384
    v_add_u32 v6, 32, v5
    v_lshrrev_b32 v124, 2, v6
    v_and_b32 v6, 3, v6
    v_lshlrev_b32 v125, 12, v124
    v_lshl_add_u32 v125, v6, 10, v125
    v_lshl_add_u32 v125, v7, 4, v125
    v_mul_u32_u24 v6, 589824, v6
    v_lshl_add_u32 v6, v124, 7, v6
    v_lshl_add_u32 v132, v7, 4, v6
    s_mov_b64 exec, 0xffffffff
    buffer_load_dwordx4 v[152:155], v125, s[16:19], 0 offen offset:384
    s_mov_b64 exec, -1
    v_mul_u32_u24 v4, 192, v2
    v_add_u32 v5, 0, v1
    v_mul_u32_u24 v6, 2731, v5
    v_lshrrev_b32 v6, 16, v6
    v_mul_u32_u24 v7, 24, v6
    v_sub_u32 v7, v5, v7
    v_mul_u32_u24 v6, 393216, v6
    v_lshl_add_u32 v6, v7, 3, v6
    v_add_u32 v112, v6, v4
    v_add_u32 v5, 16, v1
    v_mul_u32_u24 v6, 2731, v5
    v_lshrrev_b32 v6, 16, v6
    v_mul_u32_u24 v7, 24, v6
    v_sub_u32 v7, v5, v7
    v_mul_u32_u24 v6, 393216, v6
    v_lshl_add_u32 v6, v7, 3, v6
    v_add_u32 v113, v6, v4
    v_add_u32 v5, 32, v1
    v_mul_u32_u24 v6, 2731, v5
    v_lshrrev_b32 v6, 16, v6
    v_mul_u32_u24 v7, 24, v6
    v_sub_u32 v7, v5, v7
    v_mul_u32_u24 v6, 393216, v6
    v_lshl_add_u32 v6, v7, 3, v6
    v_add_u32 v114, v6, v4
    v_add_u32 v5, 48, v1
    v_mul_u32_u24 v6, 2731, v5
    v_lshrrev_b32 v6, 16, v6
    v_mul_u32_u24 v7, 24, v6
    v_sub_u32 v7, v5, v7
    v_mul_u32_u24 v6, 393216, v6
    v_lshl_add_u32 v6, v7, 3, v6
    v_add_u32 v115, v6, v4
    v_add_u32 v5, 64, v1
    v_mul_u32_u24 v6, 2731, v5
    v_lshrrev_b32 v6, 16, v6
    v_mul_u32_u24 v7, 24, v6
    v_sub_u32 v7, v5, v7
    v_mul_u32_u24 v6, 393216, v6
    v_lshl_add_u32 v6, v7, 3, v6
    v_add_u32 v116, v6, v4
    v_add_u32 v5, 80, v1
    v_mul_u32_u24 v6, 2731, v5
    v_lshrrev_b32 v6, 16, v6
    v_mul_u32_u24 v7, 24, v6
    v_sub_u32 v7, v5, v7
    v_mul_u32_u24 v6, 393216, v6
    v_lshl_add_u32 v6, v7, 3, v6
    v_add_u32 v117, v6, v4
    v_add_u32 v5, 96, v1
    v_mul_u32_u24 v6, 2731, v5
    v_lshrrev_b32 v6, 16, v6
    v_mul_u32_u24 v7, 24, v6
    v_sub_u32 v7, v5, v7
    v_mul_u32_u24 v6, 393216, v6
    v_lshl_add_u32 v6, v7, 3, v6
    v_add_u32 v118, v6, v4
    v_add_u32 v5, 112, v1
    v_mul_u32_u24 v6, 2731, v5
    v_lshrrev_b32 v6, 16, v6
    v_mul_u32_u24 v7, 24, v6
    v_sub_u32 v7, v5, v7
    v_mul_u32_u24 v6, 393216, v6
    v_lshl_add_u32 v6, v7, 3, v6
    v_add_u32 v119, v6, v4
    v_add_u32 v5, 128, v1
    v_mul_u32_u24 v6, 2731, v5
    v_lshrrev_b32 v6, 16, v6
    v_mul_u32_u24 v7, 24, v6
    v_sub_u32 v7, v5, v7
    v_mul_u32_u24 v6, 393216, v6
    v_lshl_add_u32 v6, v7, 3, v6
    v_add_u32 v120, v6, v4
    s_waitcnt vmcnt(13)
    v_lshlrev_b32 v32, 16, v8
    v_and_b32 v33, 0xffff0000, v8
    v_lshlrev_b32 v34, 16, v9
    v_and_b32 v35, 0xffff0000, v9
    s_waitcnt vmcnt(12)
    v_lshlrev_b32 v36, 16, v10
    v_and_b32 v37, 0xffff0000, v10
    v_lshlrev_b32 v38, 16, v11
    v_and_b32 v39, 0xffff0000, v11
    s_waitcnt vmcnt(11)
    v_lshlrev_b32 v40, 16, v12
    v_and_b32 v41, 0xffff0000, v12
    v_lshlrev_b32 v42, 16, v13
    v_and_b32 v43, 0xffff0000, v13
    s_waitcnt vmcnt(10)
    v_lshlrev_b32 v44, 16, v14
    v_and_b32 v45, 0xffff0000, v14
    v_lshlrev_b32 v46, 16, v15
    v_and_b32 v47, 0xffff0000, v15
    s_waitcnt vmcnt(9)
    v_lshlrev_b32 v48, 16, v16
    v_and_b32 v49, 0xffff0000, v16
    v_lshlrev_b32 v50, 16, v17
    v_and_b32 v51, 0xffff0000, v17
    s_waitcnt vmcnt(8)
    v_lshlrev_b32 v52, 16, v18
    v_and_b32 v53, 0xffff0000, v18
    v_lshlrev_b32 v54, 16, v19
    v_and_b32 v55, 0xffff0000, v19
    s_waitcnt vmcnt(7)
    v_lshlrev_b32 v56, 16, v20
    v_and_b32 v57, 0xffff0000, v20
    v_lshlrev_b32 v58, 16, v21
    v_and_b32 v59, 0xffff0000, v21
    s_waitcnt vmcnt(6)
    v_lshlrev_b32 v60, 16, v22
    v_and_b32 v61, 0xffff0000, v22
    v_lshlrev_b32 v62, 16, v23
    v_and_b32 v63, 0xffff0000, v23
    s_waitcnt vmcnt(5)
    v_lshlrev_b32 v64, 16, v24
    v_and_b32 v65, 0xffff0000, v24
    v_lshlrev_b32 v66, 16, v25
    v_and_b32 v67, 0xffff0000, v25
    v_add_f32 v72, v32, v33
    v_add_f32 v73, v34, v35
    v_add_f32 v72, v72, v36
    v_add_f32 v73, v73, v37
    v_add_f32 v72, v72, v38
    v_add_f32 v73, v73, v39
    v_add_f32 v72, v72, v40
    v_add_f32 v73, v73, v41
    v_add_f32 v72, v72, v42
    v_add_f32 v73, v73, v43
    v_add_f32 v72, v72, v44
    v_add_f32 v73, v73, v45
    v_add_f32 v72, v72, v46
    v_add_f32 v73, v73, v47
    v_add_f32 v72, v72, v48
    v_add_f32 v73, v73, v49
    v_add_f32 v72, v72, v50
    v_add_f32 v73, v73, v51
    v_add_f32 v72, v72, v52
    v_add_f32 v73, v73, v53
    v_add_f32 v72, v72, v54
    v_add_f32 v73, v73, v55
    v_add_f32 v72, v72, v56
    v_add_f32 v73, v73, v57
    v_add_f32 v72, v72, v58
    v_add_f32 v73, v73, v59
    v_add_f32 v72, v72, v60
    v_add_f32 v73, v73, v61
    v_add_f32 v72, v72, v62
    v_add_f32 v73, v73, v63
    v_add_f32 v72, v72, v64
    v_add_f32 v73, v73, v65
    v_add_f32 v72, v72, v66
    v_add_f32 v73, v73, v67
    v_add_f32 v72, v72, v73
    s_nop 1
    v_add_f32_dpp v72, v72, v72 quad_perm:[1,0,3,2] row_mask:0xf bank_mask:0xf
    s_nop 1
    v_add_f32_dpp v72, v72, v72 quad_perm:[2,3,0,1] row_mask:0xf bank_mask:0xf
    s_nop 1
    v_add_f32_dpp v72, v72, v72 row_half_mirror row_mask:0xf bank_mask:0xf
    s_nop 1
    v_add_f32_dpp v72, v72, v72 row_mirror row_mask:0xf bank_mask:0xf
    v_mul_f32 v72, 0x3ae38e39, v72
    v_sub_f32 v32, v32, v72
    v_sub_f32 v33, v33, v72
    v_sub_f32 v34, v34, v72
    v_sub_f32 v35, v35, v72
    v_sub_f32 v36, v36, v72
    v_sub_f32 v37, v37, v72
    v_sub_f32 v38, v38, v72
    v_sub_f32 v39, v39, v72
    v_sub_f32 v40, v40, v72
    v_sub_f32 v41, v41, v72
    v_sub_f32 v42, v42, v72
    v_sub_f32 v43, v43, v72
    v_sub_f32 v44, v44, v72
    v_sub_f32 v45, v45, v72
    v_sub_f32 v46, v46, v72
    v_sub_f32 v47, v47, v72
    v_sub_f32 v48, v48, v72
    v_sub_f32 v49, v49, v72
    v_sub_f32 v50, v50, v72
    v_sub_f32 v51, v51, v72
    v_sub_f32 v52, v52, v72
    v_sub_f32 v53, v53, v72
    v_sub_f32 v54, v54, v72
    v_sub_f32 v55, v55, v72
    v_sub_f32 v56, v56, v72
    v_sub_f32 v57, v57, v72
    v_sub_f32 v58, v58, v72
    v_sub_f32 v59, v59, v72
    v_sub_f32 v60, v60, v72
    v_sub_f32 v61, v61, v72
    v_sub_f32 v62, v62, v72
    v_sub_f32 v63, v63, v72
    v_sub_f32 v64, v64, v72
    v_sub_f32 v65, v65, v72
    v_sub_f32 v66, v66, v72
    v_sub_f32 v67, v67, v72
    v_mul_f32 v74, v32, v32
    v_mul_f32 v75, v33, v33
    v_fmac_f32 v74, v34, v34
    v_fmac_f32 v75, v35, v35
    v_fmac_f32 v74, v36, v36
    v_fmac_f32 v75, v37, v37
    v_fmac_f32 v74, v38, v38
    v_fmac_f32 v75, v39, v39
    v_fmac_f32 v74, v40, v40
    v_fmac_f32 v75, v41, v41
    v_fmac_f32 v74, v42, v42
    v_fmac_f32 v75, v43, v43
    v_fmac_f32 v74, v44, v44
    v_fmac_f32 v75, v45, v45
    v_fmac_f32 v74, v46, v46
    v_fmac_f32 v75, v47, v47
    v_fmac_f32 v74, v48, v48
    v_fmac_f32 v75, v49, v49
    v_fmac_f32 v74, v50, v50
    v_fmac_f32 v75, v51, v51
    v_fmac_f32 v74, v52, v52
    v_fmac_f32 v75, v53, v53
    v_fmac_f32 v74, v54, v54
    v_fmac_f32 v75, v55, v55
    v_fmac_f32 v74, v56, v56
    v_fmac_f32 v75, v57, v57
    v_fmac_f32 v74, v58, v58
    v_fmac_f32 v75, v59, v59
    v_fmac_f32 v74, v60, v60
    v_fmac_f32 v75, v61, v61
    v_fmac_f32 v74, v62, v62
    v_fmac_f32 v75, v63, v63
    v_fmac_f32 v74, v64, v64
    v_fmac_f32 v75, v65, v65
    v_fmac_f32 v74, v66, v66
    v_fmac_f32 v75, v67, v67
    v_add_f32 v74, v74, v75
    s_nop 1
    v_add_f32_dpp v74, v74, v74 quad_perm:[1,0,3,2] row_mask:0xf bank_mask:0xf
    s_nop 1
    v_add_f32_dpp v74, v74, v74 quad_perm:[2,3,0,1] row_mask:0xf bank_mask:0xf
    s_nop 1
    v_add_f32_dpp v74, v74, v74 row_half_mirror row_mask:0xf bank_mask:0xf
    s_nop 1
    v_add_f32_dpp v74, v74, v74 row_mirror row_mask:0xf bank_mask:0xf
    v_mov_b32 v75, 0x3727c5ac
    v_fmac_f32 v75, 0x3ae38e39, v74
    v_rsq_f32 v75, v75
    s_nop 0
    v_mul_f32 v32, v32, v75
    v_mul_f32 v33, v33, v75
    v_mul_f32 v34, v34, v75
    v_mul_f32 v35, v35, v75
    v_mul_f32 v36, v36, v75
    v_mul_f32 v37, v37, v75
    v_mul_f32 v38, v38, v75
    v_mul_f32 v39, v39, v75
    v_mul_f32 v40, v40, v75
    v_mul_f32 v41, v41, v75
    v_mul_f32 v42, v42, v75
    v_mul_f32 v43, v43, v75
    v_mul_f32 v44, v44, v75
    v_mul_f32 v45, v45, v75
    v_mul_f32 v46, v46, v75
    v_mul_f32 v47, v47, v75
    v_mul_f32 v48, v48, v75
    v_mul_f32 v49, v49, v75
    v_mul_f32 v50, v50, v75
    v_mul_f32 v51, v51, v75
    v_mul_f32 v52, v52, v75
    v_mul_f32 v53, v53, v75
    v_mul_f32 v54, v54, v75
    v_mul_f32 v55, v55, v75
    v_mul_f32 v56, v56, v75
    v_mul_f32 v57, v57, v75
    v_mul_f32 v58, v58, v75
    v_mul_f32 v59, v59, v75
    v_mul_f32 v60, v60, v75
    v_mul_f32 v61, v61, v75
    v_mul_f32 v62, v62, v75
    v_mul_f32 v63, v63, v75
    v_mul_f32 v64, v64, v75
    v_mul_f32 v65, v65, v75
    v_mul_f32 v66, v66, v75
    v_mul_f32 v67, v67, v75
    v_cvt_pk_bf16_f32 v8, v32, v33
    v_cvt_pk_bf16_f32 v9, v34, v35
    v_cvt_pk_bf16_f32 v10, v36, v37
    v_cvt_pk_bf16_f32 v11, v38, v39
    v_cvt_pk_bf16_f32 v12, v40, v41
    v_cvt_pk_bf16_f32 v13, v42, v43
    v_cvt_pk_bf16_f32 v14, v44, v45
    v_cvt_pk_bf16_f32 v15, v46, v47
    v_cvt_pk_bf16_f32 v16, v48, v49
    v_cvt_pk_bf16_f32 v17, v50, v51
    v_cvt_pk_bf16_f32 v18, v52, v53
    v_cvt_pk_bf16_f32 v19, v54, v55
    v_cvt_pk_bf16_f32 v20, v56, v57
    v_cvt_pk_bf16_f32 v21, v58, v59
    v_cvt_pk_bf16_f32 v22, v60, v61
    v_cvt_pk_bf16_f32 v23, v62, v63
    v_cvt_pk_bf16_f32 v24, v64, v65
    v_cvt_pk_bf16_f32 v25, v66, v67
    v_lshlrev_b32 v32, 16, v8
    v_and_b32 v33, 0xffff0000, v8
    v_lshlrev_b32 v34, 16, v9
    v_and_b32 v35, 0xffff0000, v9
    v_lshlrev_b32 v36, 16, v10
    v_and_b32 v37, 0xffff0000, v10
    v_lshlrev_b32 v38, 16, v11
    v_and_b32 v39, 0xffff0000, v11
    v_lshlrev_b32 v40, 16, v12
    v_and_b32 v41, 0xffff0000, v12
    v_lshlrev_b32 v42, 16, v13
    v_and_b32 v43, 0xffff0000, v13
    v_lshlrev_b32 v44, 16, v14
    v_and_b32 v45, 0xffff0000, v14
    v_lshlrev_b32 v46, 16, v15
    v_and_b32 v47, 0xffff0000, v15
    v_lshlrev_b32 v48, 16, v16
    v_and_b32 v49, 0xffff0000, v16
    v_lshlrev_b32 v50, 16, v17
    v_and_b32 v51, 0xffff0000, v17
    v_lshlrev_b32 v52, 16, v18
    v_and_b32 v53, 0xffff0000, v18
    v_lshlrev_b32 v54, 16, v19
    v_and_b32 v55, 0xffff0000, v19
    v_lshlrev_b32 v56, 16, v20
    v_and_b32 v57, 0xffff0000, v20
    v_lshlrev_b32 v58, 16, v21
    v_and_b32 v59, 0xffff0000, v21
    v_lshlrev_b32 v60, 16, v22
    v_and_b32 v61, 0xffff0000, v22
    v_lshlrev_b32 v62, 16, v23
    v_and_b32 v63, 0xffff0000, v23
    v_lshlrev_b32 v64, 16, v24
    v_and_b32 v65, 0xffff0000, v24
    v_lshlrev_b32 v66, 16, v25
    v_and_b32 v67, 0xffff0000, v25
    v_add_f32 v72, v32, v33
    v_add_f32 v73, v34, v35
    v_add_f32 v72, v72, v36
    v_add_f32 v73, v73, v37
    v_add_f32 v72, v72, v38
    v_add_f32 v73, v73, v39
    v_add_f32 v72, v72, v40
    v_add_f32 v73, v73, v41
    v_add_f32 v72, v72, v42
    v_add_f32 v73, v73, v43
    v_add_f32 v72, v72, v44
    v_add_f32 v73, v73, v45
    v_add_f32 v72, v72, v46
    v_add_f32 v73, v73, v47
    v_add_f32 v72, v72, v48
    v_add_f32 v73, v73, v49
    v_add_f32 v72, v72, v50
    v_add_f32 v73, v73, v51
    v_add_f32 v72, v72, v52
    v_add_f32 v73, v73, v53
    v_add_f32 v72, v72, v54
    v_add_f32 v73, v73, v55
    v_add_f32 v72, v72, v56
    v_add_f32 v73, v73, v57
    v_add_f32 v72, v72, v58
    v_add_f32 v73, v73, v59
    v_add_f32 v72, v72, v60
    v_add_f32 v73, v73, v61
    v_add_f32 v72, v72, v62
    v_add_f32 v73, v73, v63
    v_add_f32 v72, v72, v64
    v_add_f32 v73, v73, v65
    v_add_f32 v72, v72, v66
    v_add_f32 v73, v73, v67
    v_add_f32 v72, v72, v73
    s_nop 1
    v_add_f32_dpp v72, v72, v72 quad_perm:[1,0,3,2] row_mask:0xf bank_mask:0xf
    s_nop 1
    v_add_f32_dpp v72, v72, v72 quad_perm:[2,3,0,1] row_mask:0xf bank_mask:0xf
    s_nop 1
    v_add_f32_dpp v72, v72, v72 row_half_mirror row_mask:0xf bank_mask:0xf
    s_nop 1
    v_add_f32_dpp v72, v72, v72 row_mirror row_mask:0xf bank_mask:0xf
    v_mul_f32 v72, 0x3ae38e39, v72
    v_sub_f32 v32, v32, v72
    v_sub_f32 v33, v33, v72
    v_sub_f32 v34, v34, v72
    v_sub_f32 v35, v35, v72
    v_sub_f32 v36, v36, v72
    v_sub_f32 v37, v37, v72
    v_sub_f32 v38, v38, v72
    v_sub_f32 v39, v39, v72
    v_sub_f32 v40, v40, v72
    v_sub_f32 v41, v41, v72
    v_sub_f32 v42, v42, v72
    v_sub_f32 v43, v43, v72
    v_sub_f32 v44, v44, v72
    v_sub_f32 v45, v45, v72
    v_sub_f32 v46, v46, v72
    v_sub_f32 v47, v47, v72
    v_sub_f32 v48, v48, v72
    v_sub_f32 v49, v49, v72
    v_sub_f32 v50, v50, v72
    v_sub_f32 v51, v51, v72
    v_sub_f32 v52, v52, v72
    v_sub_f32 v53, v53, v72
    v_sub_f32 v54, v54, v72
    v_sub_f32 v55, v55, v72
    v_sub_f32 v56, v56, v72
    v_sub_f32 v57, v57, v72
    v_sub_f32 v58, v58, v72
    v_sub_f32 v59, v59, v72
    v_sub_f32 v60, v60, v72
    v_sub_f32 v61, v61, v72
    v_sub_f32 v62, v62, v72
    v_sub_f32 v63, v63, v72
    v_sub_f32 v64, v64, v72
    v_sub_f32 v65, v65, v72
    v_sub_f32 v66, v66, v72
    v_sub_f32 v67, v67, v72
    v_mul_f32 v74, v32, v32
    v_mul_f32 v75, v33, v33
    v_fmac_f32 v74, v34, v34
    v_fmac_f32 v75, v35, v35
    v_fmac_f32 v74, v36, v36
    v_fmac_f32 v75, v37, v37
    v_fmac_f32 v74, v38, v38
    v_fmac_f32 v75, v39, v39
    v_fmac_f32 v74, v40, v40
    v_fmac_f32 v75, v41, v41
    v_fmac_f32 v74, v42, v42
    v_fmac_f32 v75, v43, v43
    v_fmac_f32 v74, v44, v44
    v_fmac_f32 v75, v45, v45
    v_fmac_f32 v74, v46, v46
    v_fmac_f32 v75, v47, v47
    v_fmac_f32 v74, v48, v48
    v_fmac_f32 v75, v49, v49
    v_fmac_f32 v74, v50, v50
    v_fmac_f32 v75, v51, v51
    v_fmac_f32 v74, v52, v52
    v_fmac_f32 v75, v53, v53
    v_fmac_f32 v74, v54, v54
    v_fmac_f32 v75, v55, v55
    v_fmac_f32 v74, v56, v56
    v_fmac_f32 v75, v57, v57
    v_fmac_f32 v74, v58, v58
    v_fmac_f32 v75, v59, v59
    v_fmac_f32 v74, v60, v60
    v_fmac_f32 v75, v61, v61
    v_fmac_f32 v74, v62, v62
    v_fmac_f32 v75, v63, v63
    v_fmac_f32 v74, v64, v64
    v_fmac_f32 v75, v65, v65
    v_fmac_f32 v74, v66, v66
    v_fmac_f32 v75, v67, v67
    v_add_f32 v74, v74, v75
    s_nop 1
    v_add_f32_dpp v74, v74, v74 quad_perm:[1,0,3,2] row_mask:0xf bank_mask:0xf
    s_nop 1
    v_add_f32_dpp v74, v74, v74 quad_perm:[2,3,0,1] row_mask:0xf bank_mask:0xf
    s_nop 1
    v_add_f32_dpp v74, v74, v74 row_half_mirror row_mask:0xf bank_mask:0xf
    s_nop 1
    v_add_f32_dpp v74, v74, v74 row_mirror row_mask:0xf bank_mask:0xf
    v_mov_b32 v75, 0x3727c5ac
    v_fmac_f32 v75, 0x3ae38e39, v74
    v_rsq_f32 v75, v75
    s_nop 0
    v_mul_f32 v32, v32, v75
    v_mul_f32 v33, v33, v75
    v_mul_f32 v34, v34, v75
    v_mul_f32 v35, v35, v75
    v_mul_f32 v36, v36, v75
    v_mul_f32 v37, v37, v75
    v_mul_f32 v38, v38, v75
    v_mul_f32 v39, v39, v75
    v_mul_f32 v40, v40, v75
    v_mul_f32 v41, v41, v75
    v_mul_f32 v42, v42, v75
    v_mul_f32 v43, v43, v75
    v_mul_f32 v44, v44, v75
    v_mul_f32 v45, v45, v75
    v_mul_f32 v46, v46, v75
    v_mul_f32 v47, v47, v75
    v_mul_f32 v48, v48, v75
    v_mul_f32 v49, v49, v75
    v_mul_f32 v50, v50, v75
    v_mul_f32 v51, v51, v75
    v_mul_f32 v52, v52, v75
    v_mul_f32 v53, v53, v75
    v_mul_f32 v54, v54, v75
    v_mul_f32 v55, v55, v75
    v_mul_f32 v56, v56, v75
    v_mul_f32 v57, v57, v75
    v_mul_f32 v58, v58, v75
    v_mul_f32 v59, v59, v75
    v_mul_f32 v60, v60, v75
    v_mul_f32 v61, v61, v75
    v_mul_f32 v62, v62, v75
    v_mul_f32 v63, v63, v75
    v_mul_f32 v64, v64, v75
    v_mul_f32 v65, v65, v75
    v_mul_f32 v66, v66, v75
    v_mul_f32 v67, v67, v75
    v_cvt_pk_bf16_f32 v8, v32, v33
    v_cvt_pk_bf16_f32 v9, v34, v35
    v_cvt_pk_bf16_f32 v10, v36, v37
    v_cvt_pk_bf16_f32 v11, v38, v39
    v_cvt_pk_bf16_f32 v12, v40, v41
    v_cvt_pk_bf16_f32 v13, v42, v43
    v_cvt_pk_bf16_f32 v14, v44, v45
    v_cvt_pk_bf16_f32 v15, v46, v47
    v_cvt_pk_bf16_f32 v16, v48, v49
    v_cvt_pk_bf16_f32 v17, v50, v51
    v_cvt_pk_bf16_f32 v18, v52, v53
    v_cvt_pk_bf16_f32 v19, v54, v55
    v_cvt_pk_bf16_f32 v20, v56, v57
    v_cvt_pk_bf16_f32 v21, v58, v59
    v_cvt_pk_bf16_f32 v22, v60, v61
    v_cvt_pk_bf16_f32 v23, v62, v63
    v_cvt_pk_bf16_f32 v24, v64, v65
    v_cvt_pk_bf16_f32 v25, v66, v67
    buffer_store_dwordx2 v[8:9], v112, s[12:15], 0 offen
    buffer_store_dwordx2 v[10:11], v113, s[12:15], 0 offen
    buffer_store_dwordx2 v[12:13], v114, s[12:15], 0 offen
    buffer_store_dwordx2 v[14:15], v115, s[12:15], 0 offen
    buffer_store_dwordx2 v[16:17], v116, s[12:15], 0 offen
    buffer_store_dwordx2 v[18:19], v117, s[12:15], 0 offen
    buffer_store_dwordx2 v[20:21], v118, s[12:15], 0 offen
    buffer_store_dwordx2 v[22:23], v119, s[12:15], 0 offen
    buffer_store_dwordx2 v[24:25], v120, s[12:15], 0 offen
    s_waitcnt vmcnt(13)
    buffer_store_dwordx4 v[136:139], v128, s[20:23], 0 offen
    s_waitcnt vmcnt(13)
    buffer_store_dwordx4 v[140:143], v129, s[20:23], 0 offen
    s_waitcnt vmcnt(13)
    buffer_store_dwordx4 v[144:147], v130, s[20:23], 0 offen
    s_waitcnt vmcnt(13)
    buffer_store_dwordx4 v[148:151], v131, s[20:23], 0 offen
    s_mov_b64 exec, 0xffffffff
    s_waitcnt vmcnt(13)
    buffer_store_dwordx4 v[152:155], v132, s[20:23], 0 offen
L_ln2_kernel_end:
    s_endpgm
.globl mlp1_kernel
.p2align 8
.type mlp1_kernel,@function
mlp1_kernel:
    s_cmp_ge_u32 s2, 216
    s_cbranch_scc1 L_mlp1_kernel_end
    s_load_dwordx16 s[64:79], s[0:1], 0
    s_load_dwordx4 s[80:83], s[0:1], 64
    s_load_dwordx2 s[84:85], s[0:1], 80
    s_waitcnt lgkmcnt(0)
    s_add_u32 s8, s84, 11927552
    s_addc_u32 s9, s85, 0
    s_and_b32 s9, s9, 0xffff
    s_mov_b32 s10, 2359296
    s_mov_b32 s11, 0x20000
    s_mov_b32 s12, s72
    s_and_b32 s13, s73, 0xffff
    s_mov_b32 s14, 18874368
    s_mov_b32 s15, 0x20000
    s_and_b32 s31, s2, 7
    s_lshr_b32 s32, s2, 3
    s_mul_i32 s31, s31, 27
    s_add_u32 s31, s31, s32
    s_mov_b32 s33, 0x2AAAAAAB
    s_mul_hi_u32 s33, s31, s33
    s_mul_i32 s32, s33, 6
    s_sub_u32 s32, s31, s32
    s_mul_i32 s36, s32, 393216
    s_mul_i32 s37, s33, 256
    s_mov_b32 s52, 9216
    s_lshl_b32 s53, s52, 6
    v_lshrrev_b32 v1, 6, v0
    v_and_b32 v2, 63, v0
    v_readfirstlane_b32 s38, v1
    s_lshr_b32 s55, s38, 2
    s_and_b32 s38, s38, 3
    s_cmp_eq_u32 s55, 0
    s_cbranch_scc1 L_mlp1_kernel_comp
    s_and_b32 s39, s38, 1
    s_lshr_b32 s40, s38, 1
    s_mul_i32 s34, s38, 3072
    s_mul_i32 s35, s38, 4096
    s_add_u32 s35, s35, 12288
    s_mul_i32 s42, s38, 192
    s_add_u32 s42, s42, 0
    v_add_u32 v6, s42, v2
    v_mul_u32_u24 v7, 0xAAAB, v6
    v_lshrrev_b32 v7, 19, v7
    v_mul_u32_u24 v8, 12, v7
    v_sub_u32 v8, v6, v8
    v_lshrrev_b32 v9, 1, v7
    v_and_b32 v9, 2, v9
    v_xor_b32 v8, v8, v9
    v_mul_u32_u24 v7, 192, v7
    v_lshl_add_u32 v7, v8, 4, v7
    s_sub_u32 s42, s36, 0
    v_add_u32 v16, s42, v7
    s_mul_i32 s42, s38, 192
    s_add_u32 s42, s42, 64
    v_add_u32 v6, s42, v2
    v_mul_u32_u24 v7, 0xAAAB, v6
    v_lshrrev_b32 v7, 19, v7
    v_mul_u32_u24 v8, 12, v7
    v_sub_u32 v8, v6, v8
    v_lshrrev_b32 v9, 1, v7
    v_and_b32 v9, 2, v9
    v_xor_b32 v8, v8, v9
    v_mul_u32_u24 v7, 192, v7
    v_lshl_add_u32 v7, v8, 4, v7
    s_sub_u32 s42, s36, 1024
    v_add_u32 v17, s42, v7
    s_mul_i32 s42, s38, 192
    s_add_u32 s42, s42, 128
    v_add_u32 v6, s42, v2
    v_mul_u32_u24 v7, 0xAAAB, v6
    v_lshrrev_b32 v7, 19, v7
    v_mul_u32_u24 v8, 12, v7
    v_sub_u32 v8, v6, v8
    v_lshrrev_b32 v9, 1, v7
    v_and_b32 v9, 2, v9
    v_xor_b32 v8, v8, v9
    v_mul_u32_u24 v7, 192, v7
    v_lshl_add_u32 v7, v8, 4, v7
    s_sub_u32 s42, s36, 2048
    v_add_u32 v18, s42, v7
    s_mov_b32 s43, s52
    s_lshl_b32 s42, s38, 4
    s_add_u32 s42, s42, 0
    v_lshrrev_b32 v6, 4, v2
    v_add_u32 v6, s42, v6
    v_and_b32 v7, 7, v6
    v_lshlrev_b32 v7, 1, v7
    v_and_b32 v8, 15, v2
    v_xor_b32 v8, v8, v7
    v_mul_lo_u32 v6, v6, s43
    v_lshl_add_u32 v6, v8, 4, v6
    s_sub_u32 s42, s37, 0
    v_add_u32 v19, s42, v6
    s_lshl_b32 s42, s38, 4
    s_add_u32 s42, s42, 4
    v_lshrrev_b32 v6, 4, v2
    v_add_u32 v6, s42, v6
    v_and_b32 v7, 7, v6
    v_lshlrev_b32 v7, 1, v7
    v_and_b32 v8, 15, v2
    v_xor_b32 v8, v8, v7
    v_mul_lo_u32 v6, v6, s43
    v_lshl_add_u32 v6, v8, 4, v6
    s_sub_u32 s42, s37, 1024
    v_add_u32 v20, s42, v6
    s_lshl_b32 s42, s38, 4
    s_add_u32 s42, s42, 8
    v_lshrrev_b32 v6, 4, v2
    v_add_u32 v6, s42, v6
    v_and_b32 v7, 7, v6
    v_lshlrev_b32 v7, 1, v7
    v_and_b32 v8, 15, v2
    v_xor_b32 v8, v8, v7
    v_mul_lo_u32 v6, v6, s43
    v_lshl_add_u32 v6, v8, 4, v6
    s_sub_u32 s42, s37, 2048
    v_add_u32 v21, s42, v6
    s_lshl_b32 s42, s38, 4
    s_add_u32 s42, s42, 12
    v_lshrrev_b32 v6, 4, v2
    v_add_u32 v6, s42, v6
    v_and_b32 v7, 7, v6
    v_lshlrev_b32 v7, 1, v7
    v_and_b32 v8, 15, v2
    v_xor_b32 v8, v8, v7
    v_mul_lo_u32 v6, v6, s43
    v_lshl_add_u32 v6, v8, 4, v6
    s_sub_u32 s42, s37, 3072
    v_add_u32 v22, s42, v6
    s_mov_b32 s28, 0
    s_mov_b32 s29, 0
    s_add_u32 m0, s34, 0
    s_nop 0
    buffer_load_dwordx4 v16, s[8:11], s28 offen offset:0 lds
    buffer_load_dwordx4 v17, s[8:11], s28 offen offset:1024 lds
    buffer_load_dwordx4 v18, s[8:11], s28 offen offset:2048 lds
    s_add_u32 m0, s35, 0
    s_nop 0
    buffer_load_dwordx4 v19, s[12:15], s29 offen offset:0 lds
    buffer_load_dwordx4 v20, s[12:15], s29 offen offset:1024 lds
    buffer_load_dwordx4 v21, s[12:15], s29 offen offset:2048 lds
    buffer_load_dwordx4 v22, s[12:15], s29 offen offset:3072 lds
    s_add_u32 s28, s28, 12288
    s_add_u32 s29, s29, s53
    s_add_u32 m0, s34, 28672
    s_nop 0
    buffer_load_dwordx4 v16, s[8:11], s28 offen offset:0 lds
    buffer_load_dwordx4 v17, s[8:11], s28 offen offset:1024 lds
    buffer_load_dwordx4 v18, s[8:11], s28 offen offset:2048 lds
    s_add_u32 m0, s35, 28672
    s_nop 0
    buffer_load_dwordx4 v19, s[12:15], s29 offen offset:0 lds
    buffer_load_dwordx4 v20, s[12:15], s29 offen offset:1024 lds
    buffer_load_dwordx4 v21, s[12:15], s29 offen offset:2048 lds
    buffer_load_dwordx4 v22, s[12:15], s29 offen offset:3072 lds
    s_add_u32 s28, s28, 12288
    s_add_u32 s29, s29, s53
    s_add_u32 m0, s34, 57344
    s_nop 0
    buffer_load_dwordx4 v16, s[8:11], s28 offen offset:0 lds
    buffer_load_dwordx4 v17, s[8:11], s28 offen offset:1024 lds
    buffer_load_dwordx4 v18, s[8:11], s28 offen offset:2048 lds
    s_add_u32 m0, s35, 57344
    s_nop 0
    buffer_load_dwordx4 v19, s[12:15], s29 offen offset:0 lds
    buffer_load_dwordx4 v20, s[12:15], s29 offen offset:1024 lds
    buffer_load_dwordx4 v21, s[12:15], s29 offen offset:2048 lds
    buffer_load_dwordx4 v22, s[12:15], s29 offen offset:3072 lds
    s_add_u32 s28, s28, 12288
    s_add_u32 s29, s29, s53
    s_waitcnt vmcnt(14)
    s_barrier
    s_mov_b32 s30, 0
L_mlp1_kernel_lloop:
    s_waitcnt vmcnt(7)
    s_barrier
    s_add_u32 m0, s34, 86016
    s_nop 0
    buffer_load_dwordx4 v16, s[8:11], s28 offen offset:0 lds
    buffer_load_dwordx4 v17, s[8:11], s28 offen offset:1024 lds
    buffer_load_dwordx4 v18, s[8:11], s28 offen offset:2048 lds
    s_add_u32 m0, s35, 86016
    s_nop 0
    buffer_load_dwordx4 v19, s[12:15], s29 offen offset:0 lds
    buffer_load_dwordx4 v20, s[12:15], s29 offen offset:1024 lds
    buffer_load_dwordx4 v21, s[12:15], s29 offen offset:2048 lds
    buffer_load_dwordx4 v22, s[12:15], s29 offen offset:3072 lds
    s_add_u32 s28, s28, 12288
    s_add_u32 s29, s29, s53
    s_waitcnt vmcnt(7)
    s_barrier
    s_add_u32 m0, s34, 0
    s_nop 0
    buffer_load_dwordx4 v16, s[8:11], s28 offen offset:0 lds
    buffer_load_dwordx4 v17, s[8:11], s28 offen offset:1024 lds
    buffer_load_dwordx4 v18, s[8:11], s28 offen offset:2048 lds
    s_add_u32 m0, s35, 0
    s_nop 0
    buffer_load_dwordx4 v19, s[12:15], s29 offen offset:0 lds
    buffer_load_dwordx4 v20, s[12:15], s29 offen offset:1024 lds
    buffer_load_dwordx4 v21, s[12:15], s29 offen offset:2048 lds
    buffer_load_dwordx4 v22, s[12:15], s29 offen offset:3072 lds
    s_add_u32 s28, s28, 12288
    s_add_u32 s29, s29, s53
    s_waitcnt vmcnt(7)
    s_barrier
    s_add_u32 m0, s34, 28672
    s_nop 0
    buffer_load_dwordx4 v16, s[8:11], s28 offen offset:0 lds
    buffer_load_dwordx4 v17, s[8:11], s28 offen offset:1024 lds
    buffer_load_dwordx4 v18, s[8:11], s28 offen offset:2048 lds
    s_add_u32 m0, s35, 28672
    s_nop 0
    buffer_load_dwordx4 v19, s[12:15], s29 offen offset:0 lds
    buffer_load_dwordx4 v20, s[12:15], s29 offen offset:1024 lds
    buffer_load_dwordx4 v21, s[12:15], s29 offen offset:2048 lds
    buffer_load_dwordx4 v22, s[12:15], s29 offen offset:3072 lds
    s_add_u32 s28, s28, 12288
    s_add_u32 s29, s29, s53
    s_waitcnt vmcnt(7)
    s_barrier
    s_add_u32 m0, s34, 57344
    s_nop 0
    buffer_load_dwordx4 v16, s[8:11], s28 offen offset:0 lds
    buffer_load_dwordx4 v17, s[8:11], s28 offen offset:1024 lds
    buffer_load_dwordx4 v18, s[8:11], s28 offen offset:2048 lds
    s_add_u32 m0, s35, 57344
    s_nop 0
    buffer_load_dwordx4 v19, s[12:15], s29 offen offset:0 lds
    buffer_load_dwordx4 v20, s[12:15], s29 offen offset:1024 lds
    buffer_load_dwordx4 v21, s[12:15], s29 offen offset:2048 lds
    buffer_load_dwordx4 v22, s[12:15], s29 offen offset:3072 lds
    s_add_u32 s28, s28, 12288
    s_add_u32 s29, s29, s53
    s_add_u32 s30, s30, 1
    s_cmp_lt_u32 s30, 8
    s_cbranch_scc1 L_mlp1_kernel_lloop
    s_endpgm
L_mlp1_kernel_comp:
    s_and_b32 s39, s38, 1
    s_lshr_b32 s40, s38, 1
    s_add_u32 s16, s84, 14286848
    s_addc_u32 s17, s85, 0
    s_and_b32 s17, s17, 0xffff
    s_mov_b32 s18, 5308416
    s_mov_b32 s19, 0x20000
    s_mov_b32 s24, s74
    s_and_b32 s25, s75, 0xffff
    s_mov_b32 s26, 9216
    s_mov_b32 s27, 0x20000
    v_and_b32 v3, 15, v2
    v_lshrrev_b32 v4, 4, v2
    s_mul_i32 s41, s33, 128
    s_mul_i32 s42, s40, 64
    s_add_u32 s41, s41, s42
    v_add_u32 v5, s41, v3
    s_mul_i32 s42, s39, 96
    v_lshl_add_u32 v6, v4, 3, s42
    v_mul_u32_u24 v185, 1152, v5
    s_mul_i32 s42, s32, 192
    v_add3_u32 v185, v185, v6, s42
    v_mul_u32_u24 v184, 192, v5
    s_mul_i32 s42, s32, 884736
    v_add3_u32 v184, v184, v6, s42
    s_mov_b32 s44, 0
    s_mov_b32 s48, 0
    s_mov_b32 s45, 18432
    s_mov_b32 s49, 3072
    s_mov_b32 s46, 36864
    s_mov_b32 s50, 6144
    s_mov_b32 s47, 55296
    s_mov_b32 s51, 9216
    v_lshlrev_b32 v7, 1, v5
    buffer_load_ushort v180, v7, s[24:27], 0 offen offset:0
    buffer_load_ushort v181, v7, s[24:27], 0 offen offset:32
    buffer_load_ushort v182, v7, s[24:27], 0 offen offset:64
    buffer_load_ushort v183, v7, s[24:27], 0 offen offset:96
    v_lshrrev_b32 v5, 2, v2
    v_and_b32 v5, 3, v5
    v_lshl_add_u32 v6, v4, 2, v5
    v_and_b32 v7, 3, v2
    v_lshlrev_b32 v7, 3, v7
    v_and_b32 v8, 1, v4
    v_mul_u32_u24 v9, 192, v6
    v_add_u32 v9, v9, v7
    s_mul_i32 s42, s39, 3
    s_add_u32 s43, s42, 0
    v_xor_b32 v10, s43, v8
    v_lshl_add_u32 v23, v10, 5, v9
    v_add_u32 v26, 28672, v23
    v_add_u32 v29, 57344, v23
    v_add_u32 v32, 86016, v23
    s_add_u32 s43, s42, 1
    v_xor_b32 v10, s43, v8
    v_lshl_add_u32 v24, v10, 5, v9
    v_add_u32 v27, 28672, v24
    v_add_u32 v30, 57344, v24
    v_add_u32 v33, 86016, v24
    s_add_u32 s43, s42, 2
    v_xor_b32 v10, s43, v8
    v_lshl_add_u32 v25, v10, 5, v9
    v_add_u32 v28, 28672, v25
    v_add_u32 v31, 57344, v25
    v_add_u32 v34, 86016, v25
    v_mul_u32_u24 v9, 256, v6
    v_add_u32 v9, v9, v7
    v_add_u32 v9, 12288, v9
    v_and_b32 v11, 7, v6
    s_mul_i32 s42, s40, 4
    s_add_u32 s43, s42, 0
    v_xor_b32 v10, s43, v11
    v_lshl_add_u32 v35, v10, 5, v9
    v_add_u32 v39, 28672, v35
    v_add_u32 v43, 57344, v35
    v_add_u32 v47, 86016, v35
    s_add_u32 s43, s42, 1
    v_xor_b32 v10, s43, v11
    v_lshl_add_u32 v36, v10, 5, v9
    v_add_u32 v40, 28672, v36
    v_add_u32 v44, 57344, v36
    v_add_u32 v48, 86016, v36
    s_add_u32 s43, s42, 2
    v_xor_b32 v10, s43, v11
    v_lshl_add_u32 v37, v10, 5, v9
    v_add_u32 v41, 28672, v37
    v_add_u32 v45, 57344, v37
    v_add_u32 v49, 86016, v37
    s_add_u32 s43, s42, 3
    v_xor_b32 v10, s43, v11
    v_lshl_add_u32 v38, v10, 5, v9
    v_add_u32 v42, 28672, v38
    v_add_u32 v46, 57344, v38
    v_add_u32 v50, 86016, v38
    v_mov_b32 v108, 0
    v_mov_b32 v109, 0
    v_mov_b32 v110, 0
    v_mov_b32 v111, 0
    v_mov_b32 v112, 0
    v_mov_b32 v113, 0
    v_mov_b32 v114, 0
    v_mov_b32 v115, 0
    v_mov_b32 v116, 0
    v_mov_b32 v117, 0
    v_mov_b32 v118, 0
    v_mov_b32 v119, 0
    v_mov_b32 v120, 0
    v_mov_b32 v121, 0
    v_mov_b32 v122, 0
    v_mov_b32 v123, 0
    v_mov_b32 v124, 0
    v_mov_b32 v125, 0
    v_mov_b32 v126, 0
    v_mov_b32 v127, 0
    v_mov_b32 v128, 0
    v_mov_b32 v129, 0
    v_mov_b32 v130, 0
    v_mov_b32 v131, 0
    v_mov_b32 v132, 0
    v_mov_b32 v133, 0
    v_mov_b32 v134, 0
    v_mov_b32 v135, 0
    v_mov_b32 v136, 0
    v_mov_b32 v137, 0
    v_mov_b32 v138, 0
    v_mov_b32 v139, 0
    v_mov_b32 v140, 0
    v_mov_b32 v141, 0
    v_mov_b32 v142, 0
    v_mov_b32 v143, 0
    v_mov_b32 v144, 0
    v_mov_b32 v145, 0
    v_mov_b32 v146, 0
    v_mov_b32 v147, 0
    v_mov_b32 v148, 0
    v_mov_b32 v149, 0
    v_mov_b32 v150, 0
    v_mov_b32 v151, 0
    v_mov_b32 v152, 0
    v_mov_b32 v153, 0
    v_mov_b32 v154, 0
    v_mov_b32 v155, 0
    s_barrier
    ds_read_b64_tr_b16 v[52:53], v23 offset:0
    ds_read_b64_tr_b16 v[54:55], v23 offset:3072
    ds_read_b64_tr_b16 v[64:65], v35 offset:0
    ds_read_b64_tr_b16 v[66:67], v35 offset:4096
    ds_read_b64_tr_b16 v[56:57], v24 offset:0
    ds_read_b64_tr_b16 v[58:59], v24 offset:3072
    ds_read_b64_tr_b16 v[60:61], v25 offset:0
    ds_read_b64_tr_b16 v[62:63], v25 offset:3072
    ds_read_b64_tr_b16 v[68:69], v36 offset:0
    ds_read_b64_tr_b16 v[70:71], v36 offset:4096
    ds_read_b64_tr_b16 v[72:73], v37 offset:0
    ds_read_b64_tr_b16 v[74:75], v37 offset:4096
    ds_read_b64_tr_b16 v[76:77], v38 offset:0
    ds_read_b64_tr_b16 v[78:79], v38 offset:4096
    s_mov_b32 s30, 0
L_mlp1_kernel_loop:
    s_waitcnt lgkmcnt(10)
    v_mfma_f32_16x16x32_bf16 v[108:111], v[52:55], v[64:67], v[108:111]
    ds_read_b64_tr_b16 v[80:81], v23 offset:6144
    ds_read_b64_tr_b16 v[82:83], v23 offset:9216
    s_waitcnt lgkmcnt(10)
    v_mfma_f32_16x16x32_bf16 v[112:115], v[56:59], v[64:67], v[112:115]
    ds_read_b64_tr_b16 v[92:93], v35 offset:8192
    ds_read_b64_tr_b16 v[94:95], v35 offset:12288
    s_waitcnt lgkmcnt(10)
    v_mfma_f32_16x16x32_bf16 v[116:119], v[60:63], v[64:67], v[116:119]
    ds_read_b64_tr_b16 v[84:85], v24 offset:6144
    s_waitcnt lgkmcnt(9)
    v_mfma_f32_16x16x32_bf16 v[120:123], v[52:55], v[68:71], v[120:123]
    ds_read_b64_tr_b16 v[86:87], v24 offset:9216
    v_mfma_f32_16x16x32_bf16 v[124:127], v[56:59], v[68:71], v[124:127]
    ds_read_b64_tr_b16 v[88:89], v25 offset:6144
    v_mfma_f32_16x16x32_bf16 v[128:131], v[60:63], v[68:71], v[128:131]
    ds_read_b64_tr_b16 v[90:91], v25 offset:9216
    s_waitcnt lgkmcnt(10)
    v_mfma_f32_16x16x32_bf16 v[132:135], v[52:55], v[72:75], v[132:135]
    ds_read_b64_tr_b16 v[96:97], v36 offset:8192
    v_mfma_f32_16x16x32_bf16 v[136:139], v[56:59], v[72:75], v[136:139]
    ds_read_b64_tr_b16 v[98:99], v36 offset:12288
    v_mfma_f32_16x16x32_bf16 v[140:143], v[60:63], v[72:75], v[140:143]
    ds_read_b64_tr_b16 v[100:101], v37 offset:8192
    s_waitcnt lgkmcnt(11)
    v_mfma_f32_16x16x32_bf16 v[144:147], v[52:55], v[76:79], v[144:147]
    ds_read_b64_tr_b16 v[102:103], v37 offset:12288
    v_mfma_f32_16x16x32_bf16 v[148:151], v[56:59], v[76:79], v[148:151]
    ds_read_b64_tr_b16 v[104:105], v38 offset:8192
    v_mfma_f32_16x16x32_bf16 v[152:155], v[60:63], v[76:79], v[152:155]
    ds_read_b64_tr_b16 v[106:107], v38 offset:12288
    s_barrier
    s_waitcnt lgkmcnt(10)
    v_mfma_f32_16x16x32_bf16 v[108:111], v[80:83], v[92:95], v[108:111]
    ds_read_b64_tr_b16 v[52:53], v26 offset:0
    ds_read_b64_tr_b16 v[54:55], v26 offset:3072
    s_waitcnt lgkmcnt(10)
    v_mfma_f32_16x16x32_bf16 v[112:115], v[84:87], v[92:95], v[112:115]
    ds_read_b64_tr_b16 v[64:65], v39 offset:0
    ds_read_b64_tr_b16 v[66:67], v39 offset:4096
    s_waitcnt lgkmcnt(10)
    v_mfma_f32_16x16x32_bf16 v[116:119], v[88:91], v[92:95], v[116:119]
    ds_read_b64_tr_b16 v[56:57], v27 offset:0
    s_waitcnt lgkmcnt(9)
    v_mfma_f32_16x16x32_bf16 v[120:123], v[80:83], v[96:99], v[120:123]
    ds_read_b64_tr_b16 v[58:59], v27 offset:3072
    v_mfma_f32_16x16x32_bf16 v[124:127], v[84:87], v[96:99], v[124:127]
    ds_read_b64_tr_b16 v[60:61], v28 offset:0
    v_mfma_f32_16x16x32_bf16 v[128:131], v[88:91], v[96:99], v[128:131]
    ds_read_b64_tr_b16 v[62:63], v28 offset:3072
    s_waitcnt lgkmcnt(10)
    v_mfma_f32_16x16x32_bf16 v[132:135], v[80:83], v[100:103], v[132:135]
    ds_read_b64_tr_b16 v[68:69], v40 offset:0
    v_mfma_f32_16x16x32_bf16 v[136:139], v[84:87], v[100:103], v[136:139]
    ds_read_b64_tr_b16 v[70:71], v40 offset:4096
    v_mfma_f32_16x16x32_bf16 v[140:143], v[88:91], v[100:103], v[140:143]
    ds_read_b64_tr_b16 v[72:73], v41 offset:0
    s_waitcnt lgkmcnt(11)
    v_mfma_f32_16x16x32_bf16 v[144:147], v[80:83], v[104:107], v[144:147]
    ds_read_b64_tr_b16 v[74:75], v41 offset:4096
    v_mfma_f32_16x16x32_bf16 v[148:151], v[84:87], v[104:107], v[148:151]
    ds_read_b64_tr_b16 v[76:77], v42 offset:0
    v_mfma_f32_16x16x32_bf16 v[152:155], v[88:91], v[104:107], v[152:155]
    ds_read_b64_tr_b16 v[78:79], v42 offset:4096
    s_waitcnt lgkmcnt(10)
    v_mfma_f32_16x16x32_bf16 v[108:111], v[52:55], v[64:67], v[108:111]
    ds_read_b64_tr_b16 v[80:81], v26 offset:6144
    ds_read_b64_tr_b16 v[82:83], v26 offset:9216
    s_waitcnt lgkmcnt(10)
    v_mfma_f32_16x16x32_bf16 v[112:115], v[56:59], v[64:67], v[112:115]
    ds_read_b64_tr_b16 v[92:93], v39 offset:8192
    ds_read_b64_tr_b16 v[94:95], v39 offset:12288
    s_waitcnt lgkmcnt(10)
    v_mfma_f32_16x16x32_bf16 v[116:119], v[60:63], v[64:67], v[116:119]
    ds_read_b64_tr_b16 v[84:85], v27 offset:6144
    s_waitcnt lgkmcnt(9)
    v_mfma_f32_16x16x32_bf16 v[120:123], v[52:55], v[68:71], v[120:123]
    ds_read_b64_tr_b16 v[86:87], v27 offset:9216
    v_mfma_f32_16x16x32_bf16 v[124:127], v[56:59], v[68:71], v[124:127]
    ds_read_b64_tr_b16 v[88:89], v28 offset:6144
    v_mfma_f32_16x16x32_bf16 v[128:131], v[60:63], v[68:71], v[128:131]
    ds_read_b64_tr_b16 v[90:91], v28 offset:9216
    s_waitcnt lgkmcnt(10)
    v_mfma_f32_16x16x32_bf16 v[132:135], v[52:55], v[72:75], v[132:135]
    ds_read_b64_tr_b16 v[96:97], v40 offset:8192
    v_mfma_f32_16x16x32_bf16 v[136:139], v[56:59], v[72:75], v[136:139]
    ds_read_b64_tr_b16 v[98:99], v40 offset:12288
    v_mfma_f32_16x16x32_bf16 v[140:143], v[60:63], v[72:75], v[140:143]
    ds_read_b64_tr_b16 v[100:101], v41 offset:8192
    s_waitcnt lgkmcnt(11)
    v_mfma_f32_16x16x32_bf16 v[144:147], v[52:55], v[76:79], v[144:147]
    ds_read_b64_tr_b16 v[102:103], v41 offset:12288
    v_mfma_f32_16x16x32_bf16 v[148:151], v[56:59], v[76:79], v[148:151]
    ds_read_b64_tr_b16 v[104:105], v42 offset:8192
    v_mfma_f32_16x16x32_bf16 v[152:155], v[60:63], v[76:79], v[152:155]
    ds_read_b64_tr_b16 v[106:107], v42 offset:12288
    s_barrier
    s_waitcnt lgkmcnt(10)
    v_mfma_f32_16x16x32_bf16 v[108:111], v[80:83], v[92:95], v[108:111]
    ds_read_b64_tr_b16 v[52:53], v29 offset:0
    ds_read_b64_tr_b16 v[54:55], v29 offset:3072
    s_waitcnt lgkmcnt(10)
    v_mfma_f32_16x16x32_bf16 v[112:115], v[84:87], v[92:95], v[112:115]
    ds_read_b64_tr_b16 v[64:65], v43 offset:0
    ds_read_b64_tr_b16 v[66:67], v43 offset:4096
    s_waitcnt lgkmcnt(10)
    v_mfma_f32_16x16x32_bf16 v[116:119], v[88:91], v[92:95], v[116:119]
    ds_read_b64_tr_b16 v[56:57], v30 offset:0
    s_waitcnt lgkmcnt(9)
    v_mfma_f32_16x16x32_bf16 v[120:123], v[80:83], v[96:99], v[120:123]
    ds_read_b64_tr_b16 v[58:59], v30 offset:3072
    v_mfma_f32_16x16x32_bf16 v[124:127], v[84:87], v[96:99], v[124:127]
    ds_read_b64_tr_b16 v[60:61], v31 offset:0
    v_mfma_f32_16x16x32_bf16 v[128:131], v[88:91], v[96:99], v[128:131]
    ds_read_b64_tr_b16 v[62:63], v31 offset:3072
    s_waitcnt lgkmcnt(10)
    v_mfma_f32_16x16x32_bf16 v[132:135], v[80:83], v[100:103], v[132:135]
    ds_read_b64_tr_b16 v[68:69], v44 offset:0
    v_mfma_f32_16x16x32_bf16 v[136:139], v[84:87], v[100:103], v[136:139]
    ds_read_b64_tr_b16 v[70:71], v44 offset:4096
    v_mfma_f32_16x16x32_bf16 v[140:143], v[88:91], v[100:103], v[140:143]
    ds_read_b64_tr_b16 v[72:73], v45 offset:0
    s_waitcnt lgkmcnt(11)
    v_mfma_f32_16x16x32_bf16 v[144:147], v[80:83], v[104:107], v[144:147]
    ds_read_b64_tr_b16 v[74:75], v45 offset:4096
    v_mfma_f32_16x16x32_bf16 v[148:151], v[84:87], v[104:107], v[148:151]
    ds_read_b64_tr_b16 v[76:77], v46 offset:0
    v_mfma_f32_16x16x32_bf16 v[152:155], v[88:91], v[104:107], v[152:155]
    ds_read_b64_tr_b16 v[78:79], v46 offset:4096
    s_waitcnt lgkmcnt(10)
    v_mfma_f32_16x16x32_bf16 v[108:111], v[52:55], v[64:67], v[108:111]
    ds_read_b64_tr_b16 v[80:81], v29 offset:6144
    ds_read_b64_tr_b16 v[82:83], v29 offset:9216
    s_waitcnt lgkmcnt(10)
    v_mfma_f32_16x16x32_bf16 v[112:115], v[56:59], v[64:67], v[112:115]
    ds_read_b64_tr_b16 v[92:93], v43 offset:8192
    ds_read_b64_tr_b16 v[94:95], v43 offset:12288
    s_waitcnt lgkmcnt(10)
    v_mfma_f32_16x16x32_bf16 v[116:119], v[60:63], v[64:67], v[116:119]
    ds_read_b64_tr_b16 v[84:85], v30 offset:6144
    s_waitcnt lgkmcnt(9)
    v_mfma_f32_16x16x32_bf16 v[120:123], v[52:55], v[68:71], v[120:123]
    ds_read_b64_tr_b16 v[86:87], v30 offset:9216
    v_mfma_f32_16x16x32_bf16 v[124:127], v[56:59], v[68:71], v[124:127]
    ds_read_b64_tr_b16 v[88:89], v31 offset:6144
    v_mfma_f32_16x16x32_bf16 v[128:131], v[60:63], v[68:71], v[128:131]
    ds_read_b64_tr_b16 v[90:91], v31 offset:9216
    s_waitcnt lgkmcnt(10)
    v_mfma_f32_16x16x32_bf16 v[132:135], v[52:55], v[72:75], v[132:135]
    ds_read_b64_tr_b16 v[96:97], v44 offset:8192
    v_mfma_f32_16x16x32_bf16 v[136:139], v[56:59], v[72:75], v[136:139]
    ds_read_b64_tr_b16 v[98:99], v44 offset:12288
    v_mfma_f32_16x16x32_bf16 v[140:143], v[60:63], v[72:75], v[140:143]
    ds_read_b64_tr_b16 v[100:101], v45 offset:8192
    s_waitcnt lgkmcnt(11)
    v_mfma_f32_16x16x32_bf16 v[144:147], v[52:55], v[76:79], v[144:147]
    ds_read_b64_tr_b16 v[102:103], v45 offset:12288
    v_mfma_f32_16x16x32_bf16 v[148:151], v[56:59], v[76:79], v[148:151]
    ds_read_b64_tr_b16 v[104:105], v46 offset:8192
    v_mfma_f32_16x16x32_bf16 v[152:155], v[60:63], v[76:79], v[152:155]
    ds_read_b64_tr_b16 v[106:107], v46 offset:12288
    s_barrier
    s_waitcnt lgkmcnt(10)
    v_mfma_f32_16x16x32_bf16 v[108:111], v[80:83], v[92:95], v[108:111]
    ds_read_b64_tr_b16 v[52:53], v32 offset:0
    ds_read_b64_tr_b16 v[54:55], v32 offset:3072
    s_waitcnt lgkmcnt(10)
    v_mfma_f32_16x16x32_bf16 v[112:115], v[84:87], v[92:95], v[112:115]
    ds_read_b64_tr_b16 v[64:65], v47 offset:0
    ds_read_b64_tr_b16 v[66:67], v47 offset:4096
    s_waitcnt lgkmcnt(10)
    v_mfma_f32_16x16x32_bf16 v[116:119], v[88:91], v[92:95], v[116:119]
    ds_read_b64_tr_b16 v[56:57], v33 offset:0
    s_waitcnt lgkmcnt(9)
    v_mfma_f32_16x16x32_bf16 v[120:123], v[80:83], v[96:99], v[120:123]
    ds_read_b64_tr_b16 v[58:59], v33 offset:3072
    v_mfma_f32_16x16x32_bf16 v[124:127], v[84:87], v[96:99], v[124:127]
    ds_read_b64_tr_b16 v[60:61], v34 offset:0
    v_mfma_f32_16x16x32_bf16 v[128:131], v[88:91], v[96:99], v[128:131]
    ds_read_b64_tr_b16 v[62:63], v34 offset:3072
    s_waitcnt lgkmcnt(10)
    v_mfma_f32_16x16x32_bf16 v[132:135], v[80:83], v[100:103], v[132:135]
    ds_read_b64_tr_b16 v[68:69], v48 offset:0
    v_mfma_f32_16x16x32_bf16 v[136:139], v[84:87], v[100:103], v[136:139]
    ds_read_b64_tr_b16 v[70:71], v48 offset:4096
    v_mfma_f32_16x16x32_bf16 v[140:143], v[88:91], v[100:103], v[140:143]
    ds_read_b64_tr_b16 v[72:73], v49 offset:0
    s_waitcnt lgkmcnt(11)
    v_mfma_f32_16x16x32_bf16 v[144:147], v[80:83], v[104:107], v[144:147]
    ds_read_b64_tr_b16 v[74:75], v49 offset:4096
    v_mfma_f32_16x16x32_bf16 v[148:151], v[84:87], v[104:107], v[148:151]
    ds_read_b64_tr_b16 v[76:77], v50 offset:0
    v_mfma_f32_16x16x32_bf16 v[152:155], v[88:91], v[104:107], v[152:155]
    ds_read_b64_tr_b16 v[78:79], v50 offset:4096
    s_waitcnt lgkmcnt(10)
    v_mfma_f32_16x16x32_bf16 v[108:111], v[52:55], v[64:67], v[108:111]
    ds_read_b64_tr_b16 v[80:81], v32 offset:6144
    ds_read_b64_tr_b16 v[82:83], v32 offset:9216
    s_waitcnt lgkmcnt(10)
    v_mfma_f32_16x16x32_bf16 v[112:115], v[56:59], v[64:67], v[112:115]
    ds_read_b64_tr_b16 v[92:93], v47 offset:8192
    ds_read_b64_tr_b16 v[94:95], v47 offset:12288
    s_waitcnt lgkmcnt(10)
    v_mfma_f32_16x16x32_bf16 v[116:119], v[60:63], v[64:67], v[116:119]
    ds_read_b64_tr_b16 v[84:85], v33 offset:6144
    s_waitcnt lgkmcnt(9)
    v_mfma_f32_16x16x32_bf16 v[120:123], v[52:55], v[68:71], v[120:123]
    ds_read_b64_tr_b16 v[86:87], v33 offset:9216
    v_mfma_f32_16x16x32_bf16 v[124:127], v[56:59], v[68:71], v[124:127]
    ds_read_b64_tr_b16 v[88:89], v34 offset:6144
    v_mfma_f32_16x16x32_bf16 v[128:131], v[60:63], v[68:71], v[128:131]
    ds_read_b64_tr_b16 v[90:91], v34 offset:9216
    s_waitcnt lgkmcnt(10)
    v_mfma_f32_16x16x32_bf16 v[132:135], v[52:55], v[72:75], v[132:135]
    ds_read_b64_tr_b16 v[96:97], v48 offset:8192
    v_mfma_f32_16x16x32_bf16 v[136:139], v[56:59], v[72:75], v[136:139]
    ds_read_b64_tr_b16 v[98:99], v48 offset:12288
    v_mfma_f32_16x16x32_bf16 v[140:143], v[60:63], v[72:75], v[140:143]
    ds_read_b64_tr_b16 v[100:101], v49 offset:8192
    s_waitcnt lgkmcnt(11)
    v_mfma_f32_16x16x32_bf16 v[144:147], v[52:55], v[76:79], v[144:147]
    ds_read_b64_tr_b16 v[102:103], v49 offset:12288
    v_mfma_f32_16x16x32_bf16 v[148:151], v[56:59], v[76:79], v[148:151]
    ds_read_b64_tr_b16 v[104:105], v50 offset:8192
    v_mfma_f32_16x16x32_bf16 v[152:155], v[60:63], v[76:79], v[152:155]
    ds_read_b64_tr_b16 v[106:107], v50 offset:12288
    s_barrier
    s_waitcnt lgkmcnt(10)
    v_mfma_f32_16x16x32_bf16 v[108:111], v[80:83], v[92:95], v[108:111]
    ds_read_b64_tr_b16 v[52:53], v23 offset:0
    ds_read_b64_tr_b16 v[54:55], v23 offset:3072
    s_waitcnt lgkmcnt(10)
    v_mfma_f32_16x16x32_bf16 v[112:115], v[84:87], v[92:95], v[112:115]
    ds_read_b64_tr_b16 v[64:65], v35 offset:0
    ds_read_b64_tr_b16 v[66:67], v35 offset:4096
    s_waitcnt lgkmcnt(10)
    v_mfma_f32_16x16x32_bf16 v[116:119], v[88:91], v[92:95], v[116:119]
    ds_read_b64_tr_b16 v[56:57], v24 offset:0
    s_waitcnt lgkmcnt(9)
    v_mfma_f32_16x16x32_bf16 v[120:123], v[80:83], v[96:99], v[120:123]
    ds_read_b64_tr_b16 v[58:59], v24 offset:3072
    v_mfma_f32_16x16x32_bf16 v[124:127], v[84:87], v[96:99], v[124:127]
    ds_read_b64_tr_b16 v[60:61], v25 offset:0
    v_mfma_f32_16x16x32_bf16 v[128:131], v[88:91], v[96:99], v[128:131]
    ds_read_b64_tr_b16 v[62:63], v25 offset:3072
    s_waitcnt lgkmcnt(10)
    v_mfma_f32_16x16x32_bf16 v[132:135], v[80:83], v[100:103], v[132:135]
    ds_read_b64_tr_b16 v[68:69], v36 offset:0
    v_mfma_f32_16x16x32_bf16 v[136:139], v[84:87], v[100:103], v[136:139]
    ds_read_b64_tr_b16 v[70:71], v36 offset:4096
    v_mfma_f32_16x16x32_bf16 v[140:143], v[88:91], v[100:103], v[140:143]
    ds_read_b64_tr_b16 v[72:73], v37 offset:0
    s_waitcnt lgkmcnt(11)
    v_mfma_f32_16x16x32_bf16 v[144:147], v[80:83], v[104:107], v[144:147]
    ds_read_b64_tr_b16 v[74:75], v37 offset:4096
    v_mfma_f32_16x16x32_bf16 v[148:151], v[84:87], v[104:107], v[148:151]
    ds_read_b64_tr_b16 v[76:77], v38 offset:0
    v_mfma_f32_16x16x32_bf16 v[152:155], v[88:91], v[104:107], v[152:155]
    ds_read_b64_tr_b16 v[78:79], v38 offset:4096
    s_add_u32 s30, s30, 1
    s_cmp_lt_u32 s30, 8
    s_cbranch_scc1 L_mlp1_kernel_loop
    s_waitcnt vmcnt(0) lgkmcnt(0)
    s_mov_b32 s42, 0xc0135761
    s_mov_b32 s43, 0xbdd2d3e8
    v_mov_b32 v203, s42
    v_lshlrev_b32 v180, 16, v180
    v_add_f32 v108, v108, v180
    v_add_f32 v109, v109, v180
    v_add_f32 v110, v110, v180
    v_add_f32 v111, v111, v180
    v_mul_f32 v188, v108, v108
    v_mul_f32 v189, v109, v109
    v_mul_f32 v190, v110, v110
    v_mul_f32 v191, v111, v111
    v_fma_f32 v188, v188, s43, v203
    v_fma_f32 v189, v189, s43, v203
    v_fma_f32 v190, v190, s43, v203
    v_fma_f32 v191, v191, s43, v203
    v_mul_f32 v188, v188, v108
    v_mul_f32 v189, v189, v109
    v_mul_f32 v190, v190, v110
    v_mul_f32 v191, v191, v111
    v_exp_f32 v188, v188
    v_exp_f32 v189, v189
    v_exp_f32 v190, v190
    v_exp_f32 v191, v191
    v_add_f32 v188, 1.0, v188
    v_add_f32 v189, 1.0, v189
    v_add_f32 v190, 1.0, v190
    v_add_f32 v191, 1.0, v191
    v_rcp_f32 v188, v188
    v_rcp_f32 v189, v189
    v_rcp_f32 v190, v190
    v_rcp_f32 v191, v191
    v_mul_f32 v108, v108, v188
    v_mul_f32 v109, v109, v189
    v_mul_f32 v110, v110, v190
    v_mul_f32 v111, v111, v191
    v_cvt_pk_bf16_f32 v192, v108, v109
    v_cvt_pk_bf16_f32 v193, v110, v111
    buffer_store_dwordx2 v[192:193], v184, s[16:19], s48 offen offset:0
    v_add_f32 v112, v112, v180
    v_add_f32 v113, v113, v180
    v_add_f32 v114, v114, v180
    v_add_f32 v115, v115, v180
    v_mul_f32 v188, v112, v112
    v_mul_f32 v189, v113, v113
    v_mul_f32 v190, v114, v114
    v_mul_f32 v191, v115, v115
    v_fma_f32 v188, v188, s43, v203
    v_fma_f32 v189, v189, s43, v203
    v_fma_f32 v190, v190, s43, v203
    v_fma_f32 v191, v191, s43, v203
    v_mul_f32 v188, v188, v112
    v_mul_f32 v189, v189, v113
    v_mul_f32 v190, v190, v114
    v_mul_f32 v191, v191, v115
    v_exp_f32 v188, v188
    v_exp_f32 v189, v189
    v_exp_f32 v190, v190
    v_exp_f32 v191, v191
    v_add_f32 v188, 1.0, v188
    v_add_f32 v189, 1.0, v189
    v_add_f32 v190, 1.0, v190
    v_add_f32 v191, 1.0, v191
    v_rcp_f32 v188, v188
    v_rcp_f32 v189, v189
    v_rcp_f32 v190, v190
    v_rcp_f32 v191, v191
    v_mul_f32 v112, v112, v188
    v_mul_f32 v113, v113, v189
    v_mul_f32 v114, v114, v190
    v_mul_f32 v115, v115, v191
    v_cvt_pk_bf16_f32 v194, v112, v113
    v_cvt_pk_bf16_f32 v195, v114, v115
    buffer_store_dwordx2 v[194:195], v184, s[16:19], s48 offen offset:32
    v_add_f32 v116, v116, v180
    v_add_f32 v117, v117, v180
    v_add_f32 v118, v118, v180
    v_add_f32 v119, v119, v180
    v_mul_f32 v188, v116, v116
    v_mul_f32 v189, v117, v117
    v_mul_f32 v190, v118, v118
    v_mul_f32 v191, v119, v119
    v_fma_f32 v188, v188, s43, v203
    v_fma_f32 v189, v189, s43, v203
    v_fma_f32 v190, v190, s43, v203
    v_fma_f32 v191, v191, s43, v203
    v_mul_f32 v188, v188, v116
    v_mul_f32 v189, v189, v117
    v_mul_f32 v190, v190, v118
    v_mul_f32 v191, v191, v119
    v_exp_f32 v188, v188
    v_exp_f32 v189, v189
    v_exp_f32 v190, v190
    v_exp_f32 v191, v191
    v_add_f32 v188, 1.0, v188
    v_add_f32 v189, 1.0, v189
    v_add_f32 v190, 1.0, v190
    v_add_f32 v191, 1.0, v191
    v_rcp_f32 v188, v188
    v_rcp_f32 v189, v189
    v_rcp_f32 v190, v190
    v_rcp_f32 v191, v191
    v_mul_f32 v116, v116, v188
    v_mul_f32 v117, v117, v189
    v_mul_f32 v118, v118, v190
    v_mul_f32 v119, v119, v191
    v_cvt_pk_bf16_f32 v196, v116, v117
    v_cvt_pk_bf16_f32 v197, v118, v119
    buffer_store_dwordx2 v[196:197], v184, s[16:19], s48 offen offset:64
    v_lshlrev_b32 v181, 16, v181
    v_add_f32 v120, v120, v181
    v_add_f32 v121, v121, v181
    v_add_f32 v122, v122, v181
    v_add_f32 v123, v123, v181
    v_mul_f32 v188, v120, v120
    v_mul_f32 v189, v121, v121
    v_mul_f32 v190, v122, v122
    v_mul_f32 v191, v123, v123
    v_fma_f32 v188, v188, s43, v203
    v_fma_f32 v189, v189, s43, v203
    v_fma_f32 v190, v190, s43, v203
    v_fma_f32 v191, v191, s43, v203
    v_mul_f32 v188, v188, v120
    v_mul_f32 v189, v189, v121
    v_mul_f32 v190, v190, v122
    v_mul_f32 v191, v191, v123
    v_exp_f32 v188, v188
    v_exp_f32 v189, v189
    v_exp_f32 v190, v190
    v_exp_f32 v191, v191
    v_add_f32 v188, 1.0, v188
    v_add_f32 v189, 1.0, v189
    v_add_f32 v190, 1.0, v190
    v_add_f32 v191, 1.0, v191
    v_rcp_f32 v188, v188
    v_rcp_f32 v189, v189
    v_rcp_f32 v190, v190
    v_rcp_f32 v191, v191
    v_mul_f32 v120, v120, v188
    v_mul_f32 v121, v121, v189
    v_mul_f32 v122, v122, v190
    v_mul_f32 v123, v123, v191
    v_cvt_pk_bf16_f32 v192, v120, v121
    v_cvt_pk_bf16_f32 v193, v122, v123
    buffer_store_dwordx2 v[192:193], v184, s[16:19], s49 offen offset:0
    v_add_f32 v124, v124, v181
    v_add_f32 v125, v125, v181
    v_add_f32 v126, v126, v181
    v_add_f32 v127, v127, v181
    v_mul_f32 v188, v124, v124
    v_mul_f32 v189, v125, v125
    v_mul_f32 v190, v126, v126
    v_mul_f32 v191, v127, v127
    v_fma_f32 v188, v188, s43, v203
    v_fma_f32 v189, v189, s43, v203
    v_fma_f32 v190, v190, s43, v203
    v_fma_f32 v191, v191, s43, v203
    v_mul_f32 v188, v188, v124
    v_mul_f32 v189, v189, v125
    v_mul_f32 v190, v190, v126
    v_mul_f32 v191, v191, v127
    v_exp_f32 v188, v188
    v_exp_f32 v189, v189
    v_exp_f32 v190, v190
    v_exp_f32 v191, v191
    v_add_f32 v188, 1.0, v188
    v_add_f32 v189, 1.0, v189
    v_add_f32 v190, 1.0, v190
    v_add_f32 v191, 1.0, v191
    v_rcp_f32 v188, v188
    v_rcp_f32 v189, v189
    v_rcp_f32 v190, v190
    v_rcp_f32 v191, v191
    v_mul_f32 v124, v124, v188
    v_mul_f32 v125, v125, v189
    v_mul_f32 v126, v126, v190
    v_mul_f32 v127, v127, v191
    v_cvt_pk_bf16_f32 v194, v124, v125
    v_cvt_pk_bf16_f32 v195, v126, v127
    buffer_store_dwordx2 v[194:195], v184, s[16:19], s49 offen offset:32
    v_add_f32 v128, v128, v181
    v_add_f32 v129, v129, v181
    v_add_f32 v130, v130, v181
    v_add_f32 v131, v131, v181
    v_mul_f32 v188, v128, v128
    v_mul_f32 v189, v129, v129
    v_mul_f32 v190, v130, v130
    v_mul_f32 v191, v131, v131
    v_fma_f32 v188, v188, s43, v203
    v_fma_f32 v189, v189, s43, v203
    v_fma_f32 v190, v190, s43, v203
    v_fma_f32 v191, v191, s43, v203
    v_mul_f32 v188, v188, v128
    v_mul_f32 v189, v189, v129
    v_mul_f32 v190, v190, v130
    v_mul_f32 v191, v191, v131
    v_exp_f32 v188, v188
    v_exp_f32 v189, v189
    v_exp_f32 v190, v190
    v_exp_f32 v191, v191
    v_add_f32 v188, 1.0, v188
    v_add_f32 v189, 1.0, v189
    v_add_f32 v190, 1.0, v190
    v_add_f32 v191, 1.0, v191
    v_rcp_f32 v188, v188
    v_rcp_f32 v189, v189
    v_rcp_f32 v190, v190
    v_rcp_f32 v191, v191
    v_mul_f32 v128, v128, v188
    v_mul_f32 v129, v129, v189
    v_mul_f32 v130, v130, v190
    v_mul_f32 v131, v131, v191
    v_cvt_pk_bf16_f32 v196, v128, v129
    v_cvt_pk_bf16_f32 v197, v130, v131
    buffer_store_dwordx2 v[196:197], v184, s[16:19], s49 offen offset:64
    v_lshlrev_b32 v182, 16, v182
    v_add_f32 v132, v132, v182
    v_add_f32 v133, v133, v182
    v_add_f32 v134, v134, v182
    v_add_f32 v135, v135, v182
    v_mul_f32 v188, v132, v132
    v_mul_f32 v189, v133, v133
    v_mul_f32 v190, v134, v134
    v_mul_f32 v191, v135, v135
    v_fma_f32 v188, v188, s43, v203
    v_fma_f32 v189, v189, s43, v203
    v_fma_f32 v190, v190, s43, v203
    v_fma_f32 v191, v191, s43, v203
    v_mul_f32 v188, v188, v132
    v_mul_f32 v189, v189, v133
    v_mul_f32 v190, v190, v134
    v_mul_f32 v191, v191, v135
    v_exp_f32 v188, v188
    v_exp_f32 v189, v189
    v_exp_f32 v190, v190
    v_exp_f32 v191, v191
    v_add_f32 v188, 1.0, v188
    v_add_f32 v189, 1.0, v189
    v_add_f32 v190, 1.0, v190
    v_add_f32 v191, 1.0, v191
    v_rcp_f32 v188, v188
    v_rcp_f32 v189, v189
    v_rcp_f32 v190, v190
    v_rcp_f32 v191, v191
    v_mul_f32 v132, v132, v188
    v_mul_f32 v133, v133, v189
    v_mul_f32 v134, v134, v190
    v_mul_f32 v135, v135, v191
    v_cvt_pk_bf16_f32 v192, v132, v133
    v_cvt_pk_bf16_f32 v193, v134, v135
    buffer_store_dwordx2 v[192:193], v184, s[16:19], s50 offen offset:0
    v_add_f32 v136, v136, v182
    v_add_f32 v137, v137, v182
    v_add_f32 v138, v138, v182
    v_add_f32 v139, v139, v182
    v_mul_f32 v188, v136, v136
    v_mul_f32 v189, v137, v137
    v_mul_f32 v190, v138, v138
    v_mul_f32 v191, v139, v139
    v_fma_f32 v188, v188, s43, v203
    v_fma_f32 v189, v189, s43, v203
    v_fma_f32 v190, v190, s43, v203
    v_fma_f32 v191, v191, s43, v203
    v_mul_f32 v188, v188, v136
    v_mul_f32 v189, v189, v137
    v_mul_f32 v190, v190, v138
    v_mul_f32 v191, v191, v139
    v_exp_f32 v188, v188
    v_exp_f32 v189, v189
    v_exp_f32 v190, v190
    v_exp_f32 v191, v191
    v_add_f32 v188, 1.0, v188
    v_add_f32 v189, 1.0, v189
    v_add_f32 v190, 1.0, v190
    v_add_f32 v191, 1.0, v191
    v_rcp_f32 v188, v188
    v_rcp_f32 v189, v189
    v_rcp_f32 v190, v190
    v_rcp_f32 v191, v191
    v_mul_f32 v136, v136, v188
    v_mul_f32 v137, v137, v189
    v_mul_f32 v138, v138, v190
    v_mul_f32 v139, v139, v191
    v_cvt_pk_bf16_f32 v194, v136, v137
    v_cvt_pk_bf16_f32 v195, v138, v139
    buffer_store_dwordx2 v[194:195], v184, s[16:19], s50 offen offset:32
    v_add_f32 v140, v140, v182
    v_add_f32 v141, v141, v182
    v_add_f32 v142, v142, v182
    v_add_f32 v143, v143, v182
    v_mul_f32 v188, v140, v140
    v_mul_f32 v189, v141, v141
    v_mul_f32 v190, v142, v142
    v_mul_f32 v191, v143, v143
    v_fma_f32 v188, v188, s43, v203
    v_fma_f32 v189, v189, s43, v203
    v_fma_f32 v190, v190, s43, v203
    v_fma_f32 v191, v191, s43, v203
    v_mul_f32 v188, v188, v140
    v_mul_f32 v189, v189, v141
    v_mul_f32 v190, v190, v142
    v_mul_f32 v191, v191, v143
    v_exp_f32 v188, v188
    v_exp_f32 v189, v189
    v_exp_f32 v190, v190
    v_exp_f32 v191, v191
    v_add_f32 v188, 1.0, v188
    v_add_f32 v189, 1.0, v189
    v_add_f32 v190, 1.0, v190
    v_add_f32 v191, 1.0, v191
    v_rcp_f32 v188, v188
    v_rcp_f32 v189, v189
    v_rcp_f32 v190, v190
    v_rcp_f32 v191, v191
    v_mul_f32 v140, v140, v188
    v_mul_f32 v141, v141, v189
    v_mul_f32 v142, v142, v190
    v_mul_f32 v143, v143, v191
    v_cvt_pk_bf16_f32 v196, v140, v141
    v_cvt_pk_bf16_f32 v197, v142, v143
    buffer_store_dwordx2 v[196:197], v184, s[16:19], s50 offen offset:64
    v_lshlrev_b32 v183, 16, v183
    v_add_f32 v144, v144, v183
    v_add_f32 v145, v145, v183
    v_add_f32 v146, v146, v183
    v_add_f32 v147, v147, v183
    v_mul_f32 v188, v144, v144
    v_mul_f32 v189, v145, v145
    v_mul_f32 v190, v146, v146
    v_mul_f32 v191, v147, v147
    v_fma_f32 v188, v188, s43, v203
    v_fma_f32 v189, v189, s43, v203
    v_fma_f32 v190, v190, s43, v203
    v_fma_f32 v191, v191, s43, v203
    v_mul_f32 v188, v188, v144
    v_mul_f32 v189, v189, v145
    v_mul_f32 v190, v190, v146
    v_mul_f32 v191, v191, v147
    v_exp_f32 v188, v188
    v_exp_f32 v189, v189
    v_exp_f32 v190, v190
    v_exp_f32 v191, v191
    v_add_f32 v188, 1.0, v188
    v_add_f32 v189, 1.0, v189
    v_add_f32 v190, 1.0, v190
    v_add_f32 v191, 1.0, v191
    v_rcp_f32 v188, v188
    v_rcp_f32 v189, v189
    v_rcp_f32 v190, v190
    v_rcp_f32 v191, v191
    v_mul_f32 v144, v144, v188
    v_mul_f32 v145, v145, v189
    v_mul_f32 v146, v146, v190
    v_mul_f32 v147, v147, v191
    v_cvt_pk_bf16_f32 v192, v144, v145
    v_cvt_pk_bf16_f32 v193, v146, v147
    buffer_store_dwordx2 v[192:193], v184, s[16:19], s51 offen offset:0
    v_add_f32 v148, v148, v183
    v_add_f32 v149, v149, v183
    v_add_f32 v150, v150, v183
    v_add_f32 v151, v151, v183
    v_mul_f32 v188, v148, v148
    v_mul_f32 v189, v149, v149
    v_mul_f32 v190, v150, v150
    v_mul_f32 v191, v151, v151
    v_fma_f32 v188, v188, s43, v203
    v_fma_f32 v189, v189, s43, v203
    v_fma_f32 v190, v190, s43, v203
    v_fma_f32 v191, v191, s43, v203
    v_mul_f32 v188, v188, v148
    v_mul_f32 v189, v189, v149
    v_mul_f32 v190, v190, v150
    v_mul_f32 v191, v191, v151
    v_exp_f32 v188, v188
    v_exp_f32 v189, v189
    v_exp_f32 v190, v190
    v_exp_f32 v191, v191
    v_add_f32 v188, 1.0, v188
    v_add_f32 v189, 1.0, v189
    v_add_f32 v190, 1.0, v190
    v_add_f32 v191, 1.0, v191
    v_rcp_f32 v188, v188
    v_rcp_f32 v189, v189
    v_rcp_f32 v190, v190
    v_rcp_f32 v191, v191
    v_mul_f32 v148, v148, v188
    v_mul_f32 v149, v149, v189
    v_mul_f32 v150, v150, v190
    v_mul_f32 v151, v151, v191
    v_cvt_pk_bf16_f32 v194, v148, v149
    v_cvt_pk_bf16_f32 v195, v150, v151
    buffer_store_dwordx2 v[194:195], v184, s[16:19], s51 offen offset:32
    v_add_f32 v152, v152, v183
    v_add_f32 v153, v153, v183
    v_add_f32 v154, v154, v183
    v_add_f32 v155, v155, v183
    v_mul_f32 v188, v152, v152
    v_mul_f32 v189, v153, v153
    v_mul_f32 v190, v154, v154
    v_mul_f32 v191, v155, v155
    v_fma_f32 v188, v188, s43, v203
    v_fma_f32 v189, v189, s43, v203
    v_fma_f32 v190, v190, s43, v203
    v_fma_f32 v191, v191, s43, v203
    v_mul_f32 v188, v188, v152
    v_mul_f32 v189, v189, v153
    v_mul_f32 v190, v190, v154
    v_mul_f32 v191, v191, v155
    v_exp_f32 v188, v188
    v_exp_f32 v189, v189
    v_exp_f32 v190, v190
    v_exp_f32 v191, v191
    v_add_f32 v188, 1.0, v188
    v_add_f32 v189, 1.0, v189
    v_add_f32 v190, 1.0, v190
    v_add_f32 v191, 1.0, v191
    v_rcp_f32 v188, v188
    v_rcp_f32 v189, v189
    v_rcp_f32 v190, v190
    v_rcp_f32 v191, v191
    v_mul_f32 v152, v152, v188
    v_mul_f32 v153, v153, v189
    v_mul_f32 v154, v154, v190
    v_mul_f32 v155, v155, v191
    v_cvt_pk_bf16_f32 v196, v152, v153
    v_cvt_pk_bf16_f32 v197, v154, v155
    buffer_store_dwordx2 v[196:197], v184, s[16:19], s51 offen offset:64
L_mlp1_kernel_end:
    s_endpgm
.globl mlp2_kernel
.p2align 8
.type mlp2_kernel,@function
mlp2_kernel:
    s_cmp_ge_u32 s2, 192
    s_cbranch_scc1 L_mlp2_kernel_end
    s_load_dwordx16 s[64:79], s[0:1], 0
    s_load_dwordx4 s[80:83], s[0:1], 64
    s_load_dwordx2 s[84:85], s[0:1], 80
    s_waitcnt lgkmcnt(0)
    s_add_u32 s8, s84, 14286848
    s_addc_u32 s9, s85, 0
    s_and_b32 s9, s9, 0xffff
    s_mov_b32 s10, 5308416
    s_mov_b32 s11, 0x20000
    s_mov_b32 s12, s76
    s_and_b32 s13, s77, 0xffff
    s_mov_b32 s14, 18874368
    s_mov_b32 s15, 0x20000
    s_and_b32 s31, s2, 7
    s_lshr_b32 s32, s2, 3
    s_mov_b32 s33, 0x55555556
    s_mul_hi_u32 s33, s32, s33
    s_mul_i32 s34, s33, 3
    s_sub_u32 s32, s32, s34
    s_and_b32 s34, s31, 1
    s_mul_i32 s34, s34, 3
    s_add_u32 s32, s32, s34
    s_lshr_b32 s34, s31, 1
    s_lshl_b32 s34, s34, 3
    s_add_u32 s33, s33, s34
    s_mul_i32 s36, s32, 884736
    s_mul_i32 s37, s33, 128
    s_mov_b32 s52, 4096
    s_add_u32 s56, s84, 134217728
    s_addc_u32 s57, s85, 0
    s_and_b32 s57, s57, 0xffff
    s_mov_b32 s58, 2359296
    s_mov_b32 s59, 0x20000
    s_lshr_b32 s53, s33, 3
    s_mul_i32 s53, s53, 589824
    s_and_b32 s54, s33, 7
    s_cmp_eq_u32 s54, 3
    s_cselect_b32 s12, s56, s12
    s_cselect_b32 s13, s57, s13
    s_cselect_b32 s14, s58, s14
    s_cselect_b32 s37, s53, s37
    s_cselect_b32 s52, 128, s52
    s_lshl_b32 s53, s52, 6
    v_lshrrev_b32 v1, 6, v0
    v_and_b32 v2, 63, v0
    v_readfirstlane_b32 s38, v1
    s_lshr_b32 s55, s38, 2
    s_and_b32 s38, s38, 3
    s_cmp_eq_u32 s55, 0
    s_cbranch_scc1 L_mlp2_kernel_comp
    s_and_b32 s39, s38, 1
    s_lshr_b32 s40, s38, 1
    s_mul_i32 s34, s38, 3072
    s_mul_i32 s35, s38, 2048
    s_add_u32 s35, s35, 12288
    s_mul_i32 s42, s38, 192
    s_add_u32 s42, s42, 0
    v_add_u32 v6, s42, v2
    v_mul_u32_u24 v7, 0xAAAB, v6
    v_lshrrev_b32 v7, 19, v7
    v_mul_u32_u24 v8, 12, v7
    v_sub_u32 v8, v6, v8
    v_lshrrev_b32 v9, 1, v7
    v_and_b32 v9, 2, v9
    v_xor_b32 v8, v8, v9
    v_mul_u32_u24 v7, 192, v7
    v_lshl_add_u32 v7, v8, 4, v7
    s_sub_u32 s42, s36, 0
    v_add_u32 v16, s42, v7
    s_mul_i32 s42, s38, 192
    s_add_u32 s42, s42, 64
    v_add_u32 v6, s42, v2
    v_mul_u32_u24 v7, 0xAAAB, v6
    v_lshrrev_b32 v7, 19, v7
    v_mul_u32_u24 v8, 12, v7
    v_sub_u32 v8, v6, v8
    v_lshrrev_b32 v9, 1, v7
    v_and_b32 v9, 2, v9
    v_xor_b32 v8, v8, v9
    v_mul_u32_u24 v7, 192, v7
    v_lshl_add_u32 v7, v8, 4, v7
    s_sub_u32 s42, s36, 1024
    v_add_u32 v17, s42, v7
    s_mul_i32 s42, s38, 192
    s_add_u32 s42, s42, 128
    v_add_u32 v6, s42, v2
    v_mul_u32_u24 v7, 0xAAAB, v6
    v_lshrrev_b32 v7, 19, v7
    v_mul_u32_u24 v8, 12, v7
    v_sub_u32 v8, v6, v8
    v_lshrrev_b32 v9, 1, v7
    v_and_b32 v9, 2, v9
    v_xor_b32 v8, v8, v9
    v_mul_u32_u24 v7, 192, v7
    v_lshl_add_u32 v7, v8, 4, v7
    s_sub_u32 s42, s36, 2048
    v_add_u32 v18, s42, v7
    s_mov_b32 s43, s52
    s_lshl_b32 s42, s38, 4
    s_add_u32 s42, s42, 0
    v_lshrrev_b32 v6, 3, v2
    v_add_u32 v6, s42, v6
    v_and_b32 v7, 6, v6
    v_and_b32 v8, 7, v2
    v_xor_b32 v8, v8, v7
    v_mul_lo_u32 v6, v6, s43
    v_lshl_add_u32 v6, v8, 4, v6
    s_sub_u32 s42, s37, 0
    v_add_u32 v19, s42, v6
    s_lshl_b32 s42, s38, 4
    s_add_u32 s42, s42, 8
    v_lshrrev_b32 v6, 3, v2
    v_add_u32 v6, s42, v6
    v_and_b32 v7, 6, v6
    v_and_b32 v8, 7, v2
    v_xor_b32 v8, v8, v7
    v_mul_lo_u32 v6, v6, s43
    v_lshl_add_u32 v6, v8, 4, v6
    s_sub_u32 s42, s37, 1024
    v_add_u32 v20, s42, v6
    s_mov_b32 s28, 0
    s_mov_b32 s29, 0
    s_add_u32 m0, s34, 0
    s_nop 0
    buffer_load_dwordx4 v16, s[8:11], s28 offen offset:0 lds
    buffer_load_dwordx4 v17, s[8:11], s28 offen offset:1024 lds
    buffer_load_dwordx4 v18, s[8:11], s28 offen offset:2048 lds
    s_add_u32 m0, s35, 0
    s_nop 0
    buffer_load_dwordx4 v19, s[12:15], s29 offen offset:0 lds
    buffer_load_dwordx4 v20, s[12:15], s29 offen offset:1024 lds
    s_add_u32 s28, s28, 12288
    s_add_u32 s29, s29, s53
    s_add_u32 m0, s34, 20480
    s_nop 0
    buffer_load_dwordx4 v16, s[8:11], s28 offen offset:0 lds
    buffer_load_dwordx4 v17, s[8:11], s28 offen offset:1024 lds
    buffer_load_dwordx4 v18, s[8:11], s28 offen offset:2048 lds
    s_add_u32 m0, s35, 20480
    s_nop 0
    buffer_load_dwordx4 v19, s[12:15], s29 offen offset:0 lds
    buffer_load_dwordx4 v20, s[12:15], s29 offen offset:1024 lds
    s_add_u32 s28, s28, 12288
    s_add_u32 s29, s29, s53
    s_add_u32 m0, s34, 40960
    s_nop 0
    buffer_load_dwordx4 v16, s[8:11], s28 offen offset:0 lds
    buffer_load_dwordx4 v17, s[8:11], s28 offen offset:1024 lds
    buffer_load_dwordx4 v18, s[8:11], s28 offen offset:2048 lds
    s_add_u32 m0, s35, 40960
    s_nop 0
    buffer_load_dwordx4 v19, s[12:15], s29 offen offset:0 lds
    buffer_load_dwordx4 v20, s[12:15], s29 offen offset:1024 lds
    s_add_u32 s28, s28, 12288
    s_add_u32 s29, s29, s53
    s_add_u32 m0, s34, 61440
    s_nop 0
    buffer_load_dwordx4 v16, s[8:11], s28 offen offset:0 lds
    buffer_load_dwordx4 v17, s[8:11], s28 offen offset:1024 lds
    buffer_load_dwordx4 v18, s[8:11], s28 offen offset:2048 lds
    s_add_u32 m0, s35, 61440
    s_nop 0
    buffer_load_dwordx4 v19, s[12:15], s29 offen offset:0 lds
    buffer_load_dwordx4 v20, s[12:15], s29 offen offset:1024 lds
    s_add_u32 s28, s28, 12288
    s_add_u32 s29, s29, s53
    s_add_u32 m0, s34, 81920
    s_nop 0
    buffer_load_dwordx4 v16, s[8:11], s28 offen offset:0 lds
    buffer_load_dwordx4 v17, s[8:11], s28 offen offset:1024 lds
    buffer_load_dwordx4 v18, s[8:11], s28 offen offset:2048 lds
    s_add_u32 m0, s35, 81920
    s_nop 0
    buffer_load_dwordx4 v19, s[12:15], s29 offen offset:0 lds
    buffer_load_dwordx4 v20, s[12:15], s29 offen offset:1024 lds
    s_add_u32 s28, s28, 12288
    s_add_u32 s29, s29, s53
    s_waitcnt vmcnt(20)
    s_barrier
    s_mov_b32 s30, 0
L_mlp2_kernel_lloop:
    s_waitcnt vmcnt(15)
    s_barrier
    s_add_u32 m0, s34, 102400
    s_nop 0
    buffer_load_dwordx4 v16, s[8:11], s28 offen offset:0 lds
    buffer_load_dwordx4 v17, s[8:11], s28 offen offset:1024 lds
    buffer_load_dwordx4 v18, s[8:11], s28 offen offset:2048 lds
    s_add_u32 m0, s35, 102400
    s_nop 0
    buffer_load_dwordx4 v19, s[12:15], s29 offen offset:0 lds
    buffer_load_dwordx4 v20, s[12:15], s29 offen offset:1024 lds
    s_add_u32 s28, s28, 12288
    s_add_u32 s29, s29, s53
    s_waitcnt vmcnt(15)
    s_barrier
    s_add_u32 m0, s34, 0
    s_nop 0
    buffer_load_dwordx4 v16, s[8:11], s28 offen offset:0 lds
    buffer_load_dwordx4 v17, s[8:11], s28 offen offset:1024 lds
    buffer_load_dwordx4 v18, s[8:11], s28 offen offset:2048 lds
    s_add_u32 m0, s35, 0
    s_nop 0
    buffer_load_dwordx4 v19, s[12:15], s29 offen offset:0 lds
    buffer_load_dwordx4 v20, s[12:15], s29 offen offset:1024 lds
    s_add_u32 s28, s28, 12288
    s_add_u32 s29, s29, s53
    s_waitcnt vmcnt(15)
    s_barrier
    s_add_u32 m0, s34, 20480
    s_nop 0
    buffer_load_dwordx4 v16, s[8:11], s28 offen offset:0 lds
    buffer_load_dwordx4 v17, s[8:11], s28 offen offset:1024 lds
    buffer_load_dwordx4 v18, s[8:11], s28 offen offset:2048 lds
    s_add_u32 m0, s35, 20480
    s_nop 0
    buffer_load_dwordx4 v19, s[12:15], s29 offen offset:0 lds
    buffer_load_dwordx4 v20, s[12:15], s29 offen offset:1024 lds
    s_add_u32 s28, s28, 12288
    s_add_u32 s29, s29, s53
    s_waitcnt vmcnt(15)
    s_barrier
    s_add_u32 m0, s34, 40960
    s_nop 0
    buffer_load_dwordx4 v16, s[8:11], s28 offen offset:0 lds
    buffer_load_dwordx4 v17, s[8:11], s28 offen offset:1024 lds
    buffer_load_dwordx4 v18, s[8:11], s28 offen offset:2048 lds
    s_add_u32 m0, s35, 40960
    s_nop 0
    buffer_load_dwordx4 v19, s[12:15], s29 offen offset:0 lds
    buffer_load_dwordx4 v20, s[12:15], s29 offen offset:1024 lds
    s_add_u32 s28, s28, 12288
    s_add_u32 s29, s29, s53
    s_waitcnt vmcnt(15)
    s_barrier
    s_add_u32 m0, s34, 61440
    s_nop 0
    buffer_load_dwordx4 v16, s[8:11], s28 offen offset:0 lds
    buffer_load_dwordx4 v17, s[8:11], s28 offen offset:1024 lds
    buffer_load_dwordx4 v18, s[8:11], s28 offen offset:2048 lds
    s_add_u32 m0, s35, 61440
    s_nop 0
    buffer_load_dwordx4 v19, s[12:15], s29 offen offset:0 lds
    buffer_load_dwordx4 v20, s[12:15], s29 offen offset:1024 lds
    s_add_u32 s28, s28, 12288
    s_add_u32 s29, s29, s53
    s_waitcnt vmcnt(15)
    s_barrier
    s_add_u32 m0, s34, 81920
    s_nop 0
    buffer_load_dwordx4 v16, s[8:11], s28 offen offset:0 lds
    buffer_load_dwordx4 v17, s[8:11], s28 offen offset:1024 lds
    buffer_load_dwordx4 v18, s[8:11], s28 offen offset:2048 lds
    s_add_u32 m0, s35, 81920
    s_nop 0
    buffer_load_dwordx4 v19, s[12:15], s29 offen offset:0 lds
    buffer_load_dwordx4 v20, s[12:15], s29 offen offset:1024 lds
    s_add_u32 s28, s28, 12288
    s_add_u32 s29, s29, s53
    s_add_u32 s30, s30, 1
    s_cmp_lt_u32 s30, 12
    s_cbranch_scc1 L_mlp2_kernel_lloop
    s_endpgm
L_mlp2_kernel_comp:
    s_and_b32 s39, s38, 1
    s_lshr_b32 s40, s38, 1
    s_mov_b32 s16, s80
    s_and_b32 s17, s81, 0xffff
    s_mov_b32 s18, 2359296
    s_mov_b32 s19, 0x20000
    s_add_u32 s20, s84, 9568256
    s_addc_u32 s21, s85, 0
    s_and_b32 s21, s21, 0xffff
    s_mov_b32 s22, 2359296
    s_mov_b32 s23, 0x20000
    s_mov_b32 s24, s78
    s_and_b32 s25, s79, 0xffff
    s_mov_b32 s26, 4096
    s_mov_b32 s27, 0x20000
    v_and_b32 v3, 15, v2
    v_lshrrev_b32 v4, 4, v2
    s_mul_i32 s41, s33, 64
    s_mul_i32 s42, s40, 32
    s_add_u32 s41, s41, s42
    v_add_u32 v5, s41, v3
    s_mul_i32 s42, s39, 96
    v_lshl_add_u32 v6, v4, 3, s42
    v_mul_u32_u24 v131, 1152, v5
    s_mul_i32 s42, s32, 192
    v_add3_u32 v131, v131, v6, s42
    v_mov_b32 v130, v131
    s_mov_b32 s44, 0
    s_mov_b32 s48, 0
    s_mov_b32 s45, 18432
    s_mov_b32 s49, 18432
    buffer_load_dwordx2 v[116:117], v131, s[20:23], s44 offen offset:0
    buffer_load_dwordx2 v[118:119], v131, s[20:23], s44 offen offset:32
    buffer_load_dwordx2 v[120:121], v131, s[20:23], s44 offen offset:64
    buffer_load_dwordx2 v[122:123], v131, s[20:23], s45 offen offset:0
    buffer_load_dwordx2 v[124:125], v131, s[20:23], s45 offen offset:32
    buffer_load_dwordx2 v[126:127], v131, s[20:23], s45 offen offset:64
    v_lshlrev_b32 v7, 1, v5
    buffer_load_ushort v128, v7, s[24:27], 0 offen offset:0
    buffer_load_ushort v129, v7, s[24:27], 0 offen offset:32
    v_lshrrev_b32 v5, 2, v2
    v_and_b32 v5, 3, v5
    v_lshl_add_u32 v6, v4, 2, v5
    v_and_b32 v7, 3, v2
    v_lshlrev_b32 v7, 3, v7
    v_and_b32 v8, 1, v4
    v_mul_u32_u24 v9, 192, v6
    v_add_u32 v9, v9, v7
    s_mul_i32 s42, s39, 3
    s_add_u32 s43, s42, 0
    v_xor_b32 v10, s43, v8
    v_lshl_add_u32 v21, v10, 5, v9
    v_add_u32 v24, 20480, v21
    v_add_u32 v27, 40960, v21
    v_add_u32 v30, 61440, v21
    v_add_u32 v33, 81920, v21
    v_add_u32 v36, 102400, v21
    s_add_u32 s43, s42, 1
    v_xor_b32 v10, s43, v8
    v_lshl_add_u32 v22, v10, 5, v9
    v_add_u32 v25, 20480, v22
    v_add_u32 v28, 40960, v22
    v_add_u32 v31, 61440, v22
    v_add_u32 v34, 81920, v22
    v_add_u32 v37, 102400, v22
    s_add_u32 s43, s42, 2
    v_xor_b32 v10, s43, v8
    v_lshl_add_u32 v23, v10, 5, v9
    v_add_u32 v26, 20480, v23
    v_add_u32 v29, 40960, v23
    v_add_u32 v32, 61440, v23
    v_add_u32 v35, 81920, v23
    v_add_u32 v38, 102400, v23
    v_mul_u32_u24 v9, 128, v6
    v_add_u32 v9, v9, v7
    v_add_u32 v9, 12288, v9
    v_lshrrev_b32 v11, 1, v6
    v_and_b32 v11, 3, v11
    s_mul_i32 s42, s40, 2
    s_add_u32 s43, s42, 0
    v_xor_b32 v10, s43, v11
    v_lshl_add_u32 v39, v10, 5, v9
    v_add_u32 v41, 20480, v39
    v_add_u32 v43, 40960, v39
    v_add_u32 v45, 61440, v39
    v_add_u32 v47, 81920, v39
    v_add_u32 v49, 102400, v39
    s_add_u32 s43, s42, 1
    v_xor_b32 v10, s43, v11
    v_lshl_add_u32 v40, v10, 5, v9
    v_add_u32 v42, 20480, v40
    v_add_u32 v44, 40960, v40
    v_add_u32 v46, 61440, v40
    v_add_u32 v48, 81920, v40
    v_add_u32 v50, 102400, v40
    v_mov_b32 v92, 0
    v_mov_b32 v93, 0
    v_mov_b32 v94, 0
    v_mov_b32 v95, 0
    v_mov_b32 v96, 0
    v_mov_b32 v97, 0
    v_mov_b32 v98, 0
    v_mov_b32 v99, 0
    v_mov_b32 v100, 0
    v_mov_b32 v101, 0
    v_mov_b32 v102, 0
    v_mov_b32 v103, 0
    v_mov_b32 v104, 0
    v_mov_b32 v105, 0
    v_mov_b32 v106, 0
    v_mov_b32 v107, 0
    v_mov_b32 v108, 0
    v_mov_b32 v109, 0
    v_mov_b32 v110, 0
    v_mov_b32 v111, 0
    v_mov_b32 v112, 0
    v_mov_b32 v113, 0
    v_mov_b32 v114, 0
    v_mov_b32 v115, 0
    s_barrier
    ds_read_b64_tr_b16 v[52:53], v21 offset:0
    ds_read_b64_tr_b16 v[54:55], v21 offset:3072
    ds_read_b64_tr_b16 v[64:65], v39 offset:0
    ds_read_b64_tr_b16 v[66:67], v39 offset:2048
    ds_read_b64_tr_b16 v[56:57], v22 offset:0
    ds_read_b64_tr_b16 v[58:59], v22 offset:3072
    ds_read_b64_tr_b16 v[60:61], v23 offset:0
    ds_read_b64_tr_b16 v[62:63], v23 offset:3072
    ds_read_b64_tr_b16 v[68:69], v40 offset:0
    ds_read_b64_tr_b16 v[70:71], v40 offset:2048
    s_mov_b32 s30, 0
L_mlp2_kernel_loop:
    s_waitcnt lgkmcnt(6)
    v_mfma_f32_16x16x32_bf16 v[92:95], v[52:55], v[64:67], v[92:95]
    ds_read_b64_tr_b16 v[72:73], v21 offset:6144
    ds_read_b64_tr_b16 v[74:75], v21 offset:9216
    s_waitcnt lgkmcnt(6)
    v_mfma_f32_16x16x32_bf16 v[96:99], v[56:59], v[64:67], v[96:99]
    ds_read_b64_tr_b16 v[84:85], v39 offset:4096
    ds_read_b64_tr_b16 v[86:87], v39 offset:6144
    s_waitcnt lgkmcnt(6)
    v_mfma_f32_16x16x32_bf16 v[100:103], v[60:63], v[64:67], v[100:103]
    ds_read_b64_tr_b16 v[76:77], v22 offset:6144
    ds_read_b64_tr_b16 v[78:79], v22 offset:9216
    s_waitcnt lgkmcnt(6)
    v_mfma_f32_16x16x32_bf16 v[104:107], v[52:55], v[68:71], v[104:107]
    ds_read_b64_tr_b16 v[80:81], v23 offset:6144
    ds_read_b64_tr_b16 v[82:83], v23 offset:9216
    v_mfma_f32_16x16x32_bf16 v[108:111], v[56:59], v[68:71], v[108:111]
    ds_read_b64_tr_b16 v[88:89], v40 offset:4096
    v_mfma_f32_16x16x32_bf16 v[112:115], v[60:63], v[68:71], v[112:115]
    ds_read_b64_tr_b16 v[90:91], v40 offset:6144
    s_barrier
    s_waitcnt lgkmcnt(6)
    v_mfma_f32_16x16x32_bf16 v[92:95], v[72:75], v[84:87], v[92:95]
    ds_read_b64_tr_b16 v[52:53], v24 offset:0
    ds_read_b64_tr_b16 v[54:55], v24 offset:3072
    s_waitcnt lgkmcnt(6)
    v_mfma_f32_16x16x32_bf16 v[96:99], v[76:79], v[84:87], v[96:99]
    ds_read_b64_tr_b16 v[64:65], v41 offset:0
    ds_read_b64_tr_b16 v[66:67], v41 offset:2048
    s_waitcnt lgkmcnt(6)
    v_mfma_f32_16x16x32_bf16 v[100:103], v[80:83], v[84:87], v[100:103]
    ds_read_b64_tr_b16 v[56:57], v25 offset:0
    ds_read_b64_tr_b16 v[58:59], v25 offset:3072
    s_waitcnt lgkmcnt(6)
    v_mfma_f32_16x16x32_bf16 v[104:107], v[72:75], v[88:91], v[104:107]
    ds_read_b64_tr_b16 v[60:61], v26 offset:0
    ds_read_b64_tr_b16 v[62:63], v26 offset:3072
    v_mfma_f32_16x16x32_bf16 v[108:111], v[76:79], v[88:91], v[108:111]
    ds_read_b64_tr_b16 v[68:69], v42 offset:0
    v_mfma_f32_16x16x32_bf16 v[112:115], v[80:83], v[88:91], v[112:115]
    ds_read_b64_tr_b16 v[70:71], v42 offset:2048
    s_waitcnt lgkmcnt(6)
    v_mfma_f32_16x16x32_bf16 v[92:95], v[52:55], v[64:67], v[92:95]
    ds_read_b64_tr_b16 v[72:73], v24 offset:6144
    ds_read_b64_tr_b16 v[74:75], v24 offset:9216
    s_waitcnt lgkmcnt(6)
    v_mfma_f32_16x16x32_bf16 v[96:99], v[56:59], v[64:67], v[96:99]
    ds_read_b64_tr_b16 v[84:85], v41 offset:4096
    ds_read_b64_tr_b16 v[86:87], v41 offset:6144
    s_waitcnt lgkmcnt(6)
    v_mfma_f32_16x16x32_bf16 v[100:103], v[60:63], v[64:67], v[100:103]
    ds_read_b64_tr_b16 v[76:77], v25 offset:6144
    ds_read_b64_tr_b16 v[78:79], v25 offset:9216
    s_waitcnt lgkmcnt(6)
    v_mfma_f32_16x16x32_bf16 v[104:107], v[52:55], v[68:71], v[104:107]
    ds_read_b64_tr_b16 v[80:81], v26 offset:6144
    ds_read_b64_tr_b16 v[82:83], v26 offset:9216
    v_mfma_f32_16x16x32_bf16 v[108:111], v[56:59], v[68:71], v[108:111]
    ds_read_b64_tr_b16 v[88:89], v42 offset:4096
    v_mfma_f32_16x16x32_bf16 v[112:115], v[60:63], v[68:71], v[112:115]
    ds_read_b64_tr_b16 v[90:91], v42 offset:6144
    s_barrier
    s_waitcnt lgkmcnt(6)
    v_mfma_f32_16x16x32_bf16 v[92:95], v[72:75], v[84:87], v[92:95]
    ds_read_b64_tr_b16 v[52:53], v27 offset:0
    ds_read_b64_tr_b16 v[54:55], v27 offset:3072
    s_waitcnt lgkmcnt(6)
    v_mfma_f32_16x16x32_bf16 v[96:99], v[76:79], v[84:87], v[96:99]
    ds_read_b64_tr_b16 v[64:65], v43 offset:0
    ds_read_b64_tr_b16 v[66:67], v43 offset:2048
    s_waitcnt lgkmcnt(6)
    v_mfma_f32_16x16x32_bf16 v[100:103], v[80:83], v[84:87], v[100:103]
    ds_read_b64_tr_b16 v[56:57], v28 offset:0
    ds_read_b64_tr_b16 v[58:59], v28 offset:3072
    s_waitcnt lgkmcnt(6)
    v_mfma_f32_16x16x32_bf16 v[104:107], v[72:75], v[88:91], v[104:107]
    ds_read_b64_tr_b16 v[60:61], v29 offset:0
    ds_read_b64_tr_b16 v[62:63], v29 offset:3072
    v_mfma_f32_16x16x32_bf16 v[108:111], v[76:79], v[88:91], v[108:111]
    ds_read_b64_tr_b16 v[68:69], v44 offset:0
    v_mfma_f32_16x16x32_bf16 v[112:115], v[80:83], v[88:91], v[112:115]
    ds_read_b64_tr_b16 v[70:71], v44 offset:2048
    s_waitcnt lgkmcnt(6)
    v_mfma_f32_16x16x32_bf16 v[92:95], v[52:55], v[64:67], v[92:95]
    ds_read_b64_tr_b16 v[72:73], v27 offset:6144
    ds_read_b64_tr_b16 v[74:75], v27 offset:9216
    s_waitcnt lgkmcnt(6)
    v_mfma_f32_16x16x32_bf16 v[96:99], v[56:59], v[64:67], v[96:99]
    ds_read_b64_tr_b16 v[84:85], v43 offset:4096
    ds_read_b64_tr_b16 v[86:87], v43 offset:6144
    s_waitcnt lgkmcnt(6)
    v_mfma_f32_16x16x32_bf16 v[100:103], v[60:63], v[64:67], v[100:103]
    ds_read_b64_tr_b16 v[76:77], v28 offset:6144
    ds_read_b64_tr_b16 v[78:79], v28 offset:9216
    s_waitcnt lgkmcnt(6)
    v_mfma_f32_16x16x32_bf16 v[104:107], v[52:55], v[68:71], v[104:107]
    ds_read_b64_tr_b16 v[80:81], v29 offset:6144
    ds_read_b64_tr_b16 v[82:83], v29 offset:9216
    v_mfma_f32_16x16x32_bf16 v[108:111], v[56:59], v[68:71], v[108:111]
    ds_read_b64_tr_b16 v[88:89], v44 offset:4096
    v_mfma_f32_16x16x32_bf16 v[112:115], v[60:63], v[68:71], v[112:115]
    ds_read_b64_tr_b16 v[90:91], v44 offset:6144
    s_barrier
    s_waitcnt lgkmcnt(6)
    v_mfma_f32_16x16x32_bf16 v[92:95], v[72:75], v[84:87], v[92:95]
    ds_read_b64_tr_b16 v[52:53], v30 offset:0
    ds_read_b64_tr_b16 v[54:55], v30 offset:3072
    s_waitcnt lgkmcnt(6)
    v_mfma_f32_16x16x32_bf16 v[96:99], v[76:79], v[84:87], v[96:99]
    ds_read_b64_tr_b16 v[64:65], v45 offset:0
    ds_read_b64_tr_b16 v[66:67], v45 offset:2048
    s_waitcnt lgkmcnt(6)
    v_mfma_f32_16x16x32_bf16 v[100:103], v[80:83], v[84:87], v[100:103]
    ds_read_b64_tr_b16 v[56:57], v31 offset:0
    ds_read_b64_tr_b16 v[58:59], v31 offset:3072
    s_waitcnt lgkmcnt(6)
    v_mfma_f32_16x16x32_bf16 v[104:107], v[72:75], v[88:91], v[104:107]
    ds_read_b64_tr_b16 v[60:61], v32 offset:0
    ds_read_b64_tr_b16 v[62:63], v32 offset:3072
    v_mfma_f32_16x16x32_bf16 v[108:111], v[76:79], v[88:91], v[108:111]
    ds_read_b64_tr_b16 v[68:69], v46 offset:0
    v_mfma_f32_16x16x32_bf16 v[112:115], v[80:83], v[88:91], v[112:115]
    ds_read_b64_tr_b16 v[70:71], v46 offset:2048
    s_waitcnt lgkmcnt(6)
    v_mfma_f32_16x16x32_bf16 v[92:95], v[52:55], v[64:67], v[92:95]
    ds_read_b64_tr_b16 v[72:73], v30 offset:6144
    ds_read_b64_tr_b16 v[74:75], v30 offset:9216
    s_waitcnt lgkmcnt(6)
    v_mfma_f32_16x16x32_bf16 v[96:99], v[56:59], v[64:67], v[96:99]
    ds_read_b64_tr_b16 v[84:85], v45 offset:4096
    ds_read_b64_tr_b16 v[86:87], v45 offset:6144
    s_waitcnt lgkmcnt(6)
    v_mfma_f32_16x16x32_bf16 v[100:103], v[60:63], v[64:67], v[100:103]
    ds_read_b64_tr_b16 v[76:77], v31 offset:6144
    ds_read_b64_tr_b16 v[78:79], v31 offset:9216
    s_waitcnt lgkmcnt(6)
    v_mfma_f32_16x16x32_bf16 v[104:107], v[52:55], v[68:71], v[104:107]
    ds_read_b64_tr_b16 v[80:81], v32 offset:6144
    ds_read_b64_tr_b16 v[82:83], v32 offset:9216
    v_mfma_f32_16x16x32_bf16 v[108:111], v[56:59], v[68:71], v[108:111]
    ds_read_b64_tr_b16 v[88:89], v46 offset:4096
    v_mfma_f32_16x16x32_bf16 v[112:115], v[60:63], v[68:71], v[112:115]
    ds_read_b64_tr_b16 v[90:91], v46 offset:6144
    s_barrier
    s_waitcnt lgkmcnt(6)
    v_mfma_f32_16x16x32_bf16 v[92:95], v[72:75], v[84:87], v[92:95]
    ds_read_b64_tr_b16 v[52:53], v33 offset:0
    ds_read_b64_tr_b16 v[54:55], v33 offset:3072
    s_waitcnt lgkmcnt(6)
    v_mfma_f32_16x16x32_bf16 v[96:99], v[76:79], v[84:87], v[96:99]
    ds_read_b64_tr_b16 v[64:65], v47 offset:0
    ds_read_b64_tr_b16 v[66:67], v47 offset:2048
    s_waitcnt lgkmcnt(6)
    v_mfma_f32_16x16x32_bf16 v[100:103], v[80:83], v[84:87], v[100:103]
    ds_read_b64_tr_b16 v[56:57], v34 offset:0
    ds_read_b64_tr_b16 v[58:59], v34 offset:3072
    s_waitcnt lgkmcnt(6)
    v_mfma_f32_16x16x32_bf16 v[104:107], v[72:75], v[88:91], v[104:107]
    ds_read_b64_tr_b16 v[60:61], v35 offset:0
    ds_read_b64_tr_b16 v[62:63], v35 offset:3072
    v_mfma_f32_16x16x32_bf16 v[108:111], v[76:79], v[88:91], v[108:111]
    ds_read_b64_tr_b16 v[68:69], v48 offset:0
    v_mfma_f32_16x16x32_bf16 v[112:115], v[80:83], v[88:91], v[112:115]
    ds_read_b64_tr_b16 v[70:71], v48 offset:2048
    s_waitcnt lgkmcnt(6)
    v_mfma_f32_16x16x32_bf16 v[92:95], v[52:55], v[64:67], v[92:95]
    ds_read_b64_tr_b16 v[72:73], v33 offset:6144
    ds_read_b64_tr_b16 v[74:75], v33 offset:9216
    s_waitcnt lgkmcnt(6)
    v_mfma_f32_16x16x32_bf16 v[96:99], v[56:59], v[64:67], v[96:99]
    ds_read_b64_tr_b16 v[84:85], v47 offset:4096
    ds_read_b64_tr_b16 v[86:87], v47 offset:6144
    s_waitcnt lgkmcnt(6)
    v_mfma_f32_16x16x32_bf16 v[100:103], v[60:63], v[64:67], v[100:103]
    ds_read_b64_tr_b16 v[76:77], v34 offset:6144
    ds_read_b64_tr_b16 v[78:79], v34 offset:9216
    s_waitcnt lgkmcnt(6)
    v_mfma_f32_16x16x32_bf16 v[104:107], v[52:55], v[68:71], v[104:107]
    ds_read_b64_tr_b16 v[80:81], v35 offset:6144
    ds_read_b64_tr_b16 v[82:83], v35 offset:9216
    v_mfma_f32_16x16x32_bf16 v[108:111], v[56:59], v[68:71], v[108:111]
    ds_read_b64_tr_b16 v[88:89], v48 offset:4096
    v_mfma_f32_16x16x32_bf16 v[112:115], v[60:63], v[68:71], v[112:115]
    ds_read_b64_tr_b16 v[90:91], v48 offset:6144
    s_barrier
    s_waitcnt lgkmcnt(6)
    v_mfma_f32_16x16x32_bf16 v[92:95], v[72:75], v[84:87], v[92:95]
    ds_read_b64_tr_b16 v[52:53], v36 offset:0
    ds_read_b64_tr_b16 v[54:55], v36 offset:3072
    s_waitcnt lgkmcnt(6)
    v_mfma_f32_16x16x32_bf16 v[96:99], v[76:79], v[84:87], v[96:99]
    ds_read_b64_tr_b16 v[64:65], v49 offset:0
    ds_read_b64_tr_b16 v[66:67], v49 offset:2048
    s_waitcnt lgkmcnt(6)
    v_mfma_f32_16x16x32_bf16 v[100:103], v[80:83], v[84:87], v[100:103]
    ds_read_b64_tr_b16 v[56:57], v37 offset:0
    ds_read_b64_tr_b16 v[58:59], v37 offset:3072
    s_waitcnt lgkmcnt(6)
    v_mfma_f32_16x16x32_bf16 v[104:107], v[72:75], v[88:91], v[104:107]
    ds_read_b64_tr_b16 v[60:61], v38 offset:0
    ds_read_b64_tr_b16 v[62:63], v38 offset:3072
    v_mfma_f32_16x16x32_bf16 v[108:111], v[76:79], v[88:91], v[108:111]
    ds_read_b64_tr_b16 v[68:69], v50 offset:0
    v_mfma_f32_16x16x32_bf16 v[112:115], v[80:83], v[88:91], v[112:115]
    ds_read_b64_tr_b16 v[70:71], v50 offset:2048
    s_waitcnt lgkmcnt(6)
    v_mfma_f32_16x16x32_bf16 v[92:95], v[52:55], v[64:67], v[92:95]
    ds_read_b64_tr_b16 v[72:73], v36 offset:6144
    ds_read_b64_tr_b16 v[74:75], v36 offset:9216
    s_waitcnt lgkmcnt(6)
    v_mfma_f32_16x16x32_bf16 v[96:99], v[56:59], v[64:67], v[96:99]
    ds_read_b64_tr_b16 v[84:85], v49 offset:4096
    ds_read_b64_tr_b16 v[86:87], v49 offset:6144
    s_waitcnt lgkmcnt(6)
    v_mfma_f32_16x16x32_bf16 v[100:103], v[60:63], v[64:67], v[100:103]
    ds_read_b64_tr_b16 v[76:77], v37 offset:6144
    ds_read_b64_tr_b16 v[78:79], v37 offset:9216
    s_waitcnt lgkmcnt(6)
    v_mfma_f32_16x16x32_bf16 v[104:107], v[52:55], v[68:71], v[104:107]
    ds_read_b64_tr_b16 v[80:81], v38 offset:6144
    ds_read_b64_tr_b16 v[82:83], v38 offset:9216
    v_mfma_f32_16x16x32_bf16 v[108:111], v[56:59], v[68:71], v[108:111]
    ds_read_b64_tr_b16 v[88:89], v50 offset:4096
    v_mfma_f32_16x16x32_bf16 v[112:115], v[60:63], v[68:71], v[112:115]
    ds_read_b64_tr_b16 v[90:91], v50 offset:6144
    s_barrier
    s_waitcnt lgkmcnt(6)
    v_mfma_f32_16x16x32_bf16 v[92:95], v[72:75], v[84:87], v[92:95]
    ds_read_b64_tr_b16 v[52:53], v21 offset:0
    ds_read_b64_tr_b16 v[54:55], v21 offset:3072
    s_waitcnt lgkmcnt(6)
    v_mfma_f32_16x16x32_bf16 v[96:99], v[76:79], v[84:87], v[96:99]
    ds_read_b64_tr_b16 v[64:65], v39 offset:0
    ds_read_b64_tr_b16 v[66:67], v39 offset:2048
    s_waitcnt lgkmcnt(6)
    v_mfma_f32_16x16x32_bf16 v[100:103], v[80:83], v[84:87], v[100:103]
    ds_read_b64_tr_b16 v[56:57], v22 offset:0
    ds_read_b64_tr_b16 v[58:59], v22 offset:3072
    s_waitcnt lgkmcnt(6)
    v_mfma_f32_16x16x32_bf16 v[104:107], v[72:75], v[88:91], v[104:107]
    ds_read_b64_tr_b16 v[60:61], v23 offset:0
    ds_read_b64_tr_b16 v[62:63], v23 offset:3072
    v_mfma_f32_16x16x32_bf16 v[108:111], v[76:79], v[88:91], v[108:111]
    ds_read_b64_tr_b16 v[68:69], v40 offset:0
    v_mfma_f32_16x16x32_bf16 v[112:115], v[80:83], v[88:91], v[112:115]
    ds_read_b64_tr_b16 v[70:71], v40 offset:2048
    s_add_u32 s30, s30, 1
    s_cmp_lt_u32 s30, 12
    s_cbranch_scc1 L_mlp2_kernel_loop
    s_waitcnt vmcnt(0) lgkmcnt(0)
    v_lshlrev_b32 v128, 16, v128
    v_add_f32 v92, v92, v128
    v_add_f32 v93, v93, v128
    v_add_f32 v94, v94, v128
    v_add_f32 v95, v95, v128
    v_lshlrev_b32 v132, 16, v116
    v_and_b32 v133, 0xffff0000, v116
    v_lshlrev_b32 v134, 16, v117
    v_and_b32 v135, 0xffff0000, v117
    v_add_f32 v92, v92, v132
    v_add_f32 v93, v93, v133
    v_add_f32 v94, v94, v134
    v_add_f32 v95, v95, v135
    v_cvt_pk_bf16_f32 v136, v92, v93
    v_cvt_pk_bf16_f32 v137, v94, v95
    buffer_store_dwordx2 v[136:137], v130, s[16:19], s48 offen offset:0
    v_add_f32 v96, v96, v128
    v_add_f32 v97, v97, v128
    v_add_f32 v98, v98, v128
    v_add_f32 v99, v99, v128
    v_lshlrev_b32 v132, 16, v118
    v_and_b32 v133, 0xffff0000, v118
    v_lshlrev_b32 v134, 16, v119
    v_and_b32 v135, 0xffff0000, v119
    v_add_f32 v96, v96, v132
    v_add_f32 v97, v97, v133
    v_add_f32 v98, v98, v134
    v_add_f32 v99, v99, v135
    v_cvt_pk_bf16_f32 v138, v96, v97
    v_cvt_pk_bf16_f32 v139, v98, v99
    buffer_store_dwordx2 v[138:139], v130, s[16:19], s48 offen offset:32
    v_add_f32 v100, v100, v128
    v_add_f32 v101, v101, v128
    v_add_f32 v102, v102, v128
    v_add_f32 v103, v103, v128
    v_lshlrev_b32 v132, 16, v120
    v_and_b32 v133, 0xffff0000, v120
    v_lshlrev_b32 v134, 16, v121
    v_and_b32 v135, 0xffff0000, v121
    v_add_f32 v100, v100, v132
    v_add_f32 v101, v101, v133
    v_add_f32 v102, v102, v134
    v_add_f32 v103, v103, v135
    v_cvt_pk_bf16_f32 v140, v100, v101
    v_cvt_pk_bf16_f32 v141, v102, v103
    buffer_store_dwordx2 v[140:141], v130, s[16:19], s48 offen offset:64
    v_lshlrev_b32 v129, 16, v129
    v_add_f32 v104, v104, v129
    v_add_f32 v105, v105, v129
    v_add_f32 v106, v106, v129
    v_add_f32 v107, v107, v129
    v_lshlrev_b32 v132, 16, v122
    v_and_b32 v133, 0xffff0000, v122
    v_lshlrev_b32 v134, 16, v123
    v_and_b32 v135, 0xffff0000, v123
    v_add_f32 v104, v104, v132
    v_add_f32 v105, v105, v133
    v_add_f32 v106, v106, v134
    v_add_f32 v107, v107, v135
    v_cvt_pk_bf16_f32 v136, v104, v105
    v_cvt_pk_bf16_f32 v137, v106, v107
    buffer_store_dwordx2 v[136:137], v130, s[16:19], s49 offen offset:0
    v_add_f32 v108, v108, v129
    v_add_f32 v109, v109, v129
    v_add_f32 v110, v110, v129
    v_add_f32 v111, v111, v129
    v_lshlrev_b32 v132, 16, v124
    v_and_b32 v133, 0xffff0000, v124
    v_lshlrev_b32 v134, 16, v125
    v_and_b32 v135, 0xffff0000, v125
    v_add_f32 v108, v108, v132
    v_add_f32 v109, v109, v133
    v_add_f32 v110, v110, v134
    v_add_f32 v111, v111, v135
    v_cvt_pk_bf16_f32 v138, v108, v109
    v_cvt_pk_bf16_f32 v139, v110, v111
    buffer_store_dwordx2 v[138:139], v130, s[16:19], s49 offen offset:32
    v_add_f32 v112, v112, v129
    v_add_f32 v113, v113, v129
    v_add_f32 v114, v114, v129
    v_add_f32 v115, v115, v129
    v_lshlrev_b32 v132, 16, v126
    v_and_b32 v133, 0xffff0000, v126
    v_lshlrev_b32 v134, 16, v127
    v_and_b32 v135, 0xffff0000, v127
    v_add_f32 v112, v112, v132
    v_add_f32 v113, v113, v133
    v_add_f32 v114, v114, v134
    v_add_f32 v115, v115, v135
    v_cvt_pk_bf16_f32 v140, v112, v113
    v_cvt_pk_bf16_f32 v141, v114, v115
    buffer_store_dwordx2 v[140:141], v130, s[16:19], s49 offen offset:64
L_mlp2_kernel_end:
    s_endpgm
.section .rodata,"a"
.p2align 6
.amdhsa_kernel qkv_kernel
  .amdhsa_next_free_vgpr 256
  .amdhsa_next_free_sgpr 96
  .amdhsa_accum_offset 84
  .amdhsa_group_segment_fixed_size 0
  .amdhsa_kernarg_size 88
  .amdhsa_user_sgpr_count 2
  .amdhsa_user_sgpr_kernarg_segment_ptr 1
  .amdhsa_system_sgpr_workgroup_id_x 1
.end_amdhsa_kernel
.p2align 6
.amdhsa_kernel attn_kernel
  .amdhsa_next_free_vgpr 168
  .amdhsa_next_free_sgpr 96
  .amdhsa_accum_offset 168
  .amdhsa_group_segment_fixed_size 0
  .amdhsa_kernarg_size 88
  .amdhsa_user_sgpr_count 2
  .amdhsa_user_sgpr_kernarg_segment_ptr 1
  .amdhsa_system_sgpr_workgroup_id_x 1
.end_amdhsa_kernel
.p2align 6
.amdhsa_kernel wo_kernel
  .amdhsa_next_free_vgpr 160
  .amdhsa_next_free_sgpr 96
  .amdhsa_accum_offset 160
  .amdhsa_group_segment_fixed_size 0
  .amdhsa_kernarg_size 88
  .amdhsa_user_sgpr_count 2
  .amdhsa_user_sgpr_kernarg_segment_ptr 1
  .amdhsa_system_sgpr_workgroup_id_x 1
.end_amdhsa_kernel
.p2align 6
.amdhsa_kernel ln2_kernel
  .amdhsa_next_free_vgpr 160
  .amdhsa_next_free_sgpr 96
  .amdhsa_accum_offset 160
  .amdhsa_group_segment_fixed_size 0
  .amdhsa_kernarg_size 88
  .amdhsa_user_sgpr_count 2
  .amdhsa_user_sgpr_kernarg_segment_ptr 1
  .amdhsa_system_sgpr_workgroup_id_x 1
.end_amdhsa_kernel
.p2align 6
.amdhsa_kernel mlp1_kernel
  .amdhsa_next_free_vgpr 208
  .amdhsa_next_free_sgpr 96
  .amdhsa_accum_offset 204
  .amdhsa_group_segment_fixed_size 0
  .amdhsa_kernarg_size 88
  .amdhsa_user_sgpr_count 2
  .amdhsa_user_sgpr_kernarg_segment_ptr 1
  .amdhsa_system_sgpr_workgroup_id_x 1
.end_amdhsa_kernel
.p2align 6
.amdhsa_kernel mlp2_kernel
  .amdhsa_next_free_vgpr 152
  .amdhsa_next_free_sgpr 96
  .amdhsa_accum_offset 148
  .amdhsa_group_segment_fixed_size 0
  .amdhsa_kernarg_size 88
  .amdhsa_user_sgpr_count 2
  .amdhsa_user_sgpr_kernarg_segment_ptr 1
  .amdhsa_system_sgpr_workgroup_id_x 1
.end_amdhsa_kernel
```
